```python
import torch

def _softmax(x, axis=-1):
    return torch.softmax(x, dim=axis)
def _gelu(x):
    return torch.nn.functional.gelu(x, approximate="tanh")
def _silu(x):
    return torch.nn.functional.silu(x)
def _sigmoid(x):
    return torch.sigmoid(x)
def _layernorm(x, axis=-1, eps=1e-5):
    m = x.mean(dim=axis, keepdim=True)
    v = x.var(dim=axis, keepdim=True, unbiased=False)
    return (x - m) / torch.sqrt(v + eps)
def _scatter_add(tgt, idx, src, axis=0):
    return tgt.clone().index_add_(axis, idx, src)
def _segment_sum(src, seg, n):
    out = torch.zeros((n,) + src.shape[1:], dtype=src.dtype)
    return out.index_add_(0, seg, src)
def _pad(x, pw):
    flat = tuple(v for pair in reversed(pw) for v in pair)
    return torch.nn.functional.pad(x, flat)

kernel_name = 'recurrent_scan__sliding_local_dilated__mixer_token_mlp__prompt'

def setup_inputs():

    _w = (lambda a: (lambda t: t.to(torch.bfloat16) if t.is_floating_point() else t)(torch.as_tensor(a)))
    def _A_setup():
        B, S, D = 1, 2048, 448
        return {
            "x": _w((lambda *s: torch.randn(*s, dtype=torch.bfloat16) * 0.05)(B, S, D)),
            "wqkv": _w((lambda *s: torch.randn(*s, dtype=torch.bfloat16) * 0.2)(D, 3 * D)),
            "wo": _w((lambda *s: torch.randn(*s, dtype=torch.bfloat16) * 0.2)(D, D)),
        }
    _A_in = _A_setup()

    def _B_setup():
        B, S, D, F = 1, 2048, 448, 1792
        return {
            "x": _w((lambda *s: torch.randn(*s, dtype=torch.bfloat16) * 0.05)(B, S, D)),
            "w1": _w((lambda *s: torch.randn(*s, dtype=torch.bfloat16) * 0.8)(S, F) * (S ** -0.5)),
            "b1": _w((lambda *s: torch.randn(*s, dtype=torch.bfloat16) * 0.8)(F) * 0.02),
            "w2": _w((lambda *s: torch.randn(*s, dtype=torch.bfloat16) * 0.1)(F, S) * (F ** -0.5)),
            "b2": _w((lambda *s: torch.randn(*s, dtype=torch.bfloat16) * 0.1)(S) * 0.02),
        }
    _B_in = _B_setup()

    return {
        "A_x": _A_in["x"],
        "A_wqkv": _A_in["wqkv"],
        "A_wo": _A_in["wo"],
        "B_x": _B_in["x"],
        "B_w1": _B_in["w1"],
        "B_b1": _B_in["b1"],
        "B_w2": _B_in["w2"],
        "B_b2": _B_in["b2"],
    }

def reference(A_x, A_wqkv, A_wo, B_x, B_w1, B_b1, B_w2, B_b2):
    def _A_ref(x, wqkv, wo):
        B, S, D = x.shape
        H = 16; Dh = D // H
        W, dil = 8, 2
        qkv = (lambda x, *d: x.permute(*d))((x @ wqkv).reshape(B, S, 3, H, Dh), 2, 0, 3, 1, 4)
        q, k, v = qkv[0], qkv[1], qkv[2]
        scale = Dh ** -0.5
        pos = torch.arange(S)
        off = torch.arange(W) * dil
        idx = pos[:, None] - off[None, :]
        mask = idx >= 0
        idx_c = torch.where(mask, idx, 0).reshape(-1)
        kg = k[:, :, idx_c, :].reshape(B, H, S, W, Dh)
        vg = v[:, :, idx_c, :].reshape(B, H, S, W, Dh)
        logits = torch.einsum("bhsd,bhswd->bhsw", q, kg) * scale
        logits = torch.where(mask[None, None, :, :], logits, -1e9)
        attn = _softmax(logits, axis=-1)
        o = torch.einsum("bhsw,bhswd->bhsd", attn, vg)
        return (lambda x, *d: x.permute(*d))(o, 0, 2, 1, 3).reshape(B, S, D) @ wo

    def _B_ref(x, w1, b1, w2, b2):
        B, S, D = x.shape
        h = _layernorm(x, axis=-1)
        u = torch.einsum("bsd,sf->bdf", h, w1) + b1
        u = _gelu(u)
        y = torch.einsum("bdf,fs->bds", u, w2) + b2
        return (lambda x, *d: x.permute(*d))(y, 0, 2, 1)

    x = A_x
    xn = _layernorm(x, axis=-1)
    s = _A_ref(xn, A_wqkv, A_wo)
    g = _silu(_B_ref(xn, B_w1, B_b1, B_w2, B_b2))
    return x + s * g
```

```asm
; @launch grid=(256,1,1) block=(256,1,1) lds=163840
.amdgcn_target "amdgcn-amd-amdhsa--gfx950"
.text
.p2align 12
.globl recurrent_scan__sliding_local_dilated__mixer_token_mlp__prompt_kernel
.p2align 8
.type recurrent_scan__sliding_local_dilated__mixer_token_mlp__prompt_kernel,@function
recurrent_scan__sliding_local_dilated__mixer_token_mlp__prompt_kernel:
    s_load_dwordx2 s[8:9], s[0:1], 0
    s_load_dwordx2 s[20:21], s[0:1], 32
    s_load_dwordx2 s[12:13], s[0:1], 8
    s_load_dwordx2 s[40:41], s[0:1], 80
    s_load_dwordx2 s[28:29], s[0:1], 40
    s_cmp_ge_u32 s2, 256
    s_cbranch_scc1 L_end
    s_lshr_b32 s47, s2, 3
    v_lshrrev_b32 v2, 6, v0
    s_getpc_b64 s[74:75]
L_pc:
    s_or_b32 s74, s74, 60
    s_bitset0_b32 s74, 6
    v_lshrrev_b32 v7, 4, v0
    v_lshl_add_u32 v7, v7, 5, s47
    v_lshlrev_b32 v7, 7, v7
    v_min_u32 v6, L_last-L_pc-128, v7
    v_mov_b32 v7, 0
    v_lshl_add_u64 v[6:7], v[6:7], 0, s[74:75]
    global_load_dwordx2 v[100:101], v[6:7], off
    v_readfirstlane_b32 s3, v2
    s_and_b32 s46, s2, 7
    v_and_b32 v1, 63, v0
    s_bitcmp1_b32 s2, 0
    s_cselect_b32 s76, 12, 20
    s_cselect_b32 s77, 20, 0
    s_cmp_lt_u32 s47, s76
    s_cselect_b32 s76, 0, 108
    s_add_u32 s76, s76, s77
    s_add_u32 s76, s76, s47
    s_and_b32 s77, s2, 6
    s_lshl_b32 s77, s77, 4
    s_add_u32 s65, s76, s77
    s_and_b32 s76, s46, 1
    s_mul_i32 s75, s76, 6
    s_sub_u32 s75, 24, s75
    s_cmp_ge_u32 s47, s75
    s_cbranch_scc1 L_a0
    s_mul_i32 s74, s47, 43
    s_lshr_b32 s74, s74, 8
    s_mul_i32 s75, s74, 6
    s_sub_u32 s51, s47, s75
    s_lshr_b32 s75, s46, 1
    s_add_u32 s74, s74, s75
    s_add_u32 s77, s74, s76
    s_sub_u32 s77, s77, 4
    s_min_u32 s74, s74, s77
    s_mul_i32 s75, s75, 7
    s_lshl2_add_u32 s75, s76, s75
    s_add_u32 s50, s75, s74
    s_lshl_b32 s52, s3, 12
    s_mul_i32 s54, s3, 1835008
    s_lshl_b32 s75, s50, 7
    s_add_u32 s54, s54, s75
    s_lshl2_add_u32 s75, s51, s3
    s_mul_i32 s74, s75, 86
    s_add_u32 s75, s74, 86
    s_bfe_u32 s74, s74, 0x30008
    s_bfe_u32 s75, s75, 0x30008
    s_mul_i32 s53, s74, 114688
    s_add_u32 s53, s53, s54
    v_lshrrev_b32 v12, 3, v1
    v_lshrrev_b32 v13, 5, v1
    v_and_b32 v14, 3, v12
    v_lshl_add_u32 v13, v13, 3, v14
    v_mul_u32_u24 v13, 3584, v13
    v_and_b32 v14, 6, v12
    v_and_b32 v15, 7, v1
    v_xor_b32 v14, v14, v15
    v_lshl_add_u32 v2, v14, 4, v13
    v_add_u32 v3, 56320, v2
    v_add_u32 v4, 12288, v2
    v_add_u32 v5, 68608, v2
    v_lshrrev_b32 v12, 4, v0
    s_lshl_b32 s78, s65, 4
    v_and_b32 v13, 15, v0
    v_add_u32 v12, s78, v12
    v_cmp_gt_u32 s[78:79], 8, v13
    v_mul_u32_u24 v12, 896, v12
    v_bfrev_b32 v14, 1
    v_lshl_add_u32 v12, v13, 4, v12
    s_mov_b32 s22, 7340032
    s_mov_b32 s23, 0x20000
    v_cndmask_b32 v14, v14, v12, s[78:79]
    s_mov_b32 s10, 1835008
    s_mov_b32 s11, 0x20000
    s_waitcnt lgkmcnt(0)
    buffer_load_dwordx4 v[40:43], v12, s[8:11], 0 offen offset:0
    buffer_load_dwordx4 v[44:47], v12, s[8:11], 0 offen offset:256
    buffer_load_dwordx4 v[48:51], v12, s[8:11], 0 offen offset:512
    buffer_load_dwordx4 v[52:55], v14, s[8:11], 0 offen offset:768
    s_add_u32 m0, s52, 0
    s_nop 0
    buffer_load_dwordx4 v2, s[20:23], s53 offen lds
    buffer_load_dwordx4 v3, s[20:23], s53 offen offset:1024 lds
    buffer_load_dwordx4 v4, s[20:23], s53 offen offset:2048 lds
    buffer_load_dwordx4 v5, s[20:23], s53 offen offset:3072 lds
    s_branch L_mcont
L_a0:
    s_bfe_u32 s63, s46, 0x10001
    s_lshr_b32 s62, s46, 2
    s_mul_i32 s77, s76, 3
    s_add_u32 s77, s77, 2
    s_cmp_ge_u32 s47, 28
    s_cselect_b32 s75, 28, s75
    s_cselect_b32 s77, 2, s77
    s_cselect_b32 s64, 0, 4
    s_lshl1_add_u32 s64, s76, s64
    s_sub_u32 s75, s47, s75
    s_add_u32 s64, s64, s75
    s_cmp_lt_u32 s75, s77
    s_cselect_b32 s77, 0, s77
    s_cselect_b32 s74, 1, 0
    s_sub_u32 s64, s64, s77
    s_xor_b32 s74, s74, s62
    s_lshl1_add_u32 s62, s62, s74
    s_mov_b32 s74, 0x4152630
    s_movk_i32 s75, 0x263
    s_lshl_b32 s55, s64, 2
    s_lshr_b64 s[74:75], s[74:75], s55
    s_and_b32 s74, s74, 7
    s_lshl_b32 s55, s74, 7
    s_mul_i32 s53, s74, 172032
    s_add_u32 s54, s53, 10752
    s_and_b32 s76, s3, 1
    s_lshl_b32 s74, s76, 3
    v_lshrrev_b32 v13, 4, v1
    v_lshl_add_u32 v12, v13, 1, s74
    v_and_b32 v14, 15, v1
    v_xor_b32 v14, v14, v12
    s_and_b32 s74, s62, 1
    s_lshl_b32 s74, s74, 1
    v_subrev_u32 v14, s74, v14
    s_lshl_b32 s77, s3, 3
    v_add_u32 v13, s77, v13
    v_mul_u32_u24 v13, 2688, v13
    v_cmp_gt_u32 s[6:7], 14, v14
    v_lshl_add_u32 v13, v14, 4, v13
    s_mul_i32 s74, s62, 224
    v_add_u32 v13, s74, v13
    v_bfrev_b32 v14, 1
    s_lshl_b32 s56, s3, 10
    s_add_u32 s57, s56, 98304
    v_cndmask_b32 v2, v14, v13, s[6:7]
    s_mov_b32 s14, 1204224
    s_mov_b32 s15, 0x20000
    s_mov_b32 s10, 1835008
    s_mov_b32 s11, 0x20000
    s_waitcnt lgkmcnt(0)
    s_add_u32 m0, s56, 49152
    s_nop 0
    buffer_load_dwordx4 v2, s[12:15], s53 offen lds
    s_add_u32 m0, s56, 53248
    s_nop 0
    buffer_load_dwordx4 v2, s[12:15], s54 offen lds
    s_add_u32 m0, s56, 56448
    s_nop 0
    buffer_load_dwordx4 v2, s[12:15], s53 offen offset:896 lds
    s_add_u32 m0, s56, 60544
    s_nop 0
    buffer_load_dwordx4 v2, s[12:15], s54 offen offset:896 lds
    s_add_u32 m0, s56, 63744
    s_nop 0
    buffer_load_dwordx4 v2, s[12:15], s53 offen offset:1792 lds
    s_add_u32 m0, s56, 67840
    s_nop 0
    buffer_load_dwordx4 v2, s[12:15], s54 offen offset:1792 lds
    s_cmp_ge_u32 s47, 28
    s_cbranch_scc1 L_pure
    s_branch L_attn
L_ret:
    s_setpc_b64 s[70:71]
L_mcont:
    s_mul_i32 s55, s74, 0x11111111
    s_add_u32 s55, s55, 0x76543210
    s_and_b32 s55, s55, 0x77777777
    s_mul_i32 s58, s75, 0x11111111
    s_add_u32 s58, s58, 0x76543210
    s_or_b32 s58, s58, 0x88888888
    s_add_u32 m0, s52, 16384
    s_bfe_u32 s53, s55, 0x40004
    s_mul_i32 s53, s53, 114688
    s_add_u32 s53, s53, s54
    buffer_load_dwordx4 v2, s[20:23], s53 offen lds
    buffer_load_dwordx4 v3, s[20:23], s53 offen offset:1024 lds
    buffer_load_dwordx4 v4, s[20:23], s53 offen offset:2048 lds
    buffer_load_dwordx4 v5, s[20:23], s53 offen offset:3072 lds
    v_lshrrev_b32 v12, 4, v1
    v_lshlrev_b32 v12, 3, v12
    s_lshl_b32 s76, s50, 7
    s_lshl_b32 s75, s3, 5
    s_add_u32 s76, s76, s75
    s_mov_b32 s30, 3584
    s_mov_b32 s31, 0x20000
    buffer_load_dwordx2 v[24:25], v12, s[28:31], s76 offen
    s_load_dword s44, s[40:41], 0
    s_load_dword s45, s[40:41], 81792
    s_load_dwordx2 s[16:17], s[0:1], 16
    s_load_dwordx2 s[24:25], s[0:1], 48
    s_load_dwordx2 s[32:33], s[0:1], 56
    s_load_dwordx2 s[36:37], s[0:1], 64
    s_mov_b32 s42, 12058624
    s_mov_b32 s43, 0x20000
    s_mov_b32 s18, 401408
    s_mov_b32 s19, 0x20000
    s_mov_b32 s26, 7340032
    s_mov_b32 s27, 0x20000
    s_mov_b32 s34, 4096
    s_mov_b32 s35, 0x20000
    s_mov_b32 s38, 1835008
    s_mov_b32 s39, 0x20000
    s_mul_i32 s57, s3, 950272
    s_mul_i32 s75, s51, 10240
    s_add_u32 s57, s57, s75
    s_add_u32 s57, s57, 262144
    s_mul_i32 s75, s74, 59392
    s_add_u32 s56, s57, s75
    v_bfe_u32 v12, v1, 2, 3
    v_lshrrev_b32 v13, 5, v1
    v_lshlrev_b32 v13, 10, v13
    v_lshl_add_u32 v13, v12, 7, v13
    v_and_b32 v14, 3, v1
    v_lshl_add_u32 v13, v14, 3, v13
    v_add_u32 v13, s52, v13
    v_lshrrev_b32 v12, 1, v12
    s_add_u32 s74, s3, 0
    s_and_b32 s74, s74, 3
    v_xor_b32 v14, s74, v12
    v_lshl_add_u32 v248, v14, 5, v13
    s_add_u32 s74, s3, 1
    s_and_b32 s74, s74, 3
    v_xor_b32 v14, s74, v12
    v_lshl_add_u32 v249, v14, 5, v13
    s_add_u32 s74, s3, 2
    s_and_b32 s74, s74, 3
    v_xor_b32 v14, s74, v12
    v_lshl_add_u32 v250, v14, 5, v13
    s_add_u32 s74, s3, 3
    s_and_b32 s74, s74, 3
    v_xor_b32 v14, s74, v12
    v_lshl_add_u32 v251, v14, 5, v13
    v_mov_b32 v12, 0
    v_mov_b32 v13, 0
    v_lshlrev_b32 v14, 3, v1
    v_add_u32 v14, 122880, v14
    ds_write_b64 v14, v[12:13]
    v_lshrrev_b32 v92, 4, v0
    v_mul_u32_u24 v88, 1056, v92
    v_and_b32 v93, 15, v0
    v_lshl_add_u32 v88, v93, 4, v88
    v_add_u32 v88, 65536, v88
    v_and_b32 v94, 1, v92
    v_lshrrev_b32 v95, 1, v92
    v_lshlrev_b32 v95, 2, v95
    v_lshl_add_u32 v95, v94, 5, v95
    v_add_u32 v89, 82432, v95
    v_bfe_u32 v95, v1, 2, 2
    v_lshl_add_u32 v95, v94, 3, v95
    v_mul_u32_u24 v95, 1056, v95
    v_lshrrev_b32 v96, 5, v1
    v_lshl_add_u32 v95, v96, 5, v95
    v_and_b32 v97, 3, v1
    v_lshl_add_u32 v95, v97, 3, v95
    s_lshl_b32 s12, s3, 6
    s_add_u32 s12, s12, 65536
    v_add_u32 v90, s12, v95
    v_bfe_u32 v94, v1, 3, 2
    v_add_u32 v95, 1, v94
    v_lshrrev_b32 v95, 2, v95
    v_add_u32 v94, v94, v95
    v_and_b32 v93, 7, v1
    v_lshlrev_b32 v93, 4, v93
    v_lshl_add_u32 v93, v94, 7, v93
    v_lshl_add_u32 v93, v96, 11, v93
    s_lshl_b32 s12, s65, 24
    s_and_b32 s15, s12, 0x80000000
    v_or_b32 v91, s15, v93
    s_lshr_b32 s12, s65, 1
    s_mul_i32 s12, s12, 59392
    s_and_b32 s13, s65, 1
    s_lshl_b32 s13, s13, 10
    s_add_u32 s12, s12, s13
    s_lshl_b32 s13, s3, 12
    s_add_u32 s12, s12, s13
    s_add_u32 s12, s12, 262144
    s_mov_b32 s14, 0x3f803f80
    s_waitcnt vmcnt(12)
    v_dot2_f32_bf16 v92, v40, s14, 0
    v_dot2_f32_bf16 v93, v40, v40, 0
    v_dot2_f32_bf16 v92, v41, s14, v92
    v_dot2_f32_bf16 v93, v41, v41, v93
    v_dot2_f32_bf16 v92, v42, s14, v92
    v_dot2_f32_bf16 v93, v42, v42, v93
    v_dot2_f32_bf16 v92, v43, s14, v92
    v_dot2_f32_bf16 v93, v43, v43, v93
    s_waitcnt vmcnt(11)
    v_dot2_f32_bf16 v92, v44, s14, v92
    v_dot2_f32_bf16 v93, v44, v44, v93
    v_dot2_f32_bf16 v92, v45, s14, v92
    v_dot2_f32_bf16 v93, v45, v45, v93
    v_dot2_f32_bf16 v92, v46, s14, v92
    v_dot2_f32_bf16 v93, v46, v46, v93
    v_dot2_f32_bf16 v92, v47, s14, v92
    v_dot2_f32_bf16 v93, v47, v47, v93
    s_waitcnt vmcnt(10)
    v_dot2_f32_bf16 v92, v48, s14, v92
    v_dot2_f32_bf16 v93, v48, v48, v93
    v_dot2_f32_bf16 v92, v49, s14, v92
    v_dot2_f32_bf16 v93, v49, v49, v93
    v_dot2_f32_bf16 v92, v50, s14, v92
    v_dot2_f32_bf16 v93, v50, v50, v93
    v_dot2_f32_bf16 v92, v51, s14, v92
    v_dot2_f32_bf16 v93, v51, v51, v93
    s_waitcnt vmcnt(9)
    v_dot2_f32_bf16 v92, v52, s14, v92
    v_dot2_f32_bf16 v93, v52, v52, v93
    v_dot2_f32_bf16 v92, v53, s14, v92
    v_dot2_f32_bf16 v93, v53, v53, v93
    v_dot2_f32_bf16 v92, v54, s14, v92
    v_dot2_f32_bf16 v93, v54, v54, v93
    v_dot2_f32_bf16 v92, v55, s14, v92
    v_dot2_f32_bf16 v93, v55, v55, v93
    s_add_u32 m0, s52, 32768
    s_bfe_u32 s53, s55, 0x40008
    s_mul_i32 s53, s53, 114688
    s_add_u32 s53, s53, s54
    buffer_load_dwordx4 v2, s[20:23], s53 offen lds
    buffer_load_dwordx4 v3, s[20:23], s53 offen offset:1024 lds
    v_lshlrev_b32 v56, 16, v40
    v_and_b32 v57, 0xffff0000, v40
    v_lshlrev_b32 v58, 16, v41
    v_add_f32_dpp v92, v92, v92 quad_perm:[1,0,3,2] row_mask:0xf bank_mask:0xf
    v_add_f32_dpp v93, v93, v93 quad_perm:[1,0,3,2] row_mask:0xf bank_mask:0xf
    v_and_b32 v59, 0xffff0000, v41
    v_add_f32_dpp v92, v92, v92 quad_perm:[2,3,0,1] row_mask:0xf bank_mask:0xf
    v_add_f32_dpp v93, v93, v93 quad_perm:[2,3,0,1] row_mask:0xf bank_mask:0xf
    v_lshlrev_b32 v60, 16, v42
    v_add_f32_dpp v92, v92, v92 row_half_mirror row_mask:0xf bank_mask:0xf
    v_add_f32_dpp v93, v93, v93 row_half_mirror row_mask:0xf bank_mask:0xf
    v_and_b32 v61, 0xffff0000, v42
    v_add_f32_dpp v92, v92, v92 row_mirror row_mask:0xf bank_mask:0xf
    v_add_f32_dpp v93, v93, v93 row_mirror row_mask:0xf bank_mask:0xf
    v_lshlrev_b32 v62, 16, v43
    v_mul_f32 v92, 0x3b124925, v92
    v_mul_f32 v93, 0x3b124925, v93
    v_fma_f32 v93, -v92, v92, v93
    v_max_f32 v93, 0, v93
    v_add_f32 v94, 0x3727c5ac, v93
    v_rsq_f32 v94, v94
    v_and_b32 v63, 0xffff0000, v43
    v_lshlrev_b32 v64, 16, v44
    v_mul_f32 v95, v94, v94
    v_mov_b32 v96, 0x3727c5ac
    v_fmac_f32 v96, v93, v95
    v_rsq_f32 v96, v96
    v_sub_f32 v95, 0, v92
    buffer_load_dwordx4 v4, s[20:23], s53 offen offset:2048 lds
    buffer_load_dwordx4 v5, s[20:23], s53 offen offset:3072 lds
    v_and_b32 v65, 0xffff0000, v44
    v_lshlrev_b32 v66, 16, v45
    v_mul_f32 v98, v94, v96
    v_mul_f32 v99, v95, v98
    ds_write2_b32 v89, v94, v95 offset1:16
    v_pk_fma_f32 v[56:57], v[56:57], v[98:99], v[98:99] op_sel:[0,0,1] op_sel_hi:[1,0,1]
    v_pk_fma_f32 v[58:59], v[58:59], v[98:99], v[98:99] op_sel:[0,0,1] op_sel_hi:[1,0,1]
    v_pk_fma_f32 v[60:61], v[60:61], v[98:99], v[98:99] op_sel:[0,0,1] op_sel_hi:[1,0,1]
    v_pk_fma_f32 v[62:63], v[62:63], v[98:99], v[98:99] op_sel:[0,0,1] op_sel_hi:[1,0,1]
    v_cvt_pk_bf16_f32 v40, v56, v57
    v_cvt_pk_bf16_f32 v41, v58, v59
    v_cvt_pk_bf16_f32 v42, v60, v61
    v_cvt_pk_bf16_f32 v43, v62, v63
    ds_write_b128 v88, v[40:43] offset:0
    v_and_b32 v67, 0xffff0000, v45
    v_lshlrev_b32 v68, 16, v46
    v_and_b32 v69, 0xffff0000, v46
    v_lshlrev_b32 v70, 16, v47
    v_and_b32 v71, 0xffff0000, v47
    v_pk_fma_f32 v[64:65], v[64:65], v[98:99], v[98:99] op_sel:[0,0,1] op_sel_hi:[1,0,1]
    v_pk_fma_f32 v[66:67], v[66:67], v[98:99], v[98:99] op_sel:[0,0,1] op_sel_hi:[1,0,1]
    v_pk_fma_f32 v[68:69], v[68:69], v[98:99], v[98:99] op_sel:[0,0,1] op_sel_hi:[1,0,1]
    v_pk_fma_f32 v[70:71], v[70:71], v[98:99], v[98:99] op_sel:[0,0,1] op_sel_hi:[1,0,1]
    v_cvt_pk_bf16_f32 v44, v64, v65
    v_cvt_pk_bf16_f32 v45, v66, v67
    v_cvt_pk_bf16_f32 v46, v68, v69
    v_cvt_pk_bf16_f32 v47, v70, v71
    ds_write_b128 v88, v[44:47] offset:256
    s_add_u32 m0, s52, 49152
    s_bfe_u32 s53, s55, 0x4000c
    s_mul_i32 s53, s53, 114688
    s_add_u32 s53, s53, s54
    buffer_load_dwordx4 v2, s[20:23], s53 offen lds
    buffer_load_dwordx4 v3, s[20:23], s53 offen offset:1024 lds
    v_lshlrev_b32 v72, 16, v48
    v_and_b32 v73, 0xffff0000, v48
    v_lshlrev_b32 v74, 16, v49
    v_and_b32 v75, 0xffff0000, v49
    v_lshlrev_b32 v76, 16, v50
    v_and_b32 v77, 0xffff0000, v50
    v_lshlrev_b32 v78, 16, v51
    v_and_b32 v79, 0xffff0000, v51
    v_pk_fma_f32 v[72:73], v[72:73], v[98:99], v[98:99] op_sel:[0,0,1] op_sel_hi:[1,0,1]
    v_pk_fma_f32 v[74:75], v[74:75], v[98:99], v[98:99] op_sel:[0,0,1] op_sel_hi:[1,0,1]
    v_pk_fma_f32 v[76:77], v[76:77], v[98:99], v[98:99] op_sel:[0,0,1] op_sel_hi:[1,0,1]
    v_pk_fma_f32 v[78:79], v[78:79], v[98:99], v[98:99] op_sel:[0,0,1] op_sel_hi:[1,0,1]
    v_cvt_pk_bf16_f32 v48, v72, v73
    v_cvt_pk_bf16_f32 v49, v74, v75
    v_cvt_pk_bf16_f32 v50, v76, v77
    v_cvt_pk_bf16_f32 v51, v78, v79
    ds_write_b128 v88, v[48:51] offset:512
    v_lshlrev_b32 v80, 16, v52
    v_and_b32 v81, 0xffff0000, v52
    v_lshlrev_b32 v82, 16, v53
    v_and_b32 v83, 0xffff0000, v53
    v_lshlrev_b32 v84, 16, v54
    v_and_b32 v85, 0xffff0000, v54
    v_lshlrev_b32 v86, 16, v55
    v_and_b32 v87, 0xffff0000, v55
    v_pk_fma_f32 v[80:81], v[80:81], v[98:99], v[98:99] op_sel:[0,0,1] op_sel_hi:[1,0,1]
    v_pk_fma_f32 v[82:83], v[82:83], v[98:99], v[98:99] op_sel:[0,0,1] op_sel_hi:[1,0,1]
    v_pk_fma_f32 v[84:85], v[84:85], v[98:99], v[98:99] op_sel:[0,0,1] op_sel_hi:[1,0,1]
    v_pk_fma_f32 v[86:87], v[86:87], v[98:99], v[98:99] op_sel:[0,0,1] op_sel_hi:[1,0,1]
    v_cvt_pk_bf16_f32 v52, v80, v81
    v_cvt_pk_bf16_f32 v53, v82, v83
    v_cvt_pk_bf16_f32 v54, v84, v85
    v_cvt_pk_bf16_f32 v55, v86, v87
    ds_write_b128 v88, v[52:55] offset:768
    buffer_load_dwordx4 v4, s[20:23], s53 offen offset:2048 lds
    buffer_load_dwordx4 v5, s[20:23], s53 offen offset:3072 lds
    s_waitcnt lgkmcnt(0)
    s_barrier
    ds_read_b64_tr_b16 v[56:57], v90 offset:0
    ds_read_b64_tr_b16 v[58:59], v90 offset:4224
    ds_read_b64_tr_b16 v[60:61], v90 offset:256
    ds_read_b64_tr_b16 v[62:63], v90 offset:4480
    ds_read_b64_tr_b16 v[64:65], v90 offset:512
    ds_read_b64_tr_b16 v[66:67], v90 offset:4736
    s_cmp_ge_u32 s3, 2
    s_cbranch_scc1 L_ln3_1
    ds_read_b64_tr_b16 v[68:69], v90 offset:768
    ds_read_b64_tr_b16 v[70:71], v90 offset:4992
    v_mov_b32 v92, v91
    s_add_u32 s13, s12, 49152
    s_branch L_lnj_2
L_ln3_1:
    v_and_b32 v94, 7, v1
    v_lshlrev_b32 v93, 4, v94
    v_add_u32 v93, 82432, v93
    ds_read_b128 v[68:71], v93
    v_subrev_u32 v95, 192, v0
    v_cmp_gt_u32 vcc, 8, v95
    v_lshrrev_b32 v92, 1, v94
    v_lshlrev_b32 v92, 12, v92
    v_and_b32 v94, 1, v94
    v_lshl_add_u32 v92, v94, 4, v92
    v_or_b32 v92, s15, v92
    v_bfrev_b32 v93, 1
    s_lshl_b32 s13, s65, 5
    s_add_u32 s13, s13, 81920
    v_cndmask_b32 v92, v93, v92, vcc
L_lnj_2:
    s_mul_i32 s45, s45, 0x2c9277b5
    s_mul_i32 s44, s44, 0x9e3779b1
    s_add_u32 s45, s45, 0x5bd1e995
    s_add_u32 s44, s44, 0x7f4a7c15
    s_waitcnt lgkmcnt(4)
    buffer_store_dwordx4 v[56:59], v91, s[40:43], s12 offen sc1
    s_add_u32 s12, s12, 16384
    s_waitcnt lgkmcnt(2)
    buffer_store_dwordx4 v[60:63], v91, s[40:43], s12 offen sc1
    s_add_u32 s12, s12, 16384
    s_waitcnt lgkmcnt(0)
    buffer_store_dwordx4 v[64:67], v91, s[40:43], s12 offen sc1
    s_waitcnt lgkmcnt(0)
    buffer_store_dwordx4 v[68:71], v92, s[40:43], s13 offen sc1
    s_waitcnt vmcnt(17)
    ds_read_b64_tr_b16 a[0:1], v248 offset:0
    ds_read_b64_tr_b16 a[2:3], v248 offset:2048
    ds_read_b64_tr_b16 a[4:5], v249 offset:0
    ds_read_b64_tr_b16 a[6:7], v249 offset:2048
    ds_read_b64_tr_b16 a[8:9], v250 offset:0
    ds_read_b64_tr_b16 a[10:11], v250 offset:2048
    ds_read_b64_tr_b16 a[12:13], v251 offset:0
    ds_read_b64_tr_b16 a[14:15], v251 offset:2048
    s_waitcnt lgkmcnt(0)
    s_add_u32 m0, s52, 0
    s_bfe_u32 s53, s55, 0x40010
    s_mul_i32 s53, s53, 114688
    s_add_u32 s53, s53, s54
    buffer_load_dwordx4 v2, s[20:23], s53 offen lds
    buffer_load_dwordx4 v3, s[20:23], s53 offen offset:1024 lds
    buffer_load_dwordx4 v4, s[20:23], s53 offen offset:2048 lds
    buffer_load_dwordx4 v5, s[20:23], s53 offen offset:3072 lds
    s_waitcnt lgkmcnt(0)
    s_cmp_eq_u32 s51, 5
    s_cbranch_scc1 L_wm3_3
    s_mov_b64 exec, 0
    s_cmp_lg_u32 s3, 0
    s_cbranch_scc1 L_w_5
    s_call_b64 s[70:71], L_pad_1
L_w_5:
    s_cmp_lg_u32 s3, 1
    s_cbranch_scc1 L_w_6
    s_call_b64 s[70:71], L_pad_2
L_w_6:
    s_cmp_lg_u32 s3, 2
    s_cbranch_scc1 L_w_7
    s_call_b64 s[70:71], L_pad_4
L_w_7:
    s_cmp_lg_u32 s3, 3
    s_cbranch_scc1 L_w_8
    s_call_b64 s[70:71], L_pad_5
L_w_8:
    s_mov_b64 exec, -1
L_site_m5:
    s_branch L_wmj_4
L_wm3_3:
    s_mov_b64 exec, 0
    s_cmp_lg_u32 s3, 0
    s_cbranch_scc1 L_w_9
    s_call_b64 s[70:71], L_pad_6
L_w_9:
    s_cmp_lg_u32 s3, 1
    s_cbranch_scc1 L_w_10
    s_call_b64 s[70:71], L_pad_3
L_w_10:
    s_cmp_lg_u32 s3, 2
    s_cbranch_scc1 L_w_11
    s_call_b64 s[70:71], L_pad_4
L_w_11:
    s_cmp_lg_u32 s3, 3
    s_cbranch_scc1 L_w_12
    s_call_b64 s[70:71], L_pad_5
L_w_12:
    s_mov_b64 exec, -1
L_site_m3:
L_wmj_4:
    s_waitcnt vmcnt(17)
    ds_read_b64_tr_b16 a[16:17], v248 offset:16384
    ds_read_b64_tr_b16 a[18:19], v248 offset:18432
    ds_read_b64_tr_b16 a[20:21], v249 offset:16384
    ds_read_b64_tr_b16 a[22:23], v249 offset:18432
    ds_read_b64_tr_b16 a[24:25], v250 offset:16384
    ds_read_b64_tr_b16 a[26:27], v250 offset:18432
    ds_read_b64_tr_b16 a[28:29], v251 offset:16384
    ds_read_b64_tr_b16 a[30:31], v251 offset:18432
    s_waitcnt lgkmcnt(0)
    s_add_u32 m0, s52, 16384
    s_bfe_u32 s53, s55, 0x40014
    s_mul_i32 s53, s53, 114688
    s_add_u32 s53, s53, s54
    buffer_load_dwordx4 v2, s[20:23], s53 offen lds
    s_waitcnt vmcnt(13)
    ds_read_b64_tr_b16 a[32:33], v248 offset:32768
    ds_read_b64_tr_b16 a[34:35], v248 offset:34816
    ds_read_b64_tr_b16 a[36:37], v249 offset:32768
    ds_read_b64_tr_b16 a[38:39], v249 offset:34816
L_pad_0:
    s_cbranch_execz L_ret
    buffer_load_dwordx4 v3, s[20:23], s53 offen offset:1024 lds
    ds_read_b64_tr_b16 a[40:41], v250 offset:32768
    ds_read_b64_tr_b16 a[42:43], v250 offset:34816
    ds_read_b64_tr_b16 a[44:45], v251 offset:32768
    ds_read_b64_tr_b16 a[46:47], v251 offset:34816
    buffer_load_dwordx4 v4, s[20:23], s53 offen offset:2048 lds
    buffer_load_dwordx4 v5, s[20:23], s53 offen offset:3072 lds
    s_waitcnt lgkmcnt(0)
    s_add_u32 m0, s52, 32768
    s_bfe_u32 s53, s55, 0x40018
    s_mul_i32 s53, s53, 114688
    s_add_u32 s53, s53, s54
    buffer_load_dwordx4 v2, s[20:23], s53 offen lds
    s_waitcnt vmcnt(13)
    ds_read_b64_tr_b16 a[48:49], v248 offset:49152
    ds_read_b64_tr_b16 a[50:51], v248 offset:51200
    ds_read_b64_tr_b16 a[52:53], v249 offset:49152
    ds_read_b64_tr_b16 a[54:55], v249 offset:51200
    buffer_load_dwordx4 v3, s[20:23], s53 offen offset:1024 lds
    ds_read_b64_tr_b16 a[56:57], v250 offset:49152
    ds_read_b64_tr_b16 a[58:59], v250 offset:51200
    ds_read_b64_tr_b16 a[60:61], v251 offset:49152
    ds_read_b64_tr_b16 a[62:63], v251 offset:51200
    buffer_load_dwordx4 v4, s[20:23], s53 offen offset:2048 lds
    buffer_load_dwordx4 v5, s[20:23], s53 offen offset:3072 lds
    s_waitcnt vmcnt(12)
    s_barrier
    s_cmp_lg_u32 s3, 0
    s_cbranch_scc1 L_flag_13
    v_cmp_eq_u32 vcc, 0, v1
    v_bfrev_b32 v17, 1
    v_mov_b32 v18, s44
    v_mov_b32 v19, s45
    v_cndmask_b32 v17, v17, 0, vcc
    s_mul_i32 s65, s65, 32
    s_add_u32 s65, s65, 4096
    buffer_store_dwordx2 v[18:19], v17, s[40:43], s65 offen sc1
L_flag_13:
    v_lshlrev_b32 v10, 4, v1
    s_mov_b32 s62, -1
    s_nop 0
    s_mul_i32 s74, s3, 1024
    s_add_u32 s74, s74, 4096
    v_and_b32 v26, 31, v1
    v_mul_u32_u24 v26, 32, v26
    v_add_u32 v26, s74, v26
    s_mul_i32 s74, s47, 37
    s_lshr_b32 s74, s74, 8
    s_mul_i32 s75, s74, 7
    s_sub_u32 s49, s47, s75
    s_xor_b32 s74, s74, 0
    s_xor_b32 s48, s46, 1
    s_waitcnt lgkmcnt(0)
    s_add_u32 m0, s52, 49152
    s_bfe_u32 s53, s55, 0x4001c
    s_mul_i32 s53, s53, 114688
    s_add_u32 s53, s53, s54
    buffer_load_dwordx4 v2, s[20:23], s53 offen lds
    s_waitcnt vmcnt(9)
    ds_read_b64_tr_b16 a[64:65], v248 offset:0
    ds_read_b64_tr_b16 a[66:67], v248 offset:2048
    s_lshl_b32 s48, s48, 2
    s_add_u32 s48, s48, s74
    s_lshl_b32 s74, s74, 2
    s_lshr_b32 s74, 0x0, s74
    s_and_b32 s74, s74, 15
    s_lshl_b32 s75, s49, 2
    s_lshr_b32 s75, 0x0, s75
    s_and_b32 s75, s75, 15
    s_add_u32 s74, s74, s75
    s_sub_u32 s75, s74, 14
    s_min_u32 s74, s74, s75
    s_mul_i32 s60, s3, 1835008
    s_lshl_b32 s75, s48, 7
    s_add_u32 s60, s60, s75
    s_add_u32 s61, s60, 1835008
    buffer_load_dwordx4 v3, s[20:23], s53 offen offset:1024 lds
    ds_read_b64_tr_b16 a[68:69], v249 offset:0
    ds_read_b64_tr_b16 a[70:71], v249 offset:2048
    s_mul_i32 s75, s74, 131072
    s_add_u32 s59, s60, s75
    s_mul_i32 s67, s3, 831488
    s_lshl_b32 s75, s49, 13
    s_add_u32 s67, s67, s75
    s_add_u32 s67, s67, 4194304
    s_add_u32 s68, s67, 831488
    s_mul_i32 s75, s74, 59392
    s_add_u32 s66, s67, s75
    v_lshrrev_b32 v12, 3, v1
    v_lshrrev_b32 v13, 5, v1
    v_and_b32 v14, 3, v12
    v_lshl_add_u32 v13, v13, 3, v14
    v_mul_u32_u24 v13, 4096, v13
    buffer_load_dwordx4 v4, s[20:23], s53 offen offset:2048 lds
    ds_read_b64_tr_b16 a[72:73], v250 offset:0
    ds_read_b64_tr_b16 a[74:75], v250 offset:2048
    v_and_b32 v14, 6, v12
    v_and_b32 v15, 7, v1
    v_xor_b32 v14, v14, v15
    v_lshl_add_u32 v252, v14, 4, v13
    v_add_u32 v253, 64512, v252
    v_add_u32 v254, 14336, v252
    v_add_u32 v255, 78848, v252
    v_bfe_u32 v12, v1, 3, 2
    v_add_u32 v13, 1, v12
    v_lshrrev_b32 v13, 2, v13
    v_add_u32 v12, v12, v13
    v_and_b32 v13, 7, v1
    buffer_load_dwordx4 v5, s[20:23], s53 offen offset:3072 lds
    ds_read_b64_tr_b16 a[76:77], v251 offset:0
    ds_read_b64_tr_b16 a[78:79], v251 offset:2048
    v_lshlrev_b32 v13, 4, v13
    v_lshl_add_u32 v12, v12, 7, v13
    v_lshrrev_b32 v13, 5, v1
    v_lshl_add_u32 v234, v13, 10, v12
    v_add_u32 v235, 4096, v234
    v_lshlrev_b32 v231, 4, v1
    v_lshrrev_b32 v12, 3, v1
    v_mul_u32_u24 v13, 896, v12
    v_and_b32 v14, 6, v12
    v_and_b32 v15, 7, v1
    v_xor_b32 v14, v14, v15
    v_lshl_add_u32 v224, v14, 4, v13
    s_waitcnt lgkmcnt(0)
    s_add_u32 m0, s52, 0
    s_bfe_u32 s53, s58, 0x40000
    s_mul_i32 s53, s53, 114688
    s_add_u32 s53, s53, s54
    buffer_load_dwordx4 v2, s[20:23], s53 offen lds
    s_waitcnt vmcnt(9)
    ds_read_b64_tr_b16 a[80:81], v248 offset:16384
    ds_read_b64_tr_b16 a[82:83], v248 offset:18432
    s_mul_i32 s69, s3, 100352
    s_lshl_b32 s76, s49, 7
    s_add_u32 s69, s69, s76
    s_mul_i32 s70, s3, 14336
    s_add_u32 s70, s70, 65536
    v_and_b32 v12, 15, v1
    v_lshlrev_b32 v226, 1, v12
    s_lshl_b32 s74, s48, 2
    s_add_u32 s74, s74, s3
    s_mul_i32 s71, s74, 14336
    s_add_u32 s71, s71, s76
    s_lshl_b32 s72, s74, 5
    s_lshl_b32 s73, s74, 14
    s_add_u32 s73, s73, 7602176
    s_mul_i32 s75, s74, 79
    buffer_load_dwordx4 v3, s[20:23], s53 offen offset:1024 lds
    ds_read_b64_tr_b16 a[84:85], v249 offset:16384
    ds_read_b64_tr_b16 a[86:87], v249 offset:18432
    s_lshr_b32 s75, s75, 10
    s_min_u32 s75, s75, 4
    s_max_u32 s77, s74, 52
    s_sub_u32 s77, s77, 52
    s_mul_i32 s77, s77, 94
    s_lshr_b32 s77, s77, 10
    s_add_u32 s77, s77, s75
    v_lshrrev_b32 v12, 2, v1
    v_min_u32 v12, 13, v12
    v_and_b32 v13, 1, v12
    v_mul_u32_u24 v13, 3, v13
    s_lshl_b32 s75, s49, 2
    v_add_u32 v13, s75, v13
    buffer_load_dwordx4 v4, s[20:23], s53 offen offset:2048 lds
    ds_read_b64_tr_b16 a[88:89], v250 offset:16384
    ds_read_b64_tr_b16 a[90:91], v250 offset:18432
    v_mul_u32_u24 v13, 52, v13
    v_lshrrev_b32 v13, 8, v13
    v_lshrrev_b32 v12, 1, v12
    s_mul_i32 s75, s3, 7
    v_add_u32 v12, s75, v12
    v_mad_u32_u24 v12, v12, 6, v13
    v_mul_u32_u24 v12, 128, v12
    v_add_u32 v228, 36864, v12
    v_bfe_u32 v12, v1, 3, 3
    v_lshl_add_u32 v12, v12, 4, s77
    v_mul_u32_u24 v12, 128, v12
    v_add_u32 v229, 61440, v12
    v_bfe_u32 v12, v1, 3, 1
    buffer_load_dwordx4 v5, s[20:23], s53 offen offset:3072 lds
    ds_read_b64_tr_b16 a[92:93], v251 offset:16384
    ds_read_b64_tr_b16 a[94:95], v251 offset:18432
    v_mul_u32_u24 v12, 2162688, v12
    v_lshrrev_b32 v13, 4, v1
    v_add_u32 v14, 1, v13
    v_lshrrev_b32 v14, 2, v14
    v_add_u32 v13, v13, v14
    v_lshl_add_u32 v12, v13, 7, v12
    v_bfe_u32 v13, v1, 0, 3
    v_lshl_add_u32 v230, v13, 4, v12
    v_lshrrev_b32 v12, 2, v1
    v_lshlrev_b32 v13, 7, v12
    v_and_b32 v14, 3, v1
    v_lshl_add_u32 v13, v14, 3, v13
    s_waitcnt lgkmcnt(0)
    s_add_u32 m0, s52, 16384
    s_bfe_u32 s53, s58, 0x40004
    s_mul_i32 s53, s53, 114688
    s_add_u32 s53, s53, s54
    buffer_load_dwordx4 v2, s[20:23], s53 offen lds
    s_waitcnt vmcnt(9)
    ds_read_b64_tr_b16 a[96:97], v248 offset:32768
    ds_read_b64_tr_b16 a[98:99], v248 offset:34816
    v_add_u32 v13, 65536, v13
    v_bfe_u32 v12, v1, 3, 2
    v_xor_b32 v14, 0, v12
    v_lshl_add_u32 v244, v14, 5, v13
    v_xor_b32 v14, 1, v12
    v_lshl_add_u32 v245, v14, 5, v13
    v_xor_b32 v14, 2, v12
    v_lshl_add_u32 v246, v14, 5, v13
    v_xor_b32 v14, 3, v12
    v_lshl_add_u32 v247, v14, 5, v13
    v_add_u32 v11, 8192, v234
    s_mul_i32 s74, s3, 3072
    buffer_load_dwordx4 v3, s[20:23], s53 offen offset:1024 lds
    ds_read_b64_tr_b16 a[100:101], v249 offset:32768
    ds_read_b64_tr_b16 a[102:103], v249 offset:34816
    s_add_u32 s74, s74, 124928
    v_add_u32 v6, s74, v10
    s_sub_u32 s74, s3, 1
    s_and_b32 s74, s74, 3
    s_mul_i32 s74, s74, 3072
    s_add_u32 s74, s74, 124928
    v_add_u32 v7, s74, v10
    s_sub_u32 s74, s3, 2
    s_and_b32 s74, s74, 3
    s_mul_i32 s74, s74, 3072
    s_add_u32 s74, s74, 125952
    v_add_u32 v8, s74, v10
    s_sub_u32 s74, s3, 3
    s_and_b32 s74, s74, 3
    buffer_load_dwordx4 v4, s[20:23], s53 offen offset:2048 lds
    ds_read_b64_tr_b16 a[104:105], v250 offset:32768
    ds_read_b64_tr_b16 a[106:107], v250 offset:34816
    s_mul_i32 s74, s74, 3072
    s_add_u32 s74, s74, 126976
    v_add_u32 v9, s74, v10
    v_bfe_u32 v13, v1, 4, 1
    v_lshrrev_b32 v12, 5, v1
    v_bfe_u32 v14, v1, 3, 1
    v_lshl_add_u32 v12, v12, 1, v14
    v_add_u32 v14, 1, v12
    v_lshrrev_b32 v14, 2, v14
    v_add_u32 v12, v12, v14
    v_and_b32 v14, 7, v1
    v_lshlrev_b32 v14, 4, v14
    buffer_load_dwordx4 v5, s[20:23], s53 offen offset:3072 lds
    ds_read_b64_tr_b16 a[108:109], v251 offset:32768
    ds_read_b64_tr_b16 a[110:111], v251 offset:34816
    v_lshl_add_u32 v12, v12, 7, v14
    v_lshl_add_u32 v20, v13, 11, v12
    v_lshl_add_u32 v21, v13, 31, v12
    v_add_u32 v22, 4096, v20
    v_add_u32 v23, 8192, v21
    v_add_u32 v21, 4096, v21
    s_lshl_b32 s0, s50, 1
    s_lshr_b32 s75, s3, 1
    s_add_u32 s0, s0, s75
    s_mul_i32 s0, s0, 59392
    s_mul_i32 s75, s51, 10240
    s_add_u32 s0, s0, s75
    s_and_b32 s75, s3, 1
    s_lshl_b32 s75, s75, 10
    s_waitcnt lgkmcnt(0)
    s_add_u32 m0, s52, 32768
    s_bfe_u32 s53, s58, 0x40008
    s_mul_i32 s53, s53, 114688
    s_add_u32 s53, s53, s54
    buffer_load_dwordx4 v2, s[20:23], s53 offen lds
    s_waitcnt vmcnt(9)
    ds_read_b64_tr_b16 a[112:113], v248 offset:49152
    ds_read_b64_tr_b16 a[114:115], v248 offset:51200
    s_add_u32 s0, s0, s75
    s_add_u32 s0, s0, 4194304
    v_mov_b32 v30, 0xc0135761
    s_mov_b32 s1, 0xbdd2d3e8
    buffer_load_dwordx4 v3, s[20:23], s53 offen offset:1024 lds
    ds_read_b64_tr_b16 a[116:117], v249 offset:49152
    ds_read_b64_tr_b16 a[118:119], v249 offset:51200
    buffer_load_dwordx4 v4, s[20:23], s53 offen offset:2048 lds
    ds_read_b64_tr_b16 a[120:121], v250 offset:49152
    ds_read_b64_tr_b16 a[122:123], v250 offset:51200
    buffer_load_dwordx4 v5, s[20:23], s53 offen offset:3072 lds
    ds_read_b64_tr_b16 a[124:125], v251 offset:49152
    ds_read_b64_tr_b16 a[126:127], v251 offset:51200
    s_waitcnt lgkmcnt(0)
    s_add_u32 m0, s52, 49152
    s_bfe_u32 s53, s58, 0x4000c
    s_mul_i32 s53, s53, 114688
    s_add_u32 s53, s53, s54
    buffer_load_dwordx4 v2, s[20:23], s53 offen lds
    s_waitcnt vmcnt(9)
    ds_read_b64_tr_b16 a[128:129], v248 offset:0
    ds_read_b64_tr_b16 a[130:131], v248 offset:2048
    buffer_load_dwordx4 v3, s[20:23], s53 offen offset:1024 lds
    ds_read_b64_tr_b16 a[132:133], v249 offset:0
    ds_read_b64_tr_b16 a[134:135], v249 offset:2048
    buffer_load_dwordx4 v4, s[20:23], s53 offen offset:2048 lds
    ds_read_b64_tr_b16 a[136:137], v250 offset:0
    ds_read_b64_tr_b16 a[138:139], v250 offset:2048
    buffer_load_dwordx4 v5, s[20:23], s53 offen offset:3072 lds
    ds_read_b64_tr_b16 a[140:141], v251 offset:0
    ds_read_b64_tr_b16 a[142:143], v251 offset:2048
    s_waitcnt lgkmcnt(0)
    s_add_u32 m0, s52, 0
    s_bfe_u32 s53, s58, 0x40010
    s_mul_i32 s53, s53, 114688
    s_add_u32 s53, s53, s54
    buffer_load_dwordx4 v2, s[20:23], s53 offen lds
    s_waitcnt vmcnt(9)
    ds_read_b64_tr_b16 a[144:145], v248 offset:16384
    ds_read_b64_tr_b16 a[146:147], v248 offset:18432
    buffer_load_dwordx4 v3, s[20:23], s53 offen offset:1024 lds
    ds_read_b64_tr_b16 a[148:149], v249 offset:16384
    ds_read_b64_tr_b16 a[150:151], v249 offset:18432
    buffer_load_dwordx4 v4, s[20:23], s53 offen offset:2048 lds
    ds_read_b64_tr_b16 a[152:153], v250 offset:16384
    ds_read_b64_tr_b16 a[154:155], v250 offset:18432
    buffer_load_dwordx4 v5, s[20:23], s53 offen offset:3072 lds
    ds_read_b64_tr_b16 a[156:157], v251 offset:16384
    ds_read_b64_tr_b16 a[158:159], v251 offset:18432
    s_waitcnt lgkmcnt(0)
    s_add_u32 m0, s52, 16384
    s_bfe_u32 s53, s58, 0x40014
    s_mul_i32 s53, s53, 114688
    s_add_u32 s53, s53, s54
    buffer_load_dwordx4 v2, s[20:23], s53 offen lds
    s_waitcnt vmcnt(9)
    ds_read_b64_tr_b16 a[160:161], v248 offset:32768
    ds_read_b64_tr_b16 a[162:163], v248 offset:34816
    buffer_load_dwordx4 v3, s[20:23], s53 offen offset:1024 lds
    ds_read_b64_tr_b16 a[164:165], v249 offset:32768
    ds_read_b64_tr_b16 a[166:167], v249 offset:34816
    buffer_load_dwordx4 v4, s[20:23], s53 offen offset:2048 lds
    ds_read_b64_tr_b16 a[168:169], v250 offset:32768
    ds_read_b64_tr_b16 a[170:171], v250 offset:34816
    buffer_load_dwordx4 v5, s[20:23], s53 offen offset:3072 lds
    ds_read_b64_tr_b16 a[172:173], v251 offset:32768
    ds_read_b64_tr_b16 a[174:175], v251 offset:34816
    buffer_load_dwordx2 v[28:29], v26, s[40:43], 0 offen sc1
    s_waitcnt vmcnt(9)
    ds_read_b64_tr_b16 a[176:177], v248 offset:49152
    ds_read_b64_tr_b16 a[178:179], v248 offset:51200
    s_waitcnt lgkmcnt(2)
    s_add_u32 m0, s52, 32768
    s_bfe_u32 s53, s58, 0x40018
    s_mul_i32 s53, s53, 114688
    s_add_u32 s53, s53, s54
    buffer_load_dwordx4 v2, s[20:23], s53 offen lds
    ds_read_b64_tr_b16 a[180:181], v249 offset:49152
    ds_read_b64_tr_b16 a[182:183], v249 offset:51200
    buffer_load_dwordx4 v3, s[20:23], s53 offen offset:1024 lds
    ds_read_b64_tr_b16 a[184:185], v250 offset:49152
    ds_read_b64_tr_b16 a[186:187], v250 offset:51200
    buffer_load_dwordx4 v4, s[20:23], s53 offen offset:2048 lds
    ds_read_b64_tr_b16 a[188:189], v251 offset:49152
    ds_read_b64_tr_b16 a[190:191], v251 offset:51200
    buffer_load_dwordx4 v5, s[20:23], s53 offen offset:3072 lds
    s_waitcnt vmcnt(9)
    ds_read_b64_tr_b16 a[192:193], v248 offset:0
    ds_read_b64_tr_b16 a[194:195], v248 offset:2048
    s_waitcnt lgkmcnt(2)
    s_add_u32 m0, s52, 49152
    s_bfe_u32 s53, s58, 0x4001c
    s_mul_i32 s53, s53, 114688
    s_add_u32 s53, s53, s54
    buffer_load_dwordx4 v2, s[20:23], s53 offen lds
    ds_read_b64_tr_b16 a[196:197], v249 offset:0
    ds_read_b64_tr_b16 a[198:199], v249 offset:2048
    buffer_load_dwordx4 v3, s[20:23], s53 offen offset:1024 lds
    ds_read_b64_tr_b16 a[200:201], v250 offset:0
    ds_read_b64_tr_b16 a[202:203], v250 offset:2048
    buffer_load_dwordx4 v4, s[20:23], s53 offen offset:2048 lds
    ds_read_b64_tr_b16 a[204:205], v251 offset:0
    ds_read_b64_tr_b16 a[206:207], v251 offset:2048
L_m1go:
    s_cmp_eq_u32 s51, 5
    s_cbranch_scc1 L_m3
    buffer_load_dwordx4 v5, s[20:23], s53 offen offset:3072 lds
    s_waitcnt vmcnt(9)
    ds_read_b64_tr_b16 a[208:209], v248 offset:16384
    ds_read_b64_tr_b16 a[210:211], v248 offset:18432
    s_waitcnt vmcnt(8)
    v_cmp_ne_u64 vcc, s[44:45], v[28:29]
    s_mov_b32 s65, 0
    s_cbranch_vccz L_polled_15
L_poll_14:
    buffer_load_dwordx2 v[28:29], v26, s[40:43], 0 offen sc1
    s_waitcnt vmcnt(0)
    v_cmp_ne_u64 vcc, s[44:45], v[28:29]
    s_add_u32 s65, s65, 1
    s_cbranch_vccz L_polled_15
    s_cmp_lt_u32 s65, 200000
    s_cbranch_scc1 L_poll_14
L_polled_15:
    v_lshlrev_b32 v12, 16, v24
    v_and_b32 v13, 0xffff0000, v24
    v_lshlrev_b32 v14, 16, v25
    v_and_b32 v15, 0xffff0000, v25
    buffer_load_dwordx4 v[112:115], v234, s[40:43], s56 offen sc1
    s_bfe_u32 s56, s55, 0x40004
    s_mul_i32 s56, s56, 59392
    s_add_u32 s56, s56, s57
    ds_read_b64_tr_b16 a[212:213], v249 offset:16384
    ds_read_b64_tr_b16 a[214:215], v249 offset:18432
    buffer_load_dwordx4 v[116:119], v234, s[40:43], s56 offen sc1
    s_bfe_u32 s56, s55, 0x40008
    s_mul_i32 s56, s56, 59392
    s_add_u32 s56, s56, s57
    ds_read_b64_tr_b16 a[216:217], v250 offset:16384
    ds_read_b64_tr_b16 a[218:219], v250 offset:18432
    buffer_load_dwordx4 v[120:123], v234, s[40:43], s56 offen sc1
    s_bfe_u32 s56, s55, 0x4000c
    s_mul_i32 s56, s56, 59392
    s_add_u32 s56, s56, s57
    ds_read_b64_tr_b16 a[220:221], v251 offset:16384
    ds_read_b64_tr_b16 a[222:223], v251 offset:18432
    buffer_load_dwordx4 v[124:127], v234, s[40:43], s56 offen sc1
    s_bfe_u32 s56, s55, 0x40010
    s_mul_i32 s56, s56, 59392
    s_add_u32 s56, s56, s57
    buffer_load_dwordx4 v[128:131], v234, s[40:43], s56 offen sc1
    s_bfe_u32 s56, s55, 0x40014
    s_mul_i32 s56, s56, 59392
    s_add_u32 s56, s56, s57
    s_waitcnt vmcnt(9)
    ds_read_b64_tr_b16 a[224:225], v248 offset:32768
    ds_read_b64_tr_b16 a[226:227], v248 offset:34816
    buffer_load_dwordx4 v[132:135], v234, s[40:43], s56 offen sc1
    s_bfe_u32 s56, s55, 0x40018
    s_mul_i32 s56, s56, 59392
    s_add_u32 s56, s56, s57
    ds_read_b64_tr_b16 a[228:229], v249 offset:32768
    ds_read_b64_tr_b16 a[230:231], v249 offset:34816
    buffer_load_dwordx4 v[136:139], v234, s[40:43], s56 offen sc1
    s_bfe_u32 s56, s55, 0x4001c
    s_mul_i32 s56, s56, 59392
    s_add_u32 s56, s56, s57
    ds_read_b64_tr_b16 a[232:233], v250 offset:32768
    ds_read_b64_tr_b16 a[234:235], v250 offset:34816
    buffer_load_dwordx4 v[140:143], v234, s[40:43], s56 offen sc1
    s_bfe_u32 s56, s58, 0x40000
    s_mul_i32 s56, s56, 59392
    s_add_u32 s56, s56, s57
    ds_read_b64_tr_b16 a[236:237], v251 offset:32768
    ds_read_b64_tr_b16 a[238:239], v251 offset:34816
    buffer_load_dwordx4 v[144:147], v234, s[40:43], s56 offen sc1
    s_bfe_u32 s56, s58, 0x40004
    s_mul_i32 s56, s56, 59392
    s_add_u32 s56, s56, s57
    s_waitcnt vmcnt(9)
    ds_read_b64_tr_b16 a[240:241], v248 offset:49152
    ds_read_b64_tr_b16 a[242:243], v248 offset:51200
    buffer_load_dwordx4 v[148:151], v234, s[40:43], s56 offen sc1
    s_bfe_u32 s56, s58, 0x40008
    s_mul_i32 s56, s56, 59392
    s_add_u32 s56, s56, s57
    ds_read_b64_tr_b16 a[244:245], v249 offset:49152
    ds_read_b64_tr_b16 a[246:247], v249 offset:51200
    buffer_load_dwordx4 v[152:155], v234, s[40:43], s56 offen sc1
    s_bfe_u32 s56, s58, 0x4000c
    s_mul_i32 s56, s56, 59392
    s_add_u32 s56, s56, s57
    ds_read_b64_tr_b16 a[248:249], v250 offset:49152
    ds_read_b64_tr_b16 a[250:251], v250 offset:51200
    buffer_load_dwordx4 v[156:159], v234, s[40:43], s56 offen sc1
    ds_read_b64_tr_b16 a[252:253], v251 offset:49152
    ds_read_b64_tr_b16 a[254:255], v251 offset:51200
    s_waitcnt vmcnt(11)
    v_mfma_f32_16x16x32_bf16 v[36:39], a[4:7], v[112:115], 0
    s_bfe_u32 s56, s58, 0x40010
    v_and_b32 v29, 7, v1
    v_bfe_u32 v31, v1, 3, 1
    v_mfma_f32_16x16x32_bf16 v[40:43], a[8:11], v[112:115], 0
    s_mul_i32 s56, s56, 59392
    v_lshl_add_u32 v29, v29, 1, v31
    s_lshr_b32 s74, s52, 1
    v_mfma_f32_16x16x32_bf16 v[44:47], a[12:15], v[112:115], 0
    s_add_u32 s56, s56, s57
    s_waitcnt vmcnt(10)
    s_add_u32 s74, s74, 149504
    v_mfma_f32_16x16x32_bf16 v[32:35], a[0:3], v[112:115], v[12:15]
    buffer_load_dwordx4 v[112:115], v234, s[40:43], s56 offen sc1
    v_mfma_f32_16x16x32_bf16 v[36:39], a[20:23], v[116:119], v[36:39]
    s_bfe_u32 s56, s58, 0x40014
    v_add_u32 v18, s74, v231
    v_lshl_add_u32 v31, v29, 7, s74
    v_mfma_f32_16x16x32_bf16 v[40:43], a[24:27], v[116:119], v[40:43]
    s_mul_i32 s56, s56, 59392
    v_lshrrev_b32 v28, 4, v1
    v_bfe_u32 v16, v29, 1, 2
    v_mfma_f32_16x16x32_bf16 v[44:47], a[28:31], v[116:119], v[44:47]
    s_add_u32 s56, s56, s57
    s_waitcnt vmcnt(10)
    v_lshl_add_u32 v16, v16, 2, v28
    v_mfma_f32_16x16x32_bf16 v[32:35], a[16:19], v[116:119], v[32:35]
    buffer_load_dwordx4 v[116:119], v234, s[40:43], s56 offen sc1
    v_mfma_f32_16x16x32_bf16 v[36:39], a[36:39], v[120:123], v[36:39]
    s_bfe_u32 s56, s58, 0x40018
    v_lshl_add_u32 v16, v16, 3, v31
    v_and_b32 v19, 7, v29
    v_mfma_f32_16x16x32_bf16 v[40:43], a[40:43], v[120:123], v[40:43]
    s_mul_i32 s56, s56, 59392
    v_lshrrev_b32 v29, 3, v29
    v_lshl_or_b32 v19, v19, 1, v29
    v_mfma_f32_16x16x32_bf16 v[44:47], a[44:47], v[120:123], v[44:47]
    s_add_u32 s56, s56, s57
    s_waitcnt vmcnt(10)
    v_xor_b32 v19, v19, v28
    v_mfma_f32_16x16x32_bf16 v[32:35], a[32:35], v[120:123], v[32:35]
    buffer_load_dwordx4 v[120:123], v234, s[40:43], s56 offen sc1
    v_mfma_f32_16x16x32_bf16 v[36:39], a[52:55], v[124:127], v[36:39]
    s_bfe_u32 s56, s58, 0x4001c
    v_lshl_add_u32 v19, v19, 3, v31
    v_and_b32 v29, 8, v1
    v_mfma_f32_16x16x32_bf16 v[40:43], a[56:59], v[124:127], v[40:43]
    s_mul_i32 s56, s56, 59392
    v_lshlrev_b32 v29, 1, v29
    v_xor_b32 v225, v224, v29
    v_mfma_f32_16x16x32_bf16 v[44:47], a[60:63], v[124:127], v[44:47]
    s_add_u32 s56, s56, s57
    s_waitcnt vmcnt(10)
    v_add_u32 v24, s52, v231
    v_mfma_f32_16x16x32_bf16 v[32:35], a[48:51], v[124:127], v[32:35]
    buffer_load_dwordx4 v[124:127], v234, s[40:43], s56 offen sc1
    v_mfma_f32_16x16x32_bf16 v[36:39], a[68:71], v[128:131], v[36:39]
    s_bfe_u32 s56, s55, 0x40000
    v_and_b32 v29, 7, v1
    v_bfe_u32 v28, v1, 3, 1
    v_mfma_f32_16x16x32_bf16 v[40:43], a[72:75], v[128:131], v[40:43]
    s_mul_i32 s56, s56, 59392
    v_lshl_add_u32 v29, v29, 1, v28
    v_and_b32 v28, 48, v1
    v_mfma_f32_16x16x32_bf16 v[44:47], a[76:79], v[128:131], v[44:47]
    s_add_u32 s56, s56, s57
    s_waitcnt vmcnt(10)
    v_add_lshl_u32 v29, v29, v28, 4
    v_mfma_f32_16x16x32_bf16 v[32:35], a[64:67], v[128:131], v[32:35]
    buffer_load_dwordx4 v[128:131], v234, s[40:43], s56 offen offset:2048 sc1
    v_mfma_f32_16x16x32_bf16 v[36:39], a[84:87], v[132:135], v[36:39]
    s_bfe_u32 s56, s55, 0x40004
    s_sub_u32 s74, s3, 0
    s_and_b32 s74, s74, 3
    v_mfma_f32_16x16x32_bf16 v[40:43], a[88:91], v[132:135], v[40:43]
    s_mul_i32 s56, s56, 59392
    s_lshl_b32 s74, s74, 12
    s_add_u32 s74, s74, 0
    v_mfma_f32_16x16x32_bf16 v[44:47], a[92:95], v[132:135], v[44:47]
    s_add_u32 s56, s56, s57
    s_waitcnt vmcnt(10)
    v_add_u32 v25, s74, v29
    v_mfma_f32_16x16x32_bf16 v[32:35], a[80:83], v[132:135], v[32:35]
    buffer_load_dwordx4 v[132:135], v234, s[40:43], s56 offen offset:2048 sc1
    v_mfma_f32_16x16x32_bf16 v[36:39], a[100:103], v[136:139], v[36:39]
    s_bfe_u32 s56, s55, 0x40008
    s_sub_u32 s74, s3, 1
    s_and_b32 s74, s74, 3
    v_mfma_f32_16x16x32_bf16 v[40:43], a[104:107], v[136:139], v[40:43]
    s_mul_i32 s56, s56, 59392
    s_lshl_b32 s74, s74, 12
    s_add_u32 s74, s74, 1024
    v_mfma_f32_16x16x32_bf16 v[44:47], a[108:111], v[136:139], v[44:47]
    s_add_u32 s56, s56, s57
    s_waitcnt vmcnt(10)
    v_add_u32 v26, s74, v29
    v_mfma_f32_16x16x32_bf16 v[32:35], a[96:99], v[136:139], v[32:35]
    buffer_load_dwordx4 v[136:139], v234, s[40:43], s56 offen offset:2048 sc1
    v_mfma_f32_16x16x32_bf16 v[36:39], a[116:119], v[140:143], v[36:39]
    s_bfe_u32 s56, s55, 0x4000c
    s_sub_u32 s74, s3, 2
    s_and_b32 s74, s74, 3
    v_mfma_f32_16x16x32_bf16 v[40:43], a[120:123], v[140:143], v[40:43]
    s_mul_i32 s56, s56, 59392
    s_lshl_b32 s74, s74, 12
    s_add_u32 s74, s74, 2048
    v_mfma_f32_16x16x32_bf16 v[44:47], a[124:127], v[140:143], v[44:47]
    s_add_u32 s56, s56, s57
    s_waitcnt vmcnt(10)
    v_add_u32 v27, s74, v29
    v_mfma_f32_16x16x32_bf16 v[32:35], a[112:115], v[140:143], v[32:35]
    buffer_load_dwordx4 v[140:143], v234, s[40:43], s56 offen offset:2048 sc1
    v_mfma_f32_16x16x32_bf16 v[36:39], a[132:135], v[144:147], v[36:39]
    s_bfe_u32 s56, s55, 0x40010
    s_sub_u32 s74, s3, 3
    s_and_b32 s74, s74, 3
    v_mfma_f32_16x16x32_bf16 v[40:43], a[136:139], v[144:147], v[40:43]
    s_mul_i32 s56, s56, 59392
    s_lshl_b32 s74, s74, 12
    s_add_u32 s74, s74, 3072
    v_mfma_f32_16x16x32_bf16 v[44:47], a[140:143], v[144:147], v[44:47]
    s_add_u32 s56, s56, s57
    s_waitcnt vmcnt(10)
    v_add_u32 v28, s74, v29
    v_mfma_f32_16x16x32_bf16 v[32:35], a[128:131], v[144:147], v[32:35]
    buffer_load_dwordx4 v[144:147], v234, s[40:43], s56 offen offset:2048 sc1
    v_mfma_f32_16x16x32_bf16 v[36:39], a[148:151], v[148:151], v[36:39]
    s_bfe_u32 s56, s55, 0x40014
    s_mul_i32 s56, s56, 59392
    s_add_u32 s56, s56, s57
    v_mfma_f32_16x16x32_bf16 v[40:43], a[152:155], v[148:151], v[40:43]
    s_waitcnt vmcnt(10)
    v_mfma_f32_16x16x32_bf16 v[44:47], a[156:159], v[148:151], v[44:47]
    v_mfma_f32_16x16x32_bf16 v[32:35], a[144:147], v[148:151], v[32:35]
    buffer_load_dwordx4 v[148:151], v234, s[40:43], s56 offen offset:2048 sc1
    v_mfma_f32_16x16x32_bf16 v[36:39], a[164:167], v[152:155], v[36:39]
    s_bfe_u32 s56, s55, 0x40018
    s_mul_i32 s56, s56, 59392
    s_add_u32 s56, s56, s57
    v_mfma_f32_16x16x32_bf16 v[40:43], a[168:171], v[152:155], v[40:43]
    s_waitcnt vmcnt(10)
    v_mfma_f32_16x16x32_bf16 v[44:47], a[172:175], v[152:155], v[44:47]
    v_mfma_f32_16x16x32_bf16 v[32:35], a[160:163], v[152:155], v[32:35]
    buffer_load_dwordx4 v[152:155], v234, s[40:43], s56 offen offset:2048 sc1
    v_mfma_f32_16x16x32_bf16 v[36:39], a[180:183], v[156:159], v[36:39]
    s_bfe_u32 s56, s55, 0x4001c
    s_mul_i32 s56, s56, 59392
    s_add_u32 s56, s56, s57
    v_mfma_f32_16x16x32_bf16 v[40:43], a[184:187], v[156:159], v[40:43]
    s_waitcnt vmcnt(10)
    v_mfma_f32_16x16x32_bf16 v[44:47], a[188:191], v[156:159], v[44:47]
    v_mfma_f32_16x16x32_bf16 v[32:35], a[176:179], v[156:159], v[32:35]
    buffer_load_dwordx4 v[156:159], v234, s[40:43], s56 offen offset:2048 sc1
    s_waitcnt lgkmcnt(15)
    v_mfma_f32_16x16x32_bf16 v[36:39], a[196:199], v[112:115], v[36:39]
    s_bfe_u32 s56, s58, 0x40000
    s_mul_i32 s56, s56, 59392
    s_add_u32 s56, s56, s57
    v_mfma_f32_16x16x32_bf16 v[40:43], a[200:203], v[112:115], v[40:43]
    s_waitcnt vmcnt(10)
    v_mfma_f32_16x16x32_bf16 v[44:47], a[204:207], v[112:115], v[44:47]
L_pad_1:
    s_cbranch_execz L_ret
    v_mfma_f32_16x16x32_bf16 v[32:35], a[192:195], v[112:115], v[32:35]
    buffer_load_dwordx4 v[112:115], v234, s[40:43], s56 offen offset:2048 sc1
    v_mfma_f32_16x16x32_bf16 v[36:39], a[212:215], v[116:119], v[36:39]
    s_bfe_u32 s56, s58, 0x40004
    s_mul_i32 s56, s56, 59392
    s_add_u32 s56, s56, s57
    v_mfma_f32_16x16x32_bf16 v[40:43], a[216:219], v[116:119], v[40:43]
    s_waitcnt vmcnt(10)
    v_mfma_f32_16x16x32_bf16 v[44:47], a[220:223], v[116:119], v[44:47]
    v_mfma_f32_16x16x32_bf16 v[32:35], a[208:211], v[116:119], v[32:35]
    buffer_load_dwordx4 v[116:119], v234, s[40:43], s56 offen offset:2048 sc1
    s_waitcnt lgkmcnt(8)
    v_mfma_f32_16x16x32_bf16 v[36:39], a[228:231], v[120:123], v[36:39]
    s_bfe_u32 s56, s58, 0x40008
    s_mul_i32 s56, s56, 59392
    s_add_u32 s56, s56, s57
    v_mfma_f32_16x16x32_bf16 v[40:43], a[232:235], v[120:123], v[40:43]
    s_waitcnt vmcnt(10)
    v_mfma_f32_16x16x32_bf16 v[44:47], a[236:239], v[120:123], v[44:47]
    v_mfma_f32_16x16x32_bf16 v[32:35], a[224:227], v[120:123], v[32:35]
    buffer_load_dwordx4 v[120:123], v234, s[40:43], s56 offen offset:2048 sc1
    s_waitcnt lgkmcnt(0)
    v_mfma_f32_16x16x32_bf16 v[36:39], a[244:247], v[124:127], v[36:39]
    s_bfe_u32 s56, s58, 0x4000c
    s_mul_i32 s56, s56, 59392
    s_add_u32 s56, s56, s57
    v_mfma_f32_16x16x32_bf16 v[40:43], a[248:251], v[124:127], v[40:43]
    s_waitcnt vmcnt(10)
    v_mfma_f32_16x16x32_bf16 v[44:47], a[252:255], v[124:127], v[44:47]
    v_mfma_f32_16x16x32_bf16 v[32:35], a[240:243], v[124:127], v[32:35]
    buffer_load_dwordx4 v[124:127], v234, s[40:43], s56 offen offset:2048 sc1
    v_mfma_f32_16x16x32_bf16 v[52:55], a[4:7], v[128:131], 0
    s_bfe_u32 s56, s58, 0x40010
    s_mul_i32 s56, s56, 59392
    s_add_u32 s56, s56, s57
    v_mfma_f32_16x16x32_bf16 v[56:59], a[8:11], v[128:131], 0
    s_waitcnt vmcnt(10)
    v_mfma_f32_16x16x32_bf16 v[60:63], a[12:15], v[128:131], 0
    ds_write_b128 v6, v[36:39] offset:0
    v_mfma_f32_16x16x32_bf16 v[48:51], a[0:3], v[128:131], v[12:15]
    buffer_load_dwordx4 v[128:131], v234, s[40:43], s56 offen offset:2048 sc1
    v_mfma_f32_16x16x32_bf16 v[52:55], a[20:23], v[132:135], v[52:55]
    s_bfe_u32 s56, s58, 0x40014
    s_mul_i32 s56, s56, 59392
    s_add_u32 s56, s56, s57
    v_mfma_f32_16x16x32_bf16 v[56:59], a[24:27], v[132:135], v[56:59]
    ds_write_b128 v6, v[40:43] offset:1024
    v_mfma_f32_16x16x32_bf16 v[60:63], a[28:31], v[132:135], v[60:63]
    s_waitcnt vmcnt(10)
    v_mfma_f32_16x16x32_bf16 v[48:51], a[16:19], v[132:135], v[48:51]
    buffer_load_dwordx4 v[132:135], v234, s[40:43], s56 offen offset:2048 sc1
    v_mfma_f32_16x16x32_bf16 v[52:55], a[36:39], v[136:139], v[52:55]
    ds_write_b128 v6, v[44:47] offset:2048
    v_mfma_f32_16x16x32_bf16 v[56:59], a[40:43], v[136:139], v[56:59]
    s_bfe_u32 s56, s58, 0x40018
    s_mul_i32 s56, s56, 59392
    s_add_u32 s56, s56, s57
    v_mfma_f32_16x16x32_bf16 v[60:63], a[44:47], v[136:139], v[60:63]
    s_waitcnt vmcnt(10)
    v_mfma_f32_16x16x32_bf16 v[48:51], a[32:35], v[136:139], v[48:51]
    buffer_load_dwordx4 v[136:139], v234, s[40:43], s56 offen offset:2048 sc1
    v_mfma_f32_16x16x32_bf16 v[52:55], a[52:55], v[140:143], v[52:55]
    s_bfe_u32 s56, s58, 0x4001c
    s_mul_i32 s56, s56, 59392
    s_add_u32 s56, s56, s57
    v_mfma_f32_16x16x32_bf16 v[56:59], a[56:59], v[140:143], v[56:59]
    s_waitcnt lgkmcnt(0)
    s_barrier
    v_mfma_f32_16x16x32_bf16 v[60:63], a[60:63], v[140:143], v[60:63]
    s_waitcnt vmcnt(10)
    ds_read_b128 v[64:67], v7 offset:0
    v_mfma_f32_16x16x32_bf16 v[48:51], a[48:51], v[140:143], v[48:51]
    buffer_load_dwordx4 v[140:143], v234, s[40:43], s56 offen offset:2048 sc1
    v_mfma_f32_16x16x32_bf16 v[52:55], a[68:71], v[144:147], v[52:55]
    s_bfe_u32 s56, s55, 0x40000
    ds_read_b128 v[68:71], v8 offset:0
    v_mfma_f32_16x16x32_bf16 v[56:59], a[72:75], v[144:147], v[56:59]
    s_mul_i32 s56, s56, 59392
    ds_read_b128 v[72:75], v9 offset:0
    v_mfma_f32_16x16x32_bf16 v[60:63], a[76:79], v[144:147], v[60:63]
    s_add_u32 s56, s56, s57
    s_waitcnt vmcnt(10)
    v_mfma_f32_16x16x32_bf16 v[48:51], a[64:67], v[144:147], v[48:51]
    buffer_load_dwordx4 v[144:147], v235, s[40:43], s56 offen sc1
    v_mfma_f32_16x16x32_bf16 v[52:55], a[84:87], v[148:151], v[52:55]
    s_bfe_u32 s56, s55, 0x40004
    s_mul_i32 s56, s56, 59392
    s_add_u32 s56, s56, s57
    v_mfma_f32_16x16x32_bf16 v[56:59], a[88:91], v[148:151], v[56:59]
    s_waitcnt vmcnt(10)
    v_mfma_f32_16x16x32_bf16 v[60:63], a[92:95], v[148:151], v[60:63]
    s_waitcnt lgkmcnt(0)
    v_add_f32 v92, v32, v64
    v_add_f32 v93, v33, v65
    v_mfma_f32_16x16x32_bf16 v[48:51], a[80:83], v[148:151], v[48:51]
    buffer_load_dwordx4 v[148:151], v235, s[40:43], s56 offen sc1
    v_mfma_f32_16x16x32_bf16 v[52:55], a[100:103], v[152:155], v[52:55]
    s_bfe_u32 s56, s55, 0x40008
    v_add_f32 v94, v34, v66
    v_add_f32 v95, v35, v67
    v_mfma_f32_16x16x32_bf16 v[56:59], a[104:107], v[152:155], v[56:59]
    s_mul_i32 s56, s56, 59392
    v_add_f32 v92, v92, v68
    v_add_f32 v93, v93, v69
    v_mfma_f32_16x16x32_bf16 v[60:63], a[108:111], v[152:155], v[60:63]
    s_add_u32 s56, s56, s57
    s_waitcnt vmcnt(10)
    v_add_f32 v94, v94, v70
    v_mfma_f32_16x16x32_bf16 v[48:51], a[96:99], v[152:155], v[48:51]
    buffer_load_dwordx4 v[152:155], v235, s[40:43], s56 offen sc1
    v_mfma_f32_16x16x32_bf16 v[52:55], a[116:119], v[156:159], v[52:55]
    s_bfe_u32 s56, s55, 0x4000c
    v_add_f32 v95, v95, v71
    v_add_f32 v92, v92, v72
    v_mfma_f32_16x16x32_bf16 v[56:59], a[120:123], v[156:159], v[56:59]
    s_mul_i32 s56, s56, 59392
    v_add_f32 v93, v93, v73
    v_add_f32 v94, v94, v74
    v_mfma_f32_16x16x32_bf16 v[60:63], a[124:127], v[156:159], v[60:63]
    s_add_u32 s56, s56, s57
    s_waitcnt vmcnt(10)
    v_add_f32 v95, v95, v75
    v_mfma_f32_16x16x32_bf16 v[48:51], a[112:115], v[156:159], v[48:51]
    buffer_load_dwordx4 v[156:159], v235, s[40:43], s56 offen sc1
    v_mfma_f32_16x16x32_bf16 v[52:55], a[132:135], v[112:115], v[52:55]
    s_bfe_u32 s56, s55, 0x40010
    v_mul_f32 v76, v92, v92
    v_mul_f32 v77, v93, v93
    v_mfma_f32_16x16x32_bf16 v[56:59], a[136:139], v[112:115], v[56:59]
    s_mul_i32 s56, s56, 59392
    v_mul_f32 v78, v94, v94
    v_mul_f32 v79, v95, v95
    v_mfma_f32_16x16x32_bf16 v[60:63], a[140:143], v[112:115], v[60:63]
    s_add_u32 s56, s56, s57
    s_waitcnt vmcnt(10)
    v_fma_f32 v76, v76, s1, v30
    v_mfma_f32_16x16x32_bf16 v[48:51], a[128:131], v[112:115], v[48:51]
    buffer_load_dwordx4 v[112:115], v235, s[40:43], s56 offen sc1
    v_mfma_f32_16x16x32_bf16 v[52:55], a[148:151], v[116:119], v[52:55]
    s_bfe_u32 s56, s55, 0x40014
    v_fma_f32 v77, v77, s1, v30
    v_fma_f32 v78, v78, s1, v30
    v_mfma_f32_16x16x32_bf16 v[56:59], a[152:155], v[116:119], v[56:59]
    s_mul_i32 s56, s56, 59392
    v_fma_f32 v79, v79, s1, v30
    v_mul_f32 v76, v76, v92
    v_mfma_f32_16x16x32_bf16 v[60:63], a[156:159], v[116:119], v[60:63]
    s_add_u32 s56, s56, s57
    s_waitcnt vmcnt(10)
    v_mul_f32 v77, v77, v93
    v_mfma_f32_16x16x32_bf16 v[48:51], a[144:147], v[116:119], v[48:51]
    buffer_load_dwordx4 v[116:119], v235, s[40:43], s56 offen sc1
    v_mfma_f32_16x16x32_bf16 v[52:55], a[164:167], v[120:123], v[52:55]
    s_bfe_u32 s56, s55, 0x40018
    v_mul_f32 v78, v78, v94
    v_mul_f32 v79, v79, v95
    v_mfma_f32_16x16x32_bf16 v[56:59], a[168:171], v[120:123], v[56:59]
    s_mul_i32 s56, s56, 59392
    v_exp_f32 v76, v76
    v_mfma_f32_16x16x32_bf16 v[60:63], a[172:175], v[120:123], v[60:63]
    s_add_u32 s56, s56, s57
    s_waitcnt vmcnt(10)
    v_mfma_f32_16x16x32_bf16 v[48:51], a[160:163], v[120:123], v[48:51]
    buffer_load_dwordx4 v[120:123], v235, s[40:43], s56 offen sc1
    v_mfma_f32_16x16x32_bf16 v[52:55], a[180:183], v[124:127], v[52:55]
    s_bfe_u32 s56, s55, 0x4001c
    v_exp_f32 v77, v77
    v_mfma_f32_16x16x32_bf16 v[56:59], a[184:187], v[124:127], v[56:59]
    s_mul_i32 s56, s56, 59392
    v_exp_f32 v78, v78
    v_mfma_f32_16x16x32_bf16 v[60:63], a[188:191], v[124:127], v[60:63]
    s_add_u32 s56, s56, s57
    s_waitcnt vmcnt(10)
    v_mfma_f32_16x16x32_bf16 v[48:51], a[176:179], v[124:127], v[48:51]
    buffer_load_dwordx4 v[124:127], v235, s[40:43], s56 offen sc1
    v_mfma_f32_16x16x32_bf16 v[52:55], a[196:199], v[128:131], v[52:55]
    s_bfe_u32 s56, s58, 0x40000
    v_exp_f32 v79, v79
    v_mfma_f32_16x16x32_bf16 v[56:59], a[200:203], v[128:131], v[56:59]
    s_mul_i32 s56, s56, 59392
    v_add_f32 v76, 1.0, v76
    v_add_f32 v77, 1.0, v77
    v_mfma_f32_16x16x32_bf16 v[60:63], a[204:207], v[128:131], v[60:63]
    s_add_u32 s56, s56, s57
    s_waitcnt vmcnt(10)
    v_add_f32 v78, 1.0, v78
    v_mfma_f32_16x16x32_bf16 v[48:51], a[192:195], v[128:131], v[48:51]
    buffer_load_dwordx4 v[128:131], v235, s[40:43], s56 offen sc1
    v_mfma_f32_16x16x32_bf16 v[52:55], a[212:215], v[132:135], v[52:55]
    s_bfe_u32 s56, s58, 0x40004
    v_add_f32 v79, 1.0, v79
    s_mul_i32 s56, s56, 59392
    v_mfma_f32_16x16x32_bf16 v[56:59], a[216:219], v[132:135], v[56:59]
    s_add_u32 s56, s56, s57
    v_rcp_f32 v76, v76
    v_mfma_f32_16x16x32_bf16 v[60:63], a[220:223], v[132:135], v[60:63]
    s_waitcnt vmcnt(10)
    v_rcp_f32 v77, v77
    v_mfma_f32_16x16x32_bf16 v[48:51], a[208:211], v[132:135], v[48:51]
    buffer_load_dwordx4 v[132:135], v235, s[40:43], s56 offen sc1
    v_mfma_f32_16x16x32_bf16 v[52:55], a[228:231], v[136:139], v[52:55]
    s_bfe_u32 s56, s58, 0x40008
    v_rcp_f32 v78, v78
    v_mfma_f32_16x16x32_bf16 v[56:59], a[232:235], v[136:139], v[56:59]
    s_mul_i32 s56, s56, 59392
    v_rcp_f32 v79, v79
    v_mfma_f32_16x16x32_bf16 v[60:63], a[236:239], v[136:139], v[60:63]
    s_add_u32 s56, s56, s57
    s_waitcnt vmcnt(10)
    v_mul_f32 v76, v76, v92
    v_mfma_f32_16x16x32_bf16 v[48:51], a[224:227], v[136:139], v[48:51]
    buffer_load_dwordx4 v[136:139], v235, s[40:43], s56 offen sc1
    v_mfma_f32_16x16x32_bf16 v[52:55], a[244:247], v[140:143], v[52:55]
    s_bfe_u32 s56, s58, 0x4000c
    v_mul_f32 v77, v77, v93
    v_mul_f32 v78, v78, v94
    v_mfma_f32_16x16x32_bf16 v[56:59], a[248:251], v[140:143], v[56:59]
    s_mul_i32 s56, s56, 59392
    v_mul_f32 v79, v79, v95
    v_cvt_pk_bf16_f32 v80, v76, v77
    v_mfma_f32_16x16x32_bf16 v[60:63], a[252:255], v[140:143], v[60:63]
    s_add_u32 s56, s56, s57
    s_waitcnt vmcnt(10)
    v_cvt_pk_bf16_f32 v81, v78, v79
    v_mfma_f32_16x16x32_bf16 v[48:51], a[240:243], v[140:143], v[48:51]
    buffer_load_dwordx4 v[140:143], v235, s[40:43], s56 offen sc1
    v_mfma_f32_16x16x32_bf16 v[36:39], a[4:7], v[144:147], 0
    s_bfe_u32 s56, s58, 0x40010
    s_mul_i32 s56, s56, 59392
    s_add_u32 s56, s56, s57
    v_mfma_f32_16x16x32_bf16 v[40:43], a[8:11], v[144:147], 0
    s_waitcnt vmcnt(10)
    v_mfma_f32_16x16x32_bf16 v[44:47], a[12:15], v[144:147], 0
    ds_write_b128 v6, v[52:55] offset:12288
    v_mfma_f32_16x16x32_bf16 v[32:35], a[0:3], v[144:147], v[12:15]
    buffer_load_dwordx4 v[144:147], v235, s[40:43], s56 offen sc1
    v_mfma_f32_16x16x32_bf16 v[36:39], a[20:23], v[148:151], v[36:39]
    s_bfe_u32 s56, s58, 0x40014
    s_mul_i32 s56, s56, 59392
    s_add_u32 s56, s56, s57
    v_mfma_f32_16x16x32_bf16 v[40:43], a[24:27], v[148:151], v[40:43]
    ds_write_b128 v6, v[56:59] offset:13312
    v_mfma_f32_16x16x32_bf16 v[44:47], a[28:31], v[148:151], v[44:47]
    s_waitcnt vmcnt(10)
    v_mfma_f32_16x16x32_bf16 v[32:35], a[16:19], v[148:151], v[32:35]
    buffer_load_dwordx4 v[148:151], v235, s[40:43], s56 offen sc1
    v_mfma_f32_16x16x32_bf16 v[36:39], a[36:39], v[152:155], v[36:39]
    ds_write_b128 v6, v[60:63] offset:14336
    v_mfma_f32_16x16x32_bf16 v[40:43], a[40:43], v[152:155], v[40:43]
    s_bfe_u32 s56, s58, 0x40018
    s_mul_i32 s56, s56, 59392
    s_add_u32 s56, s56, s57
    v_mfma_f32_16x16x32_bf16 v[44:47], a[44:47], v[152:155], v[44:47]
    s_waitcnt vmcnt(10)
    v_mfma_f32_16x16x32_bf16 v[32:35], a[32:35], v[152:155], v[32:35]
    buffer_load_dwordx4 v[152:155], v235, s[40:43], s56 offen sc1
    v_mfma_f32_16x16x32_bf16 v[36:39], a[52:55], v[156:159], v[36:39]
    s_bfe_u32 s56, s58, 0x4001c
    s_mul_i32 s56, s56, 59392
    s_add_u32 s56, s56, s57
    v_mfma_f32_16x16x32_bf16 v[40:43], a[56:59], v[156:159], v[40:43]
    s_waitcnt lgkmcnt(0)
    s_barrier
    v_mfma_f32_16x16x32_bf16 v[44:47], a[60:63], v[156:159], v[44:47]
    s_waitcnt vmcnt(10)
    ds_read_b128 v[64:67], v7 offset:12288
    v_mfma_f32_16x16x32_bf16 v[32:35], a[48:51], v[156:159], v[32:35]
    buffer_load_dwordx4 v[156:159], v235, s[40:43], s56 offen sc1
    v_mfma_f32_16x16x32_bf16 v[36:39], a[68:71], v[112:115], v[36:39]
    s_bfe_u32 s56, s55, 0x40000
    ds_read_b128 v[68:71], v8 offset:12288
    v_mfma_f32_16x16x32_bf16 v[40:43], a[72:75], v[112:115], v[40:43]
    s_mul_i32 s56, s56, 59392
    ds_read_b128 v[72:75], v9 offset:12288
    v_mfma_f32_16x16x32_bf16 v[44:47], a[76:79], v[112:115], v[44:47]
    s_add_u32 s56, s56, s57
    s_waitcnt vmcnt(10)
    v_mfma_f32_16x16x32_bf16 v[32:35], a[64:67], v[112:115], v[32:35]
    buffer_load_dwordx4 v[112:115], v235, s[40:43], s56 offen offset:2048 sc1
    v_mfma_f32_16x16x32_bf16 v[36:39], a[84:87], v[116:119], v[36:39]
    s_bfe_u32 s56, s55, 0x40004
    s_mul_i32 s56, s56, 59392
    s_add_u32 s56, s56, s57
    v_mfma_f32_16x16x32_bf16 v[40:43], a[88:91], v[116:119], v[40:43]
    s_waitcnt vmcnt(10)
    v_mfma_f32_16x16x32_bf16 v[44:47], a[92:95], v[116:119], v[44:47]
    s_waitcnt lgkmcnt(0)
    v_add_f32 v96, v48, v64
    v_add_f32 v97, v49, v65
    v_mfma_f32_16x16x32_bf16 v[32:35], a[80:83], v[116:119], v[32:35]
    buffer_load_dwordx4 v[116:119], v235, s[40:43], s56 offen offset:2048 sc1
    v_mfma_f32_16x16x32_bf16 v[36:39], a[100:103], v[120:123], v[36:39]
    s_bfe_u32 s56, s55, 0x40008
    v_add_f32 v98, v50, v66
    v_add_f32 v99, v51, v67
    v_mfma_f32_16x16x32_bf16 v[40:43], a[104:107], v[120:123], v[40:43]
    s_mul_i32 s56, s56, 59392
    v_add_f32 v96, v96, v68
    v_add_f32 v97, v97, v69
    v_mfma_f32_16x16x32_bf16 v[44:47], a[108:111], v[120:123], v[44:47]
    s_add_u32 s56, s56, s57
    s_waitcnt vmcnt(10)
    v_add_f32 v98, v98, v70
    v_mfma_f32_16x16x32_bf16 v[32:35], a[96:99], v[120:123], v[32:35]
    buffer_load_dwordx4 v[120:123], v235, s[40:43], s56 offen offset:2048 sc1
    v_mfma_f32_16x16x32_bf16 v[36:39], a[116:119], v[124:127], v[36:39]
    s_bfe_u32 s56, s55, 0x4000c
    v_add_f32 v99, v99, v71
    v_add_f32 v96, v96, v72
    v_mfma_f32_16x16x32_bf16 v[40:43], a[120:123], v[124:127], v[40:43]
    s_mul_i32 s56, s56, 59392
    v_add_f32 v97, v97, v73
    v_add_f32 v98, v98, v74
    v_mfma_f32_16x16x32_bf16 v[44:47], a[124:127], v[124:127], v[44:47]
    s_add_u32 s56, s56, s57
    s_waitcnt vmcnt(10)
    v_add_f32 v99, v99, v75
    v_mfma_f32_16x16x32_bf16 v[32:35], a[112:115], v[124:127], v[32:35]
    buffer_load_dwordx4 v[124:127], v235, s[40:43], s56 offen offset:2048 sc1
    v_mfma_f32_16x16x32_bf16 v[36:39], a[132:135], v[128:131], v[36:39]
    s_bfe_u32 s56, s55, 0x40010
    v_mul_f32 v76, v96, v96
    v_mul_f32 v77, v97, v97
    v_mfma_f32_16x16x32_bf16 v[40:43], a[136:139], v[128:131], v[40:43]
    s_mul_i32 s56, s56, 59392
    v_mul_f32 v78, v98, v98
    v_mul_f32 v79, v99, v99
    v_mfma_f32_16x16x32_bf16 v[44:47], a[140:143], v[128:131], v[44:47]
    s_add_u32 s56, s56, s57
    s_waitcnt vmcnt(10)
    v_fma_f32 v76, v76, s1, v30
    v_mfma_f32_16x16x32_bf16 v[32:35], a[128:131], v[128:131], v[32:35]
    buffer_load_dwordx4 v[128:131], v235, s[40:43], s56 offen offset:2048 sc1
    v_mfma_f32_16x16x32_bf16 v[36:39], a[148:151], v[132:135], v[36:39]
    s_bfe_u32 s56, s55, 0x40014
    v_fma_f32 v77, v77, s1, v30
    v_fma_f32 v78, v78, s1, v30
    v_mfma_f32_16x16x32_bf16 v[40:43], a[152:155], v[132:135], v[40:43]
    s_mul_i32 s56, s56, 59392
    v_fma_f32 v79, v79, s1, v30
    v_mul_f32 v76, v76, v96
    v_mfma_f32_16x16x32_bf16 v[44:47], a[156:159], v[132:135], v[44:47]
    s_add_u32 s56, s56, s57
    s_waitcnt vmcnt(10)
    v_mul_f32 v77, v77, v97
    v_mfma_f32_16x16x32_bf16 v[32:35], a[144:147], v[132:135], v[32:35]
    buffer_load_dwordx4 v[132:135], v235, s[40:43], s56 offen offset:2048 sc1
    v_mfma_f32_16x16x32_bf16 v[36:39], a[164:167], v[136:139], v[36:39]
    s_bfe_u32 s56, s55, 0x40018
    v_mul_f32 v78, v78, v98
    v_mul_f32 v79, v79, v99
    v_mfma_f32_16x16x32_bf16 v[40:43], a[168:171], v[136:139], v[40:43]
    s_mul_i32 s56, s56, 59392
    v_exp_f32 v76, v76
    v_mfma_f32_16x16x32_bf16 v[44:47], a[172:175], v[136:139], v[44:47]
    s_add_u32 s56, s56, s57
    s_waitcnt vmcnt(10)
    v_mfma_f32_16x16x32_bf16 v[32:35], a[160:163], v[136:139], v[32:35]
    buffer_load_dwordx4 v[136:139], v235, s[40:43], s56 offen offset:2048 sc1
    v_mfma_f32_16x16x32_bf16 v[36:39], a[180:183], v[140:143], v[36:39]
    s_bfe_u32 s56, s55, 0x4001c
    v_exp_f32 v77, v77
    v_mfma_f32_16x16x32_bf16 v[40:43], a[184:187], v[140:143], v[40:43]
    s_mul_i32 s56, s56, 59392
    v_exp_f32 v78, v78
    v_mfma_f32_16x16x32_bf16 v[44:47], a[188:191], v[140:143], v[44:47]
    s_add_u32 s56, s56, s57
    s_waitcnt vmcnt(10)
    v_mfma_f32_16x16x32_bf16 v[32:35], a[176:179], v[140:143], v[32:35]
    buffer_load_dwordx4 v[140:143], v235, s[40:43], s56 offen offset:2048 sc1
    v_mfma_f32_16x16x32_bf16 v[36:39], a[196:199], v[144:147], v[36:39]
    s_bfe_u32 s56, s58, 0x40000
    v_exp_f32 v79, v79
    v_mfma_f32_16x16x32_bf16 v[40:43], a[200:203], v[144:147], v[40:43]
    s_mul_i32 s56, s56, 59392
    v_add_f32 v76, 1.0, v76
    v_add_f32 v77, 1.0, v77
    v_mfma_f32_16x16x32_bf16 v[44:47], a[204:207], v[144:147], v[44:47]
    s_add_u32 s56, s56, s57
    s_waitcnt vmcnt(10)
    v_add_f32 v78, 1.0, v78
    v_mfma_f32_16x16x32_bf16 v[32:35], a[192:195], v[144:147], v[32:35]
    buffer_load_dwordx4 v[144:147], v235, s[40:43], s56 offen offset:2048 sc1
    v_mfma_f32_16x16x32_bf16 v[36:39], a[212:215], v[148:151], v[36:39]
    s_bfe_u32 s56, s58, 0x40004
    v_add_f32 v79, 1.0, v79
    s_mul_i32 s56, s56, 59392
    v_mfma_f32_16x16x32_bf16 v[40:43], a[216:219], v[148:151], v[40:43]
    s_add_u32 s56, s56, s57
    v_rcp_f32 v76, v76
    v_mfma_f32_16x16x32_bf16 v[44:47], a[220:223], v[148:151], v[44:47]
    s_waitcnt vmcnt(10)
    v_rcp_f32 v77, v77
    v_mfma_f32_16x16x32_bf16 v[32:35], a[208:211], v[148:151], v[32:35]
    buffer_load_dwordx4 v[148:151], v235, s[40:43], s56 offen offset:2048 sc1
    v_mfma_f32_16x16x32_bf16 v[36:39], a[228:231], v[152:155], v[36:39]
    s_bfe_u32 s56, s58, 0x40008
    v_rcp_f32 v78, v78
    v_mfma_f32_16x16x32_bf16 v[40:43], a[232:235], v[152:155], v[40:43]
    s_mul_i32 s56, s56, 59392
    v_rcp_f32 v79, v79
    v_mfma_f32_16x16x32_bf16 v[44:47], a[236:239], v[152:155], v[44:47]
    s_add_u32 s56, s56, s57
    s_waitcnt vmcnt(10)
    v_mul_f32 v76, v76, v96
    v_mfma_f32_16x16x32_bf16 v[32:35], a[224:227], v[152:155], v[32:35]
    buffer_load_dwordx4 v[152:155], v235, s[40:43], s56 offen offset:2048 sc1
    v_mfma_f32_16x16x32_bf16 v[36:39], a[244:247], v[156:159], v[36:39]
    s_bfe_u32 s56, s58, 0x4000c
    v_mul_f32 v77, v77, v97
    v_mul_f32 v78, v78, v98
    v_mfma_f32_16x16x32_bf16 v[40:43], a[248:251], v[156:159], v[40:43]
    s_mul_i32 s56, s56, 59392
    v_mul_f32 v79, v79, v99
    v_cvt_pk_bf16_f32 v82, v76, v77
    v_mfma_f32_16x16x32_bf16 v[44:47], a[252:255], v[156:159], v[44:47]
    s_add_u32 s56, s56, s57
    s_waitcnt vmcnt(10)
    v_cvt_pk_bf16_f32 v83, v78, v79
    v_mfma_f32_16x16x32_bf16 v[32:35], a[240:243], v[156:159], v[32:35]
    buffer_load_dwordx4 v[156:159], v235, s[40:43], s56 offen offset:2048 sc1
    v_mfma_f32_16x16x32_bf16 v[52:55], a[4:7], v[112:115], 0
    s_bfe_u32 s56, s58, 0x40010
    v_permlane16_swap_b32 v80, v82
    v_mfma_f32_16x16x32_bf16 v[56:59], a[8:11], v[112:115], 0
    s_mul_i32 s56, s56, 59392
    v_permlane16_swap_b32 v81, v83
    v_mfma_f32_16x16x32_bf16 v[60:63], a[12:15], v[112:115], 0
    s_add_u32 s56, s56, s57
    s_waitcnt vmcnt(10)
    v_mfma_f32_16x16x32_bf16 v[48:51], a[0:3], v[112:115], v[12:15]
    buffer_load_dwordx4 v[112:115], v235, s[40:43], s56 offen offset:2048 sc1
    v_mfma_f32_16x16x32_bf16 v[52:55], a[20:23], v[116:119], v[52:55]
    ds_write_b128 v6, v[36:39] offset:0
    v_mfma_f32_16x16x32_bf16 v[56:59], a[24:27], v[116:119], v[56:59]
    s_bfe_u32 s56, s58, 0x40014
    s_mul_i32 s56, s56, 59392
    s_add_u32 s56, s56, s57
    v_mfma_f32_16x16x32_bf16 v[60:63], a[28:31], v[116:119], v[60:63]
    s_waitcnt vmcnt(10)
    v_mfma_f32_16x16x32_bf16 v[48:51], a[16:19], v[116:119], v[48:51]
    buffer_load_dwordx4 v[116:119], v235, s[40:43], s56 offen offset:2048 sc1
    v_mfma_f32_16x16x32_bf16 v[52:55], a[36:39], v[120:123], v[52:55]
    ds_write_b128 v6, v[40:43] offset:1024
    v_mfma_f32_16x16x32_bf16 v[56:59], a[40:43], v[120:123], v[56:59]
    s_bfe_u32 s56, s58, 0x40018
    s_mul_i32 s56, s56, 59392
    s_add_u32 s56, s56, s57
    v_mfma_f32_16x16x32_bf16 v[60:63], a[44:47], v[120:123], v[60:63]
    s_waitcnt vmcnt(10)
    v_mfma_f32_16x16x32_bf16 v[48:51], a[32:35], v[120:123], v[48:51]
    buffer_load_dwordx4 v[120:123], v235, s[40:43], s56 offen offset:2048 sc1
    v_mfma_f32_16x16x32_bf16 v[52:55], a[52:55], v[124:127], v[52:55]
    ds_write_b128 v6, v[44:47] offset:2048
    v_mfma_f32_16x16x32_bf16 v[56:59], a[56:59], v[124:127], v[56:59]
    s_bfe_u32 s56, s58, 0x4001c
    s_mul_i32 s56, s56, 59392
    s_add_u32 s56, s56, s57
    v_mfma_f32_16x16x32_bf16 v[60:63], a[60:63], v[124:127], v[60:63]
    s_waitcnt vmcnt(10)
    v_mfma_f32_16x16x32_bf16 v[48:51], a[48:51], v[124:127], v[48:51]
    buffer_load_dwordx4 v[124:127], v235, s[40:43], s56 offen offset:2048 sc1
    v_mfma_f32_16x16x32_bf16 v[52:55], a[68:71], v[128:131], v[52:55]
    s_bfe_u32 s56, s55, 0x40000
    s_mul_i32 s56, s56, 59392
    s_add_u32 s56, s56, s57
    v_mfma_f32_16x16x32_bf16 v[56:59], a[72:75], v[128:131], v[56:59]
    s_waitcnt lgkmcnt(0)
    s_barrier
    v_mfma_f32_16x16x32_bf16 v[60:63], a[76:79], v[128:131], v[60:63]
    s_waitcnt vmcnt(10)
    ds_read_b128 v[64:67], v7 offset:0
    v_mfma_f32_16x16x32_bf16 v[48:51], a[64:67], v[128:131], v[48:51]
    buffer_load_dwordx4 v[128:131], v11, s[40:43], s56 offen sc1
    v_mfma_f32_16x16x32_bf16 v[52:55], a[84:87], v[132:135], v[52:55]
    s_bfe_u32 s56, s55, 0x40004
    ds_read_b128 v[68:71], v8 offset:0
    v_mfma_f32_16x16x32_bf16 v[56:59], a[88:91], v[132:135], v[56:59]
    s_mul_i32 s56, s56, 59392
    ds_read_b128 v[72:75], v9 offset:0
    v_mfma_f32_16x16x32_bf16 v[60:63], a[92:95], v[132:135], v[60:63]
    s_add_u32 s56, s56, s57
    s_waitcnt vmcnt(10)
    v_mfma_f32_16x16x32_bf16 v[48:51], a[80:83], v[132:135], v[48:51]
    buffer_load_dwordx4 v[132:135], v11, s[40:43], s56 offen sc1
    v_mfma_f32_16x16x32_bf16 v[52:55], a[100:103], v[136:139], v[52:55]
    s_bfe_u32 s56, s55, 0x40008
    s_mul_i32 s56, s56, 59392
    s_add_u32 s56, s56, s57
    v_mfma_f32_16x16x32_bf16 v[56:59], a[104:107], v[136:139], v[56:59]
    s_waitcnt vmcnt(10)
    v_mfma_f32_16x16x32_bf16 v[60:63], a[108:111], v[136:139], v[60:63]
    s_waitcnt lgkmcnt(0)
    v_add_f32 v92, v32, v64
    v_add_f32 v93, v33, v65
    v_mfma_f32_16x16x32_bf16 v[48:51], a[96:99], v[136:139], v[48:51]
    buffer_load_dwordx4 v[136:139], v11, s[40:43], s56 offen sc1
    v_mfma_f32_16x16x32_bf16 v[52:55], a[116:119], v[140:143], v[52:55]
    s_bfe_u32 s56, s55, 0x4000c
    v_add_f32 v94, v34, v66
    v_add_f32 v95, v35, v67
    v_mfma_f32_16x16x32_bf16 v[56:59], a[120:123], v[140:143], v[56:59]
    s_mul_i32 s56, s56, 59392
    v_add_f32 v92, v92, v68
    v_add_f32 v93, v93, v69
    v_mfma_f32_16x16x32_bf16 v[60:63], a[124:127], v[140:143], v[60:63]
    s_add_u32 s56, s56, s57
    s_waitcnt vmcnt(10)
    v_add_f32 v94, v94, v70
    v_mfma_f32_16x16x32_bf16 v[48:51], a[112:115], v[140:143], v[48:51]
    buffer_load_dwordx4 v[140:143], v11, s[40:43], s56 offen sc1
    v_mfma_f32_16x16x32_bf16 v[52:55], a[132:135], v[144:147], v[52:55]
    s_bfe_u32 s56, s55, 0x40010
    v_add_f32 v95, v95, v71
    v_add_f32 v92, v92, v72
    v_mfma_f32_16x16x32_bf16 v[56:59], a[136:139], v[144:147], v[56:59]
    s_mul_i32 s56, s56, 59392
    v_add_f32 v93, v93, v73
    v_add_f32 v94, v94, v74
    v_mfma_f32_16x16x32_bf16 v[60:63], a[140:143], v[144:147], v[60:63]
    s_add_u32 s56, s56, s57
    s_waitcnt vmcnt(10)
    v_add_f32 v95, v95, v75
    v_mfma_f32_16x16x32_bf16 v[48:51], a[128:131], v[144:147], v[48:51]
    buffer_load_dwordx4 v[144:147], v11, s[40:43], s56 offen sc1
    v_mfma_f32_16x16x32_bf16 v[52:55], a[148:151], v[148:151], v[52:55]
    s_bfe_u32 s56, s55, 0x40014
    v_mul_f32 v76, v92, v92
    v_mul_f32 v77, v93, v93
    v_mfma_f32_16x16x32_bf16 v[56:59], a[152:155], v[148:151], v[56:59]
    s_mul_i32 s56, s56, 59392
    v_mul_f32 v78, v94, v94
    v_mul_f32 v79, v95, v95
    v_mfma_f32_16x16x32_bf16 v[60:63], a[156:159], v[148:151], v[60:63]
    s_add_u32 s56, s56, s57
    s_waitcnt vmcnt(10)
    v_fma_f32 v76, v76, s1, v30
    v_mfma_f32_16x16x32_bf16 v[48:51], a[144:147], v[148:151], v[48:51]
    buffer_load_dwordx4 v[148:151], v11, s[40:43], s56 offen sc1
    v_mfma_f32_16x16x32_bf16 v[52:55], a[164:167], v[152:155], v[52:55]
    s_bfe_u32 s56, s55, 0x40018
    v_fma_f32 v77, v77, s1, v30
    v_fma_f32 v78, v78, s1, v30
    v_mfma_f32_16x16x32_bf16 v[56:59], a[168:171], v[152:155], v[56:59]
    s_mul_i32 s56, s56, 59392
    v_fma_f32 v79, v79, s1, v30
    v_mul_f32 v76, v76, v92
    v_mfma_f32_16x16x32_bf16 v[60:63], a[172:175], v[152:155], v[60:63]
    s_add_u32 s56, s56, s57
    s_waitcnt vmcnt(10)
    v_mul_f32 v77, v77, v93
    v_mfma_f32_16x16x32_bf16 v[48:51], a[160:163], v[152:155], v[48:51]
    buffer_load_dwordx4 v[152:155], v11, s[40:43], s56 offen sc1
    v_mfma_f32_16x16x32_bf16 v[52:55], a[180:183], v[156:159], v[52:55]
    s_bfe_u32 s56, s55, 0x4001c
    v_mul_f32 v78, v78, v94
    v_mul_f32 v79, v79, v95
    v_mfma_f32_16x16x32_bf16 v[56:59], a[184:187], v[156:159], v[56:59]
    s_mul_i32 s56, s56, 59392
    v_exp_f32 v76, v76
    v_mfma_f32_16x16x32_bf16 v[60:63], a[188:191], v[156:159], v[60:63]
    s_add_u32 s56, s56, s57
    s_waitcnt vmcnt(10)
    v_mfma_f32_16x16x32_bf16 v[48:51], a[176:179], v[156:159], v[48:51]
    buffer_load_dwordx4 v[156:159], v11, s[40:43], s56 offen sc1
    v_mfma_f32_16x16x32_bf16 v[52:55], a[196:199], v[112:115], v[52:55]
    s_bfe_u32 s56, s58, 0x40000
    v_exp_f32 v77, v77
    v_mfma_f32_16x16x32_bf16 v[56:59], a[200:203], v[112:115], v[56:59]
    s_mul_i32 s56, s56, 59392
    v_exp_f32 v78, v78
    v_mfma_f32_16x16x32_bf16 v[60:63], a[204:207], v[112:115], v[60:63]
    s_add_u32 s56, s56, s57
    s_waitcnt vmcnt(10)
    v_mfma_f32_16x16x32_bf16 v[48:51], a[192:195], v[112:115], v[48:51]
    buffer_load_dwordx4 v[112:115], v11, s[40:43], s56 offen sc1
    v_mfma_f32_16x16x32_bf16 v[52:55], a[212:215], v[116:119], v[52:55]
    s_bfe_u32 s56, s58, 0x40004
    v_exp_f32 v79, v79
    v_mfma_f32_16x16x32_bf16 v[56:59], a[216:219], v[116:119], v[56:59]
    s_mul_i32 s56, s56, 59392
    v_add_f32 v76, 1.0, v76
    v_add_f32 v77, 1.0, v77
    v_mfma_f32_16x16x32_bf16 v[60:63], a[220:223], v[116:119], v[60:63]
    s_add_u32 s56, s56, s57
    s_waitcnt vmcnt(10)
    v_add_f32 v78, 1.0, v78
    v_mfma_f32_16x16x32_bf16 v[48:51], a[208:211], v[116:119], v[48:51]
    buffer_load_dwordx4 v[116:119], v11, s[40:43], s56 offen sc1
    v_mfma_f32_16x16x32_bf16 v[52:55], a[228:231], v[120:123], v[52:55]
    s_bfe_u32 s56, s58, 0x40008
    v_add_f32 v79, 1.0, v79
    s_mul_i32 s56, s56, 59392
    v_mfma_f32_16x16x32_bf16 v[56:59], a[232:235], v[120:123], v[56:59]
    s_add_u32 s56, s56, s57
    v_rcp_f32 v76, v76
    v_mfma_f32_16x16x32_bf16 v[60:63], a[236:239], v[120:123], v[60:63]
    s_waitcnt vmcnt(10)
    v_rcp_f32 v77, v77
    v_mfma_f32_16x16x32_bf16 v[48:51], a[224:227], v[120:123], v[48:51]
    buffer_load_dwordx4 v[120:123], v11, s[40:43], s56 offen sc1
    v_mfma_f32_16x16x32_bf16 v[52:55], a[244:247], v[124:127], v[52:55]
    s_bfe_u32 s56, s58, 0x4000c
    v_rcp_f32 v78, v78
    v_mfma_f32_16x16x32_bf16 v[56:59], a[248:251], v[124:127], v[56:59]
    s_mul_i32 s56, s56, 59392
    v_rcp_f32 v79, v79
    v_mfma_f32_16x16x32_bf16 v[60:63], a[252:255], v[124:127], v[60:63]
    s_add_u32 s56, s56, s57
    s_waitcnt vmcnt(10)
    v_mul_f32 v76, v76, v92
    v_mfma_f32_16x16x32_bf16 v[48:51], a[240:243], v[124:127], v[48:51]
    buffer_load_dwordx4 v[124:127], v11, s[40:43], s56 offen sc1
    v_mfma_f32_16x16x32_bf16 v[36:39], a[4:7], v[128:131], 0
    s_bfe_u32 s56, s58, 0x40010
    v_mul_f32 v77, v77, v93
    v_mul_f32 v78, v78, v94
    v_mfma_f32_16x16x32_bf16 v[40:43], a[8:11], v[128:131], 0
    s_mul_i32 s56, s56, 59392
    v_mul_f32 v79, v79, v95
    v_cvt_pk_bf16_f32 v84, v76, v77
    v_mfma_f32_16x16x32_bf16 v[44:47], a[12:15], v[128:131], 0
    s_add_u32 s56, s56, s57
    s_waitcnt vmcnt(10)
L_pad_2:
    s_cbranch_execz L_ret
    v_cvt_pk_bf16_f32 v85, v78, v79
    v_mfma_f32_16x16x32_bf16 v[32:35], a[0:3], v[128:131], v[12:15]
    buffer_load_dwordx4 v[128:131], v11, s[40:43], s56 offen sc1
    v_mfma_f32_16x16x32_bf16 v[36:39], a[20:23], v[132:135], v[36:39]
    ds_write_b128 v6, v[52:55] offset:12288
    v_mfma_f32_16x16x32_bf16 v[40:43], a[24:27], v[132:135], v[40:43]
    s_bfe_u32 s56, s58, 0x40014
    s_mul_i32 s56, s56, 59392
    s_add_u32 s56, s56, s57
    v_mfma_f32_16x16x32_bf16 v[44:47], a[28:31], v[132:135], v[44:47]
    s_waitcnt vmcnt(10)
    v_mfma_f32_16x16x32_bf16 v[32:35], a[16:19], v[132:135], v[32:35]
    buffer_load_dwordx4 v[132:135], v11, s[40:43], s56 offen sc1
    v_mfma_f32_16x16x32_bf16 v[36:39], a[36:39], v[136:139], v[36:39]
    ds_write_b128 v6, v[56:59] offset:13312
    v_mfma_f32_16x16x32_bf16 v[40:43], a[40:43], v[136:139], v[40:43]
    s_bfe_u32 s56, s58, 0x40018
    s_mul_i32 s56, s56, 59392
    s_add_u32 s56, s56, s57
    v_mfma_f32_16x16x32_bf16 v[44:47], a[44:47], v[136:139], v[44:47]
    s_waitcnt vmcnt(10)
    v_mfma_f32_16x16x32_bf16 v[32:35], a[32:35], v[136:139], v[32:35]
    buffer_load_dwordx4 v[136:139], v11, s[40:43], s56 offen sc1
    v_mfma_f32_16x16x32_bf16 v[36:39], a[52:55], v[140:143], v[36:39]
    ds_write_b128 v6, v[60:63] offset:14336
    v_mfma_f32_16x16x32_bf16 v[40:43], a[56:59], v[140:143], v[40:43]
    s_bfe_u32 s56, s58, 0x4001c
    s_mul_i32 s56, s56, 59392
    s_add_u32 s56, s56, s57
    v_mfma_f32_16x16x32_bf16 v[44:47], a[60:63], v[140:143], v[44:47]
    s_waitcnt vmcnt(10)
    v_mfma_f32_16x16x32_bf16 v[32:35], a[48:51], v[140:143], v[32:35]
    buffer_load_dwordx4 v[140:143], v11, s[40:43], s56 offen sc1
    v_mfma_f32_16x16x32_bf16 v[36:39], a[68:71], v[144:147], v[36:39]
    s_waitcnt vmcnt(10)
    v_mfma_f32_16x16x32_bf16 v[40:43], a[72:75], v[144:147], v[40:43]
    s_waitcnt lgkmcnt(0)
    s_barrier
    v_mfma_f32_16x16x32_bf16 v[44:47], a[76:79], v[144:147], v[44:47]
    ds_read_b128 v[64:67], v7 offset:12288
    ds_read_b128 v[68:71], v8 offset:12288
    v_mfma_f32_16x16x32_bf16 v[32:35], a[64:67], v[144:147], v[32:35]
    buffer_load_ushort v227, v226, s[32:35], s72 offen
    v_mfma_f32_16x16x32_bf16 v[36:39], a[84:87], v[148:151], v[36:39]
    s_waitcnt vmcnt(10)
    ds_read_b128 v[72:75], v9 offset:12288
    v_mfma_f32_16x16x32_bf16 v[40:43], a[88:91], v[148:151], v[40:43]
    v_mfma_f32_16x16x32_bf16 v[44:47], a[92:95], v[148:151], v[44:47]
    v_mfma_f32_16x16x32_bf16 v[32:35], a[80:83], v[148:151], v[32:35]
    s_lshr_b32 m0, s52, 1
    s_add_u32 m0, m0, 149504
    s_nop 0
    buffer_load_dwordx4 v224, s[8:11], s71 offen lds
    v_mfma_f32_16x16x32_bf16 v[36:39], a[100:103], v[152:155], v[36:39]
    s_waitcnt vmcnt(10)
    v_mfma_f32_16x16x32_bf16 v[40:43], a[104:107], v[152:155], v[40:43]
    s_waitcnt lgkmcnt(0)
    v_add_f32 v96, v48, v64
    v_add_f32 v97, v49, v65
    v_mfma_f32_16x16x32_bf16 v[44:47], a[108:111], v[152:155], v[44:47]
    v_add_f32 v98, v50, v66
    v_add_f32 v99, v51, v67
    v_mfma_f32_16x16x32_bf16 v[32:35], a[96:99], v[152:155], v[32:35]
    s_lshr_b32 m0, s52, 1
    s_add_u32 m0, m0, 150528
    s_add_u32 s72, s71, 7168
    buffer_load_dwordx4 v224, s[8:11], s72 offen lds
    v_mfma_f32_16x16x32_bf16 v[36:39], a[116:119], v[156:159], v[36:39]
    s_waitcnt vmcnt(10)
    v_add_f32 v96, v96, v68
    v_add_f32 v97, v97, v69
    v_mfma_f32_16x16x32_bf16 v[40:43], a[120:123], v[156:159], v[40:43]
    v_add_f32 v98, v98, v70
    v_add_f32 v99, v99, v71
    v_mfma_f32_16x16x32_bf16 v[44:47], a[124:127], v[156:159], v[44:47]
    v_add_f32 v96, v96, v72
    v_add_f32 v97, v97, v73
    v_mfma_f32_16x16x32_bf16 v[32:35], a[112:115], v[156:159], v[32:35]
    s_add_u32 m0, s52, 0
    s_nop 0
    buffer_load_dwordx4 v252, s[24:27], s59 offen lds
    v_mfma_f32_16x16x32_bf16 v[36:39], a[132:135], v[112:115], v[36:39]
    s_waitcnt vmcnt(10)
    v_add_f32 v98, v98, v74
    v_add_f32 v99, v99, v75
    v_mfma_f32_16x16x32_bf16 v[40:43], a[136:139], v[112:115], v[40:43]
    v_mul_f32 v76, v96, v96
    v_mul_f32 v77, v97, v97
    v_mfma_f32_16x16x32_bf16 v[44:47], a[140:143], v[112:115], v[44:47]
    v_mul_f32 v78, v98, v98
    v_mul_f32 v79, v99, v99
    v_mfma_f32_16x16x32_bf16 v[32:35], a[128:131], v[112:115], v[32:35]
    buffer_load_dwordx4 v253, s[24:27], s59 offen offset:1024 lds
    v_mfma_f32_16x16x32_bf16 v[36:39], a[148:151], v[116:119], v[36:39]
    s_waitcnt vmcnt(10)
    v_fma_f32 v76, v76, s1, v30
    v_fma_f32 v77, v77, s1, v30
    v_mfma_f32_16x16x32_bf16 v[40:43], a[152:155], v[116:119], v[40:43]
    v_fma_f32 v78, v78, s1, v30
    v_fma_f32 v79, v79, s1, v30
    v_mfma_f32_16x16x32_bf16 v[44:47], a[156:159], v[116:119], v[44:47]
    v_mul_f32 v76, v76, v96
    v_mul_f32 v77, v77, v97
    v_mfma_f32_16x16x32_bf16 v[32:35], a[144:147], v[116:119], v[32:35]
    buffer_load_dwordx4 v254, s[24:27], s59 offen offset:2048 lds
    v_mfma_f32_16x16x32_bf16 v[36:39], a[164:167], v[120:123], v[36:39]
    s_waitcnt vmcnt(10)
    v_mul_f32 v78, v78, v98
    v_mul_f32 v79, v79, v99
    v_mfma_f32_16x16x32_bf16 v[40:43], a[168:171], v[120:123], v[40:43]
    v_exp_f32 v76, v76
    v_mfma_f32_16x16x32_bf16 v[44:47], a[172:175], v[120:123], v[44:47]
    v_exp_f32 v77, v77
    v_mfma_f32_16x16x32_bf16 v[32:35], a[160:163], v[120:123], v[32:35]
    buffer_load_dwordx4 v255, s[24:27], s59 offen offset:3072 lds
    v_mfma_f32_16x16x32_bf16 v[36:39], a[180:183], v[124:127], v[36:39]
    s_waitcnt vmcnt(10)
    v_exp_f32 v78, v78
    v_mfma_f32_16x16x32_bf16 v[40:43], a[184:187], v[124:127], v[40:43]
    v_exp_f32 v79, v79
    v_mfma_f32_16x16x32_bf16 v[44:47], a[188:191], v[124:127], v[44:47]
    v_add_f32 v76, 1.0, v76
    v_add_f32 v77, 1.0, v77
    v_mfma_f32_16x16x32_bf16 v[32:35], a[176:179], v[124:127], v[32:35]
    s_add_u32 m0, s52, 16384
    s_add_u32 s59, s59, 131072
    buffer_load_dwordx4 v252, s[24:27], s59 offen lds
    v_mfma_f32_16x16x32_bf16 v[36:39], a[196:199], v[128:131], v[36:39]
    s_waitcnt vmcnt(10)
    v_add_f32 v78, 1.0, v78
    v_add_f32 v79, 1.0, v79
    v_mfma_f32_16x16x32_bf16 v[40:43], a[200:203], v[128:131], v[40:43]
    v_rcp_f32 v76, v76
    v_mfma_f32_16x16x32_bf16 v[44:47], a[204:207], v[128:131], v[44:47]
    v_rcp_f32 v77, v77
    v_mfma_f32_16x16x32_bf16 v[32:35], a[192:195], v[128:131], v[32:35]
    buffer_load_dwordx4 v253, s[24:27], s59 offen offset:1024 lds
    v_mfma_f32_16x16x32_bf16 v[36:39], a[212:215], v[132:135], v[36:39]
    s_waitcnt vmcnt(10)
    v_rcp_f32 v78, v78
    v_mfma_f32_16x16x32_bf16 v[40:43], a[216:219], v[132:135], v[40:43]
    v_rcp_f32 v79, v79
    v_mfma_f32_16x16x32_bf16 v[44:47], a[220:223], v[132:135], v[44:47]
    v_mul_f32 v76, v76, v96
    v_mul_f32 v77, v77, v97
    v_mfma_f32_16x16x32_bf16 v[32:35], a[208:211], v[132:135], v[32:35]
    buffer_load_dwordx4 v254, s[24:27], s59 offen offset:2048 lds
    v_mfma_f32_16x16x32_bf16 v[36:39], a[228:231], v[136:139], v[36:39]
    s_waitcnt vmcnt(10)
    v_mul_f32 v78, v78, v98
    v_mul_f32 v79, v79, v99
    v_mfma_f32_16x16x32_bf16 v[40:43], a[232:235], v[136:139], v[40:43]
    v_cvt_pk_bf16_f32 v86, v76, v77
    v_cvt_pk_bf16_f32 v87, v78, v79
    v_mfma_f32_16x16x32_bf16 v[44:47], a[236:239], v[136:139], v[44:47]
    v_permlane16_swap_b32 v84, v86
    v_mfma_f32_16x16x32_bf16 v[32:35], a[224:227], v[136:139], v[32:35]
    buffer_load_dwordx4 v255, s[24:27], s59 offen offset:3072 lds
    v_mfma_f32_16x16x32_bf16 v[36:39], a[244:247], v[140:143], v[36:39]
    v_permlane16_swap_b32 v85, v87
    v_mfma_f32_16x16x32_bf16 v[40:43], a[248:251], v[140:143], v[40:43]
    v_mfma_f32_16x16x32_bf16 v[44:47], a[252:255], v[140:143], v[44:47]
    v_mfma_f32_16x16x32_bf16 v[32:35], a[240:243], v[140:143], v[32:35]
    s_add_u32 m0, s52, 32768
    s_add_u32 s59, s59, 131072
    buffer_load_dwordx4 v252, s[24:27], s59 offen lds
    buffer_load_dwordx4 v253, s[24:27], s59 offen offset:1024 lds
    buffer_store_dwordx4 v[80:83], v20, s[40:43], s0 offen sc1
    buffer_store_dwordx4 v[84:87], v22, s[40:43], s0 offen sc1
    ds_write_b128 v6, v[36:39] offset:0
    buffer_load_dwordx4 v254, s[24:27], s59 offen offset:2048 lds
    ds_write_b128 v6, v[40:43] offset:1024
    buffer_load_dwordx4 v255, s[24:27], s59 offen offset:3072 lds
    ds_write_b128 v6, v[44:47] offset:2048
    s_add_u32 m0, s52, 49152
    s_add_u32 s59, s59, 131072
    buffer_load_dwordx4 v252, s[24:27], s59 offen lds
    s_waitcnt vmcnt(11)
    ds_read_b64_tr_b16 a[0:1], v248 offset:0
    ds_read_b64_tr_b16 a[2:3], v248 offset:2048
    s_waitcnt lgkmcnt(2)
    s_barrier
    ds_read_b128 v[64:67], v7 offset:0
    ds_read_b128 v[68:71], v8 offset:0
    ds_read_b128 v[72:75], v9 offset:0
    buffer_load_dwordx4 v253, s[24:27], s59 offen offset:1024 lds
    ds_read_b64_tr_b16 a[4:5], v249 offset:0
    ds_read_b64_tr_b16 a[6:7], v249 offset:2048
    s_waitcnt lgkmcnt(2)
    v_add_f32 v92, v32, v64
    v_add_f32 v93, v33, v65
    v_add_f32 v94, v34, v66
    v_add_f32 v95, v35, v67
    v_add_f32 v92, v92, v68
    v_add_f32 v93, v93, v69
    v_add_f32 v94, v94, v70
    v_add_f32 v95, v95, v71
    v_add_f32 v92, v92, v72
    v_add_f32 v93, v93, v73
    v_add_f32 v94, v94, v74
    v_add_f32 v95, v95, v75
    v_mul_f32 v76, v92, v92
    v_mul_f32 v77, v93, v93
    v_mul_f32 v78, v94, v94
    v_mul_f32 v79, v95, v95
    v_fma_f32 v76, v76, s1, v30
    v_fma_f32 v77, v77, s1, v30
    v_fma_f32 v78, v78, s1, v30
    v_fma_f32 v79, v79, s1, v30
    v_mul_f32 v76, v76, v92
    v_mul_f32 v77, v77, v93
    v_mul_f32 v78, v78, v94
    v_mul_f32 v79, v79, v95
    v_exp_f32 v76, v76
    v_exp_f32 v77, v77
    v_exp_f32 v78, v78
    v_exp_f32 v79, v79
    buffer_load_dwordx4 v254, s[24:27], s59 offen offset:2048 lds
    ds_read_b64_tr_b16 a[8:9], v250 offset:0
    ds_read_b64_tr_b16 a[10:11], v250 offset:2048
    v_add_f32 v76, 1.0, v76
    v_add_f32 v77, 1.0, v77
    v_add_f32 v78, 1.0, v78
    v_add_f32 v79, 1.0, v79
    v_rcp_f32 v76, v76
    v_rcp_f32 v77, v77
    v_rcp_f32 v78, v78
    v_rcp_f32 v79, v79
    v_mul_f32 v76, v76, v92
    v_mul_f32 v77, v77, v93
    v_mul_f32 v78, v78, v94
    v_mul_f32 v79, v79, v95
    v_cvt_pk_bf16_f32 v88, v76, v77
    v_cvt_pk_bf16_f32 v89, v78, v79
    s_nop 0
    v_permlane16_swap_b32 v88, v90
    v_permlane16_swap_b32 v89, v91
    buffer_load_dwordx4 v255, s[24:27], s59 offen offset:3072 lds
    ds_read_b64_tr_b16 a[12:13], v251 offset:0
    ds_read_b64_tr_b16 a[14:15], v251 offset:2048
    buffer_store_dwordx4 v[88:91], v23, s[40:43], s0 offen sc1
    s_waitcnt lgkmcnt(0)
    s_add_u32 m0, s52, 0
    s_add_u32 s59, s59, 131072
    buffer_load_dwordx4 v252, s[24:27], s59 offen lds
    s_waitcnt vmcnt(12)
    ds_read_b64_tr_b16 a[16:17], v248 offset:16384
    ds_read_b64_tr_b16 a[18:19], v248 offset:18432
    buffer_load_dwordx4 v253, s[24:27], s59 offen offset:1024 lds
    ds_read_b64_tr_b16 a[20:21], v249 offset:16384
    ds_read_b64_tr_b16 a[22:23], v249 offset:18432
    buffer_load_dwordx4 v254, s[24:27], s59 offen offset:2048 lds
    ds_read_b64_tr_b16 a[24:25], v250 offset:16384
    ds_read_b64_tr_b16 a[26:27], v250 offset:18432
    buffer_load_dwordx4 v255, s[24:27], s59 offen offset:3072 lds
    ds_read_b64_tr_b16 a[28:29], v251 offset:16384
    ds_read_b64_tr_b16 a[30:31], v251 offset:18432
    s_waitcnt lgkmcnt(0)
    s_add_u32 m0, s52, 16384
    s_add_u32 s59, s59, 131072
    buffer_load_dwordx4 v252, s[24:27], s59 offen lds
    s_waitcnt vmcnt(10)
    ds_read_b64_tr_b16 a[32:33], v248 offset:32768
    ds_read_b64_tr_b16 a[34:35], v248 offset:34816
    buffer_load_dwordx4 v253, s[24:27], s59 offen offset:1024 lds
    ds_read_b64_tr_b16 a[36:37], v249 offset:32768
    ds_read_b64_tr_b16 a[38:39], v249 offset:34816
    buffer_load_dwordx4 v254, s[24:27], s59 offen offset:2048 lds
    ds_read_b64_tr_b16 a[40:41], v250 offset:32768
    ds_read_b64_tr_b16 a[42:43], v250 offset:34816
    buffer_load_dwordx4 v255, s[24:27], s59 offen offset:3072 lds
    ds_read_b64_tr_b16 a[44:45], v251 offset:32768
    ds_read_b64_tr_b16 a[46:47], v251 offset:34816
    s_waitcnt lgkmcnt(0)
    s_add_u32 m0, s52, 32768
    s_add_u32 s59, s59, 131072
    buffer_load_dwordx4 v252, s[24:27], s59 offen lds
    s_waitcnt vmcnt(10)
    ds_read_b64_tr_b16 a[48:49], v248 offset:49152
    ds_read_b64_tr_b16 a[50:51], v248 offset:51200
    buffer_load_dwordx4 v253, s[24:27], s59 offen offset:1024 lds
    ds_read_b64_tr_b16 a[52:53], v249 offset:49152
    ds_read_b64_tr_b16 a[54:55], v249 offset:51200
    buffer_load_dwordx4 v254, s[24:27], s59 offen offset:2048 lds
    ds_read_b64_tr_b16 a[56:57], v250 offset:49152
    ds_read_b64_tr_b16 a[58:59], v250 offset:51200
    buffer_load_dwordx4 v255, s[24:27], s59 offen offset:3072 lds
    ds_read_b64_tr_b16 a[60:61], v251 offset:49152
    ds_read_b64_tr_b16 a[62:63], v251 offset:51200
    s_waitcnt vmcnt(12)
    s_barrier
    s_cmp_lg_u32 s3, 0
    s_cbranch_scc1 L_flag_16
    v_cmp_eq_u32 vcc, 0, v1
    v_bfrev_b32 v101, 1
    v_mov_b32 v102, s44
    v_mov_b32 v103, s45
    v_cndmask_b32 v101, v101, 0, vcc
    s_mul_i32 s74, s50, 6
    s_add_u32 s74, s74, s51
    s_mul_i32 s74, s74, 128
    s_add_u32 s74, s74, 36864
    buffer_store_dwordx2 v[102:103], v101, s[40:43], s74 offen sc1
L_flag_16:
    s_waitcnt lgkmcnt(0)
    s_add_u32 m0, s52, 49152
    s_add_u32 s59, s59, 131072
    buffer_load_dwordx4 v252, s[24:27], s59 offen lds
    s_waitcnt vmcnt(9)
    ds_read_b64_tr_b16 a[64:65], v248 offset:0
    ds_read_b64_tr_b16 a[66:67], v248 offset:2048
    buffer_load_dwordx4 v253, s[24:27], s59 offen offset:1024 lds
    ds_read_b64_tr_b16 a[68:69], v249 offset:0
    ds_read_b64_tr_b16 a[70:71], v249 offset:2048
    buffer_load_dwordx4 v254, s[24:27], s59 offen offset:2048 lds
    ds_read_b64_tr_b16 a[72:73], v250 offset:0
    ds_read_b64_tr_b16 a[74:75], v250 offset:2048
    buffer_load_dwordx4 v255, s[24:27], s59 offen offset:3072 lds
    ds_read_b64_tr_b16 a[76:77], v251 offset:0
    ds_read_b64_tr_b16 a[78:79], v251 offset:2048
    v_xor_b32 v13, 32, v16
    s_waitcnt lgkmcnt(0)
    s_add_u32 m0, s52, 0
    s_add_u32 s59, s59, 131072
    buffer_load_dwordx4 v252, s[24:27], s59 offen lds
    s_waitcnt vmcnt(9)
    ds_read_b64_tr_b16 a[80:81], v248 offset:16384
    ds_read_b64_tr_b16 a[82:83], v248 offset:18432
    v_xor_b32 v14, 64, v16
    buffer_load_dwordx4 v253, s[24:27], s59 offen offset:1024 lds
    ds_read_b64_tr_b16 a[84:85], v249 offset:16384
    ds_read_b64_tr_b16 a[86:87], v249 offset:18432
    v_xor_b32 v15, 0x60, v16
    buffer_load_dwordx4 v254, s[24:27], s59 offen offset:2048 lds
    ds_read_b64_tr_b16 a[88:89], v250 offset:16384
    ds_read_b64_tr_b16 a[90:91], v250 offset:18432
    ds_read_b64 v[236:237], v16
    buffer_load_dwordx4 v255, s[24:27], s59 offen offset:3072 lds
    ds_read_b64_tr_b16 a[92:93], v251 offset:16384
    ds_read_b64_tr_b16 a[94:95], v251 offset:18432
    ds_read_b64 v[238:239], v13
    s_waitcnt lgkmcnt(1)
    s_add_u32 m0, s52, 16384
    s_add_u32 s59, s59, 131072
    buffer_load_dwordx4 v252, s[24:27], s59 offen lds
    s_waitcnt vmcnt(9)
    ds_read_b64_tr_b16 a[96:97], v248 offset:32768
    ds_read_b64_tr_b16 a[98:99], v248 offset:34816
    ds_read_b64 v[240:241], v14
    buffer_load_dwordx4 v253, s[24:27], s59 offen offset:1024 lds
    ds_read_b64_tr_b16 a[100:101], v249 offset:32768
    ds_read_b64_tr_b16 a[102:103], v249 offset:34816
    ds_read_b64 v[242:243], v15
    buffer_load_dwordx4 v254, s[24:27], s59 offen offset:2048 lds
    ds_read_b64_tr_b16 a[104:105], v250 offset:32768
    ds_read_b64_tr_b16 a[106:107], v250 offset:34816
    v_lshlrev_b32 v20, 16, v227
    buffer_load_dwordx4 v255, s[24:27], s59 offen offset:3072 lds
    ds_read_b64_tr_b16 a[108:109], v251 offset:32768
    ds_read_b64_tr_b16 a[110:111], v251 offset:34816
    v_lshlrev_b32 v21, 16, v227
    s_waitcnt lgkmcnt(0)
    s_add_u32 m0, s52, 32768
    s_add_u32 s59, s59, 131072
    buffer_load_dwordx4 v252, s[24:27], s59 offen lds
    s_waitcnt vmcnt(9)
    ds_read_b64_tr_b16 a[112:113], v248 offset:49152
    ds_read_b64_tr_b16 a[114:115], v248 offset:51200
    v_lshlrev_b32 v22, 16, v227
    buffer_load_dwordx4 v253, s[24:27], s59 offen offset:1024 lds
    ds_read_b64_tr_b16 a[116:117], v249 offset:49152
    ds_read_b64_tr_b16 a[118:119], v249 offset:51200
    v_lshlrev_b32 v23, 16, v227
    buffer_load_dwordx4 v254, s[24:27], s59 offen offset:2048 lds
    ds_read_b64_tr_b16 a[120:121], v250 offset:49152
    ds_read_b64_tr_b16 a[122:123], v250 offset:51200
    buffer_load_dwordx4 v255, s[24:27], s59 offen offset:3072 lds
    ds_read_b64_tr_b16 a[124:125], v251 offset:49152
    ds_read_b64_tr_b16 a[126:127], v251 offset:51200
    s_waitcnt lgkmcnt(0)
    s_add_u32 m0, s52, 49152
    s_add_u32 s59, s59, 131072
    buffer_load_dwordx4 v252, s[24:27], s59 offen lds
    s_waitcnt vmcnt(9)
    ds_read_b64_tr_b16 a[128:129], v248 offset:0
    ds_read_b64_tr_b16 a[130:131], v248 offset:2048
    buffer_load_dwordx4 v253, s[24:27], s59 offen offset:1024 lds
    ds_read_b64_tr_b16 a[132:133], v249 offset:0
    ds_read_b64_tr_b16 a[134:135], v249 offset:2048
    buffer_load_dwordx4 v254, s[24:27], s59 offen offset:2048 lds
    ds_read_b64_tr_b16 a[136:137], v250 offset:0
    ds_read_b64_tr_b16 a[138:139], v250 offset:2048
    buffer_load_dwordx4 v255, s[24:27], s59 offen offset:3072 lds
    ds_read_b64_tr_b16 a[140:141], v251 offset:0
    ds_read_b64_tr_b16 a[142:143], v251 offset:2048
    s_waitcnt lgkmcnt(0)
    s_add_u32 m0, s52, 0
    s_add_u32 s59, s59, 131072
    buffer_load_dwordx4 v252, s[24:27], s59 offen lds
    s_waitcnt vmcnt(9)
    ds_read_b64_tr_b16 a[144:145], v248 offset:16384
    ds_read_b64_tr_b16 a[146:147], v248 offset:18432
    buffer_load_dwordx4 v253, s[24:27], s59 offen offset:1024 lds
    ds_read_b64_tr_b16 a[148:149], v249 offset:16384
    ds_read_b64_tr_b16 a[150:151], v249 offset:18432
    buffer_load_dwordx4 v254, s[24:27], s59 offen offset:2048 lds
    ds_read_b64_tr_b16 a[152:153], v250 offset:16384
    ds_read_b64_tr_b16 a[154:155], v250 offset:18432
    buffer_load_dwordx4 v255, s[24:27], s59 offen offset:3072 lds
    ds_read_b64_tr_b16 a[156:157], v251 offset:16384
    ds_read_b64_tr_b16 a[158:159], v251 offset:18432
    s_waitcnt lgkmcnt(0)
    s_add_u32 m0, s52, 16384
    s_add_u32 s59, s59, 131072
    buffer_load_dwordx4 v252, s[24:27], s59 offen lds
    s_waitcnt vmcnt(9)
    ds_read_b64_tr_b16 a[160:161], v248 offset:32768
    ds_read_b64_tr_b16 a[162:163], v248 offset:34816
    buffer_load_dwordx4 v253, s[24:27], s59 offen offset:1024 lds
    ds_read_b64_tr_b16 a[164:165], v249 offset:32768
    ds_read_b64_tr_b16 a[166:167], v249 offset:34816
    buffer_load_dwordx4 v254, s[24:27], s59 offen offset:2048 lds
    ds_read_b64_tr_b16 a[168:169], v250 offset:32768
    ds_read_b64_tr_b16 a[170:171], v250 offset:34816
    buffer_load_dwordx4 v255, s[24:27], s59 offen offset:3072 lds
    ds_read_b64_tr_b16 a[172:173], v251 offset:32768
    ds_read_b64_tr_b16 a[174:175], v251 offset:34816
    s_add_u32 m0, s70, 0
    s_nop 0
    buffer_load_dwordx4 v224, s[16:19], s69 offen lds
    s_waitcnt vmcnt(9)
    ds_read_b64_tr_b16 a[176:177], v248 offset:49152
    ds_read_b64_tr_b16 a[178:179], v248 offset:51200
    s_add_u32 m0, s70, 1024
    s_add_u32 s69, s69, 7168
    buffer_load_dwordx4 v224, s[16:19], s69 offen lds
    ds_read_b64_tr_b16 a[180:181], v249 offset:49152
    ds_read_b64_tr_b16 a[182:183], v249 offset:51200
    s_add_u32 m0, s70, 2048
    s_add_u32 s69, s69, 7168
    buffer_load_dwordx4 v224, s[16:19], s69 offen lds
    ds_read_b64_tr_b16 a[184:185], v250 offset:49152
    ds_read_b64_tr_b16 a[186:187], v250 offset:51200
    s_add_u32 m0, s70, 3072
    s_add_u32 s69, s69, 7168
    buffer_load_dwordx4 v224, s[16:19], s69 offen lds
    ds_read_b64_tr_b16 a[188:189], v251 offset:49152
    ds_read_b64_tr_b16 a[190:191], v251 offset:51200
    s_add_u32 m0, s70, 4096
    s_add_u32 s69, s69, 7168
    buffer_load_dwordx4 v224, s[16:19], s69 offen lds
    s_waitcnt vmcnt(9)
    ds_read_b64_tr_b16 a[192:193], v248 offset:0
    ds_read_b64_tr_b16 a[194:195], v248 offset:2048
    s_add_u32 m0, s70, 5120
    s_add_u32 s69, s69, 7168
    buffer_load_dwordx4 v224, s[16:19], s69 offen lds
    ds_read_b64_tr_b16 a[196:197], v249 offset:0
    ds_read_b64_tr_b16 a[198:199], v249 offset:2048
    buffer_load_dwordx2 v[232:233], v228, s[40:43], 0 offen sc1
    ds_read_b64_tr_b16 a[200:201], v250 offset:0
    ds_read_b64_tr_b16 a[202:203], v250 offset:2048
    s_add_u32 m0, s70, 6144
    s_add_u32 s69, s69, 7168
    buffer_load_dwordx4 v224, s[16:19], s69 offen lds
    ds_read_b64_tr_b16 a[204:205], v251 offset:0
    ds_read_b64_tr_b16 a[206:207], v251 offset:2048
    s_add_u32 m0, s70, 7168
    s_add_u32 s69, s69, 7168
    buffer_load_dwordx4 v224, s[16:19], s69 offen lds
    s_waitcnt vmcnt(9)
    ds_read_b64_tr_b16 a[208:209], v248 offset:16384
    ds_read_b64_tr_b16 a[210:211], v248 offset:18432
    s_add_u32 m0, s70, 8192
    s_add_u32 s69, s69, 7168
    buffer_load_dwordx4 v224, s[16:19], s69 offen lds
    ds_read_b64_tr_b16 a[212:213], v249 offset:16384
    ds_read_b64_tr_b16 a[214:215], v249 offset:18432
    s_add_u32 m0, s70, 9216
    s_add_u32 s69, s69, 7168
    buffer_load_dwordx4 v224, s[16:19], s69 offen lds
    ds_read_b64_tr_b16 a[216:217], v250 offset:16384
    ds_read_b64_tr_b16 a[218:219], v250 offset:18432
    s_add_u32 m0, s70, 10240
    s_add_u32 s69, s69, 7168
    buffer_load_dwordx4 v224, s[16:19], s69 offen lds
    ds_read_b64_tr_b16 a[220:221], v251 offset:16384
    ds_read_b64_tr_b16 a[222:223], v251 offset:18432
    s_add_u32 m0, s70, 11264
    s_add_u32 s69, s69, 7168
    buffer_load_dwordx4 v224, s[16:19], s69 offen lds
    s_add_u32 m0, s70, 12288
    s_add_u32 s69, s69, 7168
    buffer_load_dwordx4 v224, s[16:19], s69 offen lds
    s_add_u32 m0, s70, 13312
    s_add_u32 s69, s69, 7168
    buffer_load_dwordx4 v224, s[16:19], s69 offen lds
    s_waitcnt vmcnt(8)
    v_cmp_ne_u64 vcc, s[44:45], v[232:233]
    s_mov_b32 s65, 0
    s_cbranch_vccz L_polled_18
L_poll_17:
    buffer_load_dwordx2 v[232:233], v228, s[40:43], 0 offen sc1
    s_waitcnt vmcnt(0)
    v_cmp_ne_u64 vcc, s[44:45], v[232:233]
    s_add_u32 s65, s65, 1
    s_cbranch_vccz L_polled_18
    s_cmp_lt_u32 s65, 200000
    s_cbranch_scc1 L_poll_17
L_polled_18:
    buffer_load_dwordx4 v[112:115], v234, s[40:43], s66 offen sc1
    s_add_u32 s66, s66, 59392
    buffer_load_dwordx4 v[116:119], v234, s[40:43], s66 offen sc1
    s_add_u32 s66, s66, 59392
    buffer_load_dwordx4 v[120:123], v234, s[40:43], s66 offen sc1
    s_add_u32 s66, s66, 59392
    buffer_load_dwordx4 v[124:127], v234, s[40:43], s66 offen sc1
    s_add_u32 s66, s66, 59392
    buffer_load_dwordx4 v[128:131], v234, s[40:43], s66 offen sc1
    s_add_u32 s66, s66, 59392
    buffer_load_dwordx4 v[132:135], v234, s[40:43], s66 offen sc1
    s_add_u32 s66, s66, 59392
    buffer_load_dwordx4 v[136:139], v234, s[40:43], s66 offen sc1
    s_add_u32 s66, s66, 59392
    buffer_load_dwordx4 v[140:143], v234, s[40:43], s66 offen sc1
    s_add_u32 s66, s66, 59392
    buffer_load_dwordx4 v[144:147], v234, s[40:43], s66 offen sc1
    s_add_u32 s66, s66, 59392
    buffer_load_dwordx4 v[148:151], v234, s[40:43], s66 offen sc1
    s_add_u32 s66, s66, 59392
    buffer_load_dwordx4 v[152:155], v234, s[40:43], s66 offen sc1
    s_add_u32 s66, s66, 59392
    buffer_load_dwordx4 v[156:159], v234, s[40:43], s66 offen sc1
L_p2:
L_pad_3:
    s_cbranch_execz L_ret
    s_waitcnt lgkmcnt(0)
    s_waitcnt vmcnt(11)
    v_mfma_f32_16x16x32_bf16 v[36:39], v[112:115], a[4:7], 0
    s_add_u32 s66, s66, 59392
    s_waitcnt vmcnt(10)
    v_mfma_f32_16x16x32_bf16 v[40:43], v[112:115], a[8:11], 0
    s_barrier
    s_cmp_eq_u32 s62, -1
    s_cbranch_scc1 L_noflag
    s_cmp_lg_u32 s3, 0
    s_cbranch_scc1 L_flag_56
    v_cmp_eq_u32 vcc, 0, v1
    v_bfrev_b32 v29, 1
    v_mov_b32 v30, s44
    v_mov_b32 v31, s45
    v_cndmask_b32 v29, v29, 0, vcc
    s_lshl_b32 s74, s62, 1
    s_add_u32 s74, s74, s63
    s_lshl_b32 s74, s74, 4
    s_add_u32 s74, s74, s64
    s_mul_i32 s74, s74, 128
    s_add_u32 s74, s74, 61440
    buffer_store_dwordx2 v[30:31], v29, s[40:43], s74 offen sc1
L_flag_56:
L_noflag:
    v_mfma_f32_16x16x32_bf16 v[44:47], v[112:115], a[12:15], 0
    ds_read_b64_tr_b16 a[224:225], v244 offset:0
    ds_read_b64_tr_b16 a[226:227], v244 offset:2048
    v_mfma_f32_16x16x32_bf16 v[32:35], v[112:115], a[0:3], v[20:23]
    buffer_load_dwordx4 v[112:115], v234, s[40:43], s66 offen sc1
    v_mfma_f32_16x16x32_bf16 v[36:39], v[116:119], a[20:23], v[36:39]
    s_add_u32 s66, s66, 59392
    ds_read_b64_tr_b16 a[228:229], v245 offset:0
    v_mfma_f32_16x16x32_bf16 v[40:43], v[116:119], a[24:27], v[40:43]
    s_waitcnt vmcnt(10)
    ds_read_b64_tr_b16 a[230:231], v245 offset:2048
    v_mfma_f32_16x16x32_bf16 v[44:47], v[116:119], a[28:31], v[44:47]
    ds_read_b64_tr_b16 a[232:233], v246 offset:0
    ds_read_b64_tr_b16 a[234:235], v246 offset:2048
    v_mfma_f32_16x16x32_bf16 v[32:35], v[116:119], a[16:19], v[32:35]
    buffer_load_dwordx4 v[116:119], v234, s[40:43], s66 offen sc1
    v_mfma_f32_16x16x32_bf16 v[36:39], v[120:123], a[36:39], v[36:39]
    s_mov_b32 s66, s67
    ds_read_b64_tr_b16 a[236:237], v247 offset:0
    v_mfma_f32_16x16x32_bf16 v[40:43], v[120:123], a[40:43], v[40:43]
    s_waitcnt vmcnt(10)
    ds_read_b64_tr_b16 a[238:239], v247 offset:2048
    v_mfma_f32_16x16x32_bf16 v[44:47], v[120:123], a[44:47], v[44:47]
    ds_read_b64_tr_b16 a[240:241], v246 offset:3584
    ds_read_b64_tr_b16 a[242:243], v246 offset:5632
    v_mfma_f32_16x16x32_bf16 v[32:35], v[120:123], a[32:35], v[32:35]
    buffer_load_dwordx4 v[120:123], v234, s[40:43], s66 offen offset:2048 sc1
    v_mfma_f32_16x16x32_bf16 v[36:39], v[124:127], a[52:55], v[36:39]
    s_add_u32 s66, s66, 59392
    ds_read_b64_tr_b16 a[244:245], v247 offset:3584
    v_mfma_f32_16x16x32_bf16 v[40:43], v[124:127], a[56:59], v[40:43]
    s_waitcnt vmcnt(10)
    ds_read_b64_tr_b16 a[246:247], v247 offset:5632
    v_mfma_f32_16x16x32_bf16 v[44:47], v[124:127], a[60:63], v[44:47]
    ds_read_b64_tr_b16 a[248:249], v244 offset:3584
    ds_read_b64_tr_b16 a[250:251], v244 offset:5632
    v_mfma_f32_16x16x32_bf16 v[32:35], v[124:127], a[48:51], v[32:35]
    buffer_load_dwordx4 v[124:127], v234, s[40:43], s66 offen offset:2048 sc1
    v_mfma_f32_16x16x32_bf16 v[36:39], v[128:131], a[68:71], v[36:39]
    s_add_u32 s66, s66, 59392
    ds_read_b64_tr_b16 a[252:253], v245 offset:3584
    v_mfma_f32_16x16x32_bf16 v[40:43], v[128:131], a[72:75], v[40:43]
    s_waitcnt vmcnt(10)
    ds_read_b64_tr_b16 a[254:255], v245 offset:5632
    v_mfma_f32_16x16x32_bf16 v[44:47], v[128:131], a[76:79], v[44:47]
    ds_read_b64_tr_b16 v[160:161], v244 offset:7168
    ds_read_b64_tr_b16 v[162:163], v244 offset:9216
    v_mfma_f32_16x16x32_bf16 v[32:35], v[128:131], a[64:67], v[32:35]
L_pad_4:
    s_cbranch_execz L_ret
    buffer_load_dwordx4 v[128:131], v234, s[40:43], s66 offen offset:2048 sc1
    v_mfma_f32_16x16x32_bf16 v[36:39], v[132:135], a[84:87], v[36:39]
    s_add_u32 s66, s66, 59392
    ds_read_b64_tr_b16 v[164:165], v245 offset:7168
    v_mfma_f32_16x16x32_bf16 v[40:43], v[132:135], a[88:91], v[40:43]
    s_waitcnt vmcnt(10)
    ds_read_b64_tr_b16 v[166:167], v245 offset:9216
    v_mfma_f32_16x16x32_bf16 v[44:47], v[132:135], a[92:95], v[44:47]
    ds_read_b64_tr_b16 v[168:169], v246 offset:7168
    ds_read_b64_tr_b16 v[170:171], v246 offset:9216
    v_mfma_f32_16x16x32_bf16 v[32:35], v[132:135], a[80:83], v[32:35]
    buffer_load_dwordx4 v[132:135], v234, s[40:43], s66 offen offset:2048 sc1
    v_mfma_f32_16x16x32_bf16 v[36:39], v[136:139], a[100:103], v[36:39]
    s_add_u32 s66, s66, 59392
    ds_read_b64_tr_b16 v[172:173], v247 offset:7168
    v_mfma_f32_16x16x32_bf16 v[40:43], v[136:139], a[104:107], v[40:43]
    s_waitcnt vmcnt(10)
    ds_read_b64_tr_b16 v[174:175], v247 offset:9216
    v_mfma_f32_16x16x32_bf16 v[44:47], v[136:139], a[108:111], v[44:47]
    ds_read_b64_tr_b16 v[176:177], v246 offset:10752
    ds_read_b64_tr_b16 v[178:179], v246 offset:12800
    v_mfma_f32_16x16x32_bf16 v[32:35], v[136:139], a[96:99], v[32:35]
    buffer_load_dwordx4 v[136:139], v234, s[40:43], s66 offen offset:2048 sc1
    v_mfma_f32_16x16x32_bf16 v[36:39], v[140:143], a[116:119], v[36:39]
    s_add_u32 s66, s66, 59392
    ds_read_b64_tr_b16 v[180:181], v247 offset:10752
    v_mfma_f32_16x16x32_bf16 v[40:43], v[140:143], a[120:123], v[40:43]
    s_waitcnt vmcnt(10)
    ds_read_b64_tr_b16 v[182:183], v247 offset:12800
    v_mfma_f32_16x16x32_bf16 v[44:47], v[140:143], a[124:127], v[44:47]
    ds_read_b64_tr_b16 v[184:185], v244 offset:10752
    ds_read_b64_tr_b16 v[186:187], v244 offset:12800
    v_mfma_f32_16x16x32_bf16 v[32:35], v[140:143], a[112:115], v[32:35]
    buffer_load_dwordx4 v[140:143], v234, s[40:43], s66 offen offset:2048 sc1
    v_mfma_f32_16x16x32_bf16 v[36:39], v[144:147], a[132:135], v[36:39]
    s_add_u32 s66, s66, 59392
    ds_read_b64_tr_b16 v[188:189], v245 offset:10752
    v_mfma_f32_16x16x32_bf16 v[40:43], v[144:147], a[136:139], v[40:43]
    s_waitcnt vmcnt(10)
    ds_read_b64_tr_b16 v[190:191], v245 offset:12800
    v_mfma_f32_16x16x32_bf16 v[44:47], v[144:147], a[140:143], v[44:47]
    ds_read_b64_tr_b16 v[192:193], v244 offset:14336
    ds_read_b64_tr_b16 v[194:195], v244 offset:16384
    v_mfma_f32_16x16x32_bf16 v[32:35], v[144:147], a[128:131], v[32:35]
    buffer_load_dwordx4 v[144:147], v234, s[40:43], s66 offen offset:2048 sc1
    v_mfma_f32_16x16x32_bf16 v[36:39], v[148:151], a[148:151], v[36:39]
    s_add_u32 s66, s66, 59392
    ds_read_b64_tr_b16 v[196:197], v245 offset:14336
    v_mfma_f32_16x16x32_bf16 v[40:43], v[148:151], a[152:155], v[40:43]
    s_waitcnt vmcnt(10)
    ds_read_b64_tr_b16 v[198:199], v245 offset:16384
    v_mfma_f32_16x16x32_bf16 v[44:47], v[148:151], a[156:159], v[44:47]
    ds_read_b64_tr_b16 v[200:201], v246 offset:14336
    ds_read_b64_tr_b16 v[202:203], v246 offset:16384
    v_mfma_f32_16x16x32_bf16 v[32:35], v[148:151], a[144:147], v[32:35]
    buffer_load_dwordx4 v[148:151], v234, s[40:43], s66 offen offset:2048 sc1
    v_mfma_f32_16x16x32_bf16 v[36:39], v[152:155], a[164:167], v[36:39]
    s_add_u32 s66, s66, 59392
    ds_read_b64_tr_b16 v[204:205], v247 offset:14336
    v_mfma_f32_16x16x32_bf16 v[40:43], v[152:155], a[168:171], v[40:43]
    s_waitcnt vmcnt(10)
    ds_read_b64_tr_b16 v[206:207], v247 offset:16384
    v_mfma_f32_16x16x32_bf16 v[44:47], v[152:155], a[172:175], v[44:47]
    ds_read_b64_tr_b16 v[208:209], v246 offset:17920
    ds_read_b64_tr_b16 v[210:211], v246 offset:19968
    v_mfma_f32_16x16x32_bf16 v[32:35], v[152:155], a[160:163], v[32:35]
    buffer_load_dwordx4 v[152:155], v234, s[40:43], s66 offen offset:2048 sc1
    v_mfma_f32_16x16x32_bf16 v[36:39], v[156:159], a[180:183], v[36:39]
    s_add_u32 s66, s66, 59392
    ds_read_b64_tr_b16 v[212:213], v247 offset:17920
    v_mfma_f32_16x16x32_bf16 v[40:43], v[156:159], a[184:187], v[40:43]
    s_waitcnt vmcnt(10)
    ds_read_b64_tr_b16 v[214:215], v247 offset:19968
    v_mfma_f32_16x16x32_bf16 v[44:47], v[156:159], a[188:191], v[44:47]
    ds_read_b64_tr_b16 v[216:217], v244 offset:17920
    ds_read_b64_tr_b16 v[218:219], v244 offset:19968
    v_mfma_f32_16x16x32_bf16 v[32:35], v[156:159], a[176:179], v[32:35]
    buffer_load_dwordx4 v[156:159], v234, s[40:43], s66 offen offset:2048 sc1
    v_mfma_f32_16x16x32_bf16 v[36:39], v[112:115], a[196:199], v[36:39]
    s_add_u32 s66, s66, 59392
    ds_read_b64_tr_b16 v[220:221], v245 offset:17920
    v_mfma_f32_16x16x32_bf16 v[40:43], v[112:115], a[200:203], v[40:43]
    s_waitcnt vmcnt(10)
    ds_read_b64_tr_b16 v[222:223], v245 offset:19968
    v_mfma_f32_16x16x32_bf16 v[44:47], v[112:115], a[204:207], v[44:47]
    v_mfma_f32_16x16x32_bf16 v[32:35], v[112:115], a[192:195], v[32:35]
    buffer_load_dwordx4 v[112:115], v234, s[40:43], s66 offen offset:2048 sc1
    v_mfma_f32_16x16x32_bf16 v[36:39], v[116:119], a[212:215], v[36:39]
    s_add_u32 s66, s66, 59392
    s_waitcnt vmcnt(10)
    v_mfma_f32_16x16x32_bf16 v[40:43], v[116:119], a[216:219], v[40:43]
    v_mfma_f32_16x16x32_bf16 v[44:47], v[116:119], a[220:223], v[44:47]
    v_mfma_f32_16x16x32_bf16 v[32:35], v[116:119], a[208:211], v[32:35]
    buffer_load_dwordx4 v[116:119], v234, s[40:43], s66 offen offset:2048 sc1
    v_mfma_f32_16x16x32_bf16 v[52:55], v[120:123], a[4:7], 0
    s_add_u32 s66, s66, 59392
    s_waitcnt vmcnt(10)
    v_mfma_f32_16x16x32_bf16 v[56:59], v[120:123], a[8:11], 0
    v_mfma_f32_16x16x32_bf16 v[60:63], v[120:123], a[12:15], 0
    ds_write_b128 v24, v[36:39] offset:1024
    v_mfma_f32_16x16x32_bf16 v[48:51], v[120:123], a[0:3], v[20:23]
    buffer_load_dwordx4 v[120:123], v234, s[40:43], s66 offen offset:2048 sc1
    v_mfma_f32_16x16x32_bf16 v[52:55], v[124:127], a[20:23], v[52:55]
    s_add_u32 s66, s66, 59392
    v_xor_b32 v252, 0, v19
    v_mfma_f32_16x16x32_bf16 v[56:59], v[124:127], a[24:27], v[56:59]
    ds_write_b128 v24, v[40:43] offset:2048
    v_mfma_f32_16x16x32_bf16 v[60:63], v[124:127], a[28:31], v[60:63]
    s_waitcnt vmcnt(10)
    v_xor_b32 v253, 32, v19
    v_xor_b32 v254, 64, v19
    v_mfma_f32_16x16x32_bf16 v[48:51], v[124:127], a[16:19], v[48:51]
    buffer_load_dwordx4 v[124:127], v234, s[40:43], s66 offen offset:2048 sc1
    v_mfma_f32_16x16x32_bf16 v[52:55], v[128:131], a[36:39], v[52:55]
    ds_write_b128 v24, v[44:47] offset:3072
    v_mfma_f32_16x16x32_bf16 v[56:59], v[128:131], a[40:43], v[56:59]
    s_mov_b32 s66, s67
    v_xor_b32 v255, 96, v19
    v_lshlrev_b32 v2, 16, v236
    v_mfma_f32_16x16x32_bf16 v[60:63], v[128:131], a[44:47], v[60:63]
    s_waitcnt vmcnt(10)
    v_and_b32 v3, 0xffff0000, v236
    v_lshlrev_b32 v4, 16, v237
    v_mfma_f32_16x16x32_bf16 v[48:51], v[128:131], a[32:35], v[48:51]
    buffer_load_dwordx4 v[128:131], v235, s[40:43], s66 offen sc1
    v_mfma_f32_16x16x32_bf16 v[52:55], v[132:135], a[52:55], v[52:55]
    ds_write_b128 v24, v[32:35] offset:0
    v_mfma_f32_16x16x32_bf16 v[56:59], v[132:135], a[56:59], v[56:59]
    s_add_u32 s66, s66, 59392
    v_and_b32 v5, 0xffff0000, v237
    v_lshlrev_b32 v6, 16, v238
    v_mfma_f32_16x16x32_bf16 v[60:63], v[132:135], a[60:63], v[60:63]
    s_waitcnt vmcnt(10)
    v_and_b32 v7, 0xffff0000, v238
    v_lshlrev_b32 v8, 16, v239
    v_mfma_f32_16x16x32_bf16 v[48:51], v[132:135], a[48:51], v[48:51]
    buffer_load_dwordx4 v[132:135], v235, s[40:43], s66 offen sc1
    v_mfma_f32_16x16x32_bf16 v[52:55], v[136:139], a[68:71], v[52:55]
    s_add_u32 s66, s66, 59392
    v_and_b32 v9, 0xffff0000, v239
    v_lshlrev_b32 v10, 16, v240
    v_mfma_f32_16x16x32_bf16 v[56:59], v[136:139], a[72:75], v[56:59]
    s_waitcnt lgkmcnt(0)
    s_barrier
    v_mfma_f32_16x16x32_bf16 v[60:63], v[136:139], a[76:79], v[60:63]
    s_waitcnt vmcnt(10)
    ds_read_b128 v[80:83], v25 offset:0
    v_mfma_f32_16x16x32_bf16 v[48:51], v[136:139], a[64:67], v[48:51]
    buffer_load_dwordx4 v[136:139], v235, s[40:43], s66 offen sc1
    v_mfma_f32_16x16x32_bf16 v[52:55], v[140:143], a[84:87], v[52:55]
    s_add_u32 s66, s66, 59392
    ds_read_b128 v[96:99], v26 offset:0
    v_mfma_f32_16x16x32_bf16 v[56:59], v[140:143], a[88:91], v[56:59]
    s_waitcnt vmcnt(10)
    ds_read_b128 v[100:103], v27 offset:0
    v_mfma_f32_16x16x32_bf16 v[60:63], v[140:143], a[92:95], v[60:63]
    ds_read_b128 v[104:107], v28 offset:0
    v_and_b32 v11, 0xffff0000, v240
    v_mfma_f32_16x16x32_bf16 v[48:51], v[140:143], a[80:83], v[48:51]
    buffer_load_dwordx4 v[140:143], v235, s[40:43], s66 offen sc1
    v_mfma_f32_16x16x32_bf16 v[52:55], v[144:147], a[100:103], v[52:55]
    s_add_u32 s66, s66, 59392
    v_lshlrev_b32 v12, 16, v241
    v_and_b32 v13, 0xffff0000, v241
    v_mfma_f32_16x16x32_bf16 v[56:59], v[144:147], a[104:107], v[56:59]
    s_waitcnt vmcnt(10)
    v_lshlrev_b32 v14, 16, v242
    v_and_b32 v15, 0xffff0000, v242
    v_mfma_f32_16x16x32_bf16 v[60:63], v[144:147], a[108:111], v[60:63]
    v_lshlrev_b32 v16, 16, v243
    v_and_b32 v17, 0xffff0000, v243
    v_mfma_f32_16x16x32_bf16 v[48:51], v[144:147], a[96:99], v[48:51]
    buffer_load_dwordx4 v[144:147], v235, s[40:43], s66 offen sc1
    v_mfma_f32_16x16x32_bf16 v[52:55], v[148:151], a[116:119], v[52:55]
    s_add_u32 s66, s66, 59392
    s_waitcnt lgkmcnt(0)
    v_add_f32 v80, v80, v96
    v_mfma_f32_16x16x32_bf16 v[56:59], v[148:151], a[120:123], v[56:59]
    s_waitcnt vmcnt(10)
    v_add_f32 v81, v81, v97
    v_add_f32 v82, v82, v98
    v_mfma_f32_16x16x32_bf16 v[60:63], v[148:151], a[124:127], v[60:63]
    v_add_f32 v83, v83, v99
    v_add_f32 v80, v80, v100
    v_mfma_f32_16x16x32_bf16 v[48:51], v[148:151], a[112:115], v[48:51]
    buffer_load_dwordx4 v[148:151], v235, s[40:43], s66 offen sc1
    v_mfma_f32_16x16x32_bf16 v[52:55], v[152:155], a[132:135], v[52:55]
    s_add_u32 s66, s66, 59392
    v_add_f32 v81, v81, v101
    v_add_f32 v82, v82, v102
    v_mfma_f32_16x16x32_bf16 v[56:59], v[152:155], a[136:139], v[56:59]
    s_waitcnt vmcnt(10)
    v_add_f32 v83, v83, v103
    v_add_f32 v80, v80, v104
    v_mfma_f32_16x16x32_bf16 v[60:63], v[152:155], a[140:143], v[60:63]
    v_add_f32 v81, v81, v105
    v_add_f32 v82, v82, v106
    v_mfma_f32_16x16x32_bf16 v[48:51], v[152:155], a[128:131], v[48:51]
    buffer_load_dwordx4 v[152:155], v235, s[40:43], s66 offen sc1
    v_mfma_f32_16x16x32_bf16 v[52:55], v[156:159], a[148:151], v[52:55]
    s_add_u32 s66, s66, 59392
    v_add_f32 v83, v83, v107
    v_mul_f32 v108, 0xbfb8aa3b, v80
    v_mfma_f32_16x16x32_bf16 v[56:59], v[156:159], a[152:155], v[56:59]
    s_waitcnt vmcnt(10)
    v_mul_f32 v109, 0xbfb8aa3b, v81
    v_mul_f32 v110, 0xbfb8aa3b, v82
    v_mfma_f32_16x16x32_bf16 v[60:63], v[156:159], a[156:159], v[60:63]
    v_mul_f32 v111, 0xbfb8aa3b, v83
    v_mfma_f32_16x16x32_bf16 v[48:51], v[156:159], a[144:147], v[48:51]
    buffer_load_dwordx4 v[156:159], v235, s[40:43], s66 offen sc1
    v_mfma_f32_16x16x32_bf16 v[52:55], v[112:115], a[164:167], v[52:55]
    s_add_u32 s66, s66, 59392
    v_exp_f32 v108, v108
    v_mfma_f32_16x16x32_bf16 v[56:59], v[112:115], a[168:171], v[56:59]
    s_waitcnt vmcnt(10)
    v_exp_f32 v109, v109
    v_mfma_f32_16x16x32_bf16 v[60:63], v[112:115], a[172:175], v[60:63]
    v_exp_f32 v110, v110
    v_mfma_f32_16x16x32_bf16 v[48:51], v[112:115], a[160:163], v[48:51]
    buffer_load_dwordx4 v[112:115], v235, s[40:43], s66 offen sc1
    v_mfma_f32_16x16x32_bf16 v[52:55], v[116:119], a[180:183], v[52:55]
    s_add_u32 s66, s66, 59392
    v_exp_f32 v111, v111
    v_mfma_f32_16x16x32_bf16 v[56:59], v[116:119], a[184:187], v[56:59]
    s_waitcnt vmcnt(10)
    v_add_f32 v108, 1.0, v108
    v_add_f32 v109, 1.0, v109
    v_mfma_f32_16x16x32_bf16 v[60:63], v[116:119], a[188:191], v[60:63]
    v_add_f32 v110, 1.0, v110
    v_add_f32 v111, 1.0, v111
    v_mfma_f32_16x16x32_bf16 v[48:51], v[116:119], a[176:179], v[48:51]
    buffer_load_dwordx4 v[116:119], v235, s[40:43], s66 offen sc1
    v_mfma_f32_16x16x32_bf16 v[52:55], v[120:123], a[196:199], v[52:55]
    s_add_u32 s66, s66, 59392
    v_rcp_f32 v108, v108
    v_mfma_f32_16x16x32_bf16 v[56:59], v[120:123], a[200:203], v[56:59]
    s_waitcnt vmcnt(10)
    v_rcp_f32 v109, v109
    v_mfma_f32_16x16x32_bf16 v[60:63], v[120:123], a[204:207], v[60:63]
    v_rcp_f32 v110, v110
    v_mfma_f32_16x16x32_bf16 v[48:51], v[120:123], a[192:195], v[48:51]
    buffer_load_dwordx4 v[120:123], v235, s[40:43], s66 offen sc1
    v_mfma_f32_16x16x32_bf16 v[52:55], v[124:127], a[212:215], v[52:55]
    s_add_u32 s66, s66, 59392
    v_rcp_f32 v111, v111
    v_mfma_f32_16x16x32_bf16 v[56:59], v[124:127], a[216:219], v[56:59]
    s_waitcnt vmcnt(10)
    v_mul_f32 v80, v108, v80
    v_mul_f32 v81, v109, v81
    v_mfma_f32_16x16x32_bf16 v[60:63], v[124:127], a[220:223], v[60:63]
    v_mul_f32 v82, v110, v82
    v_mul_f32 v83, v111, v83
    v_mfma_f32_16x16x32_bf16 v[48:51], v[124:127], a[208:211], v[48:51]
    buffer_load_dwordx4 v[124:127], v235, s[40:43], s66 offen sc1
    v_mfma_f32_16x16x32_bf16 v[36:39], v[128:131], a[4:7], 0
    s_add_u32 s66, s66, 59392
    s_waitcnt vmcnt(10)
    v_mfma_f32_16x16x32_bf16 v[40:43], v[128:131], a[8:11], 0
    v_mfma_f32_16x16x32_bf16 v[44:47], v[128:131], a[12:15], 0
    ds_write_b128 v24, v[52:55] offset:17408
    v_mfma_f32_16x16x32_bf16 v[32:35], v[128:131], a[0:3], v[20:23]
    buffer_load_dwordx4 v[128:131], v235, s[40:43], s66 offen sc1
    v_mfma_f32_16x16x32_bf16 v[36:39], v[132:135], a[20:23], v[36:39]
    s_add_u32 s66, s66, 59392
    s_waitcnt vmcnt(10)
    v_mfma_f32_16x16x32_bf16 v[40:43], v[132:135], a[24:27], v[40:43]
    ds_write_b128 v24, v[56:59] offset:18432
    v_mfma_f32_16x16x32_bf16 v[44:47], v[132:135], a[28:31], v[44:47]
    v_mfma_f32_16x16x32_bf16 v[32:35], v[132:135], a[16:19], v[32:35]
    buffer_load_dwordx4 v[132:135], v235, s[40:43], s66 offen sc1
    v_mfma_f32_16x16x32_bf16 v[36:39], v[136:139], a[36:39], v[36:39]
    ds_write_b128 v24, v[60:63] offset:19456
    v_mfma_f32_16x16x32_bf16 v[40:43], v[136:139], a[40:43], v[40:43]
    s_mov_b32 s66, s67
    s_waitcnt vmcnt(10)
    v_mfma_f32_16x16x32_bf16 v[44:47], v[136:139], a[44:47], v[44:47]
    v_mfma_f32_16x16x32_bf16 v[32:35], v[136:139], a[32:35], v[32:35]
    buffer_load_dwordx4 v[136:139], v235, s[40:43], s66 offen offset:2048 sc1
    v_mfma_f32_16x16x32_bf16 v[36:39], v[140:143], a[52:55], v[36:39]
    ds_write_b128 v24, v[48:51] offset:16384
    v_mfma_f32_16x16x32_bf16 v[40:43], v[140:143], a[56:59], v[40:43]
    s_add_u32 s66, s66, 59392
    s_waitcnt vmcnt(10)
    v_mfma_f32_16x16x32_bf16 v[44:47], v[140:143], a[60:63], v[44:47]
    v_mfma_f32_16x16x32_bf16 v[32:35], v[140:143], a[48:51], v[32:35]
    buffer_load_dwordx4 v[140:143], v235, s[40:43], s66 offen offset:2048 sc1
    v_mfma_f32_16x16x32_bf16 v[36:39], v[144:147], a[68:71], v[36:39]
    s_add_u32 s66, s66, 59392
    s_waitcnt vmcnt(10)
    v_mfma_f32_16x16x32_bf16 v[40:43], v[144:147], a[72:75], v[40:43]
    s_waitcnt lgkmcnt(0)
    s_barrier
    v_mfma_f32_16x16x32_bf16 v[44:47], v[144:147], a[76:79], v[44:47]
    ds_read_b128 v[84:87], v25 offset:16384
    ds_read_b128 v[96:99], v26 offset:16384
    v_mfma_f32_16x16x32_bf16 v[32:35], v[144:147], a[64:67], v[32:35]
    buffer_load_dwordx4 v[144:147], v235, s[40:43], s66 offen offset:2048 sc1
    v_mfma_f32_16x16x32_bf16 v[36:39], v[148:151], a[84:87], v[36:39]
    s_add_u32 s66, s66, 59392
    ds_read_b128 v[100:103], v27 offset:16384
    v_mfma_f32_16x16x32_bf16 v[40:43], v[148:151], a[88:91], v[40:43]
    s_waitcnt vmcnt(10)
    ds_read_b128 v[104:107], v28 offset:16384
    v_mfma_f32_16x16x32_bf16 v[44:47], v[148:151], a[92:95], v[44:47]
    v_mfma_f32_16x16x32_bf16 v[32:35], v[148:151], a[80:83], v[32:35]
    buffer_load_dwordx2 v[232:233], v229, s[40:43], 0 offen sc1
    buffer_load_dwordx4 v[148:151], v235, s[40:43], s66 offen offset:2048 sc1
    v_mfma_f32_16x16x32_bf16 v[36:39], v[152:155], a[100:103], v[36:39]
    s_add_u32 s66, s66, 59392
    s_waitcnt vmcnt(11)
    v_mfma_f32_16x16x32_bf16 v[40:43], v[152:155], a[104:107], v[40:43]
    v_mfma_f32_16x16x32_bf16 v[44:47], v[152:155], a[108:111], v[44:47]
    s_waitcnt lgkmcnt(0)
    v_add_f32 v84, v84, v96
    v_add_f32 v85, v85, v97
    v_mfma_f32_16x16x32_bf16 v[32:35], v[152:155], a[96:99], v[32:35]
    buffer_load_dwordx4 v[152:155], v235, s[40:43], s66 offen offset:2048 sc1
    v_mfma_f32_16x16x32_bf16 v[36:39], v[156:159], a[116:119], v[36:39]
    s_add_u32 s66, s66, 59392
    v_add_f32 v86, v86, v98
    v_add_f32 v87, v87, v99
    v_mfma_f32_16x16x32_bf16 v[40:43], v[156:159], a[120:123], v[40:43]
    s_waitcnt vmcnt(11)
    v_add_f32 v84, v84, v100
    v_add_f32 v85, v85, v101
    v_mfma_f32_16x16x32_bf16 v[44:47], v[156:159], a[124:127], v[44:47]
    v_add_f32 v86, v86, v102
    v_add_f32 v87, v87, v103
    v_mfma_f32_16x16x32_bf16 v[32:35], v[156:159], a[112:115], v[32:35]
    buffer_load_dwordx4 v[156:159], v235, s[40:43], s66 offen offset:2048 sc1
    v_mfma_f32_16x16x32_bf16 v[36:39], v[112:115], a[132:135], v[36:39]
    s_add_u32 s66, s66, 59392
    v_add_f32 v84, v84, v104
    v_add_f32 v85, v85, v105
    v_mfma_f32_16x16x32_bf16 v[40:43], v[112:115], a[136:139], v[40:43]
    s_waitcnt vmcnt(11)
    v_add_f32 v86, v86, v106
    v_add_f32 v87, v87, v107
    v_mfma_f32_16x16x32_bf16 v[44:47], v[112:115], a[140:143], v[44:47]
    v_mul_f32 v108, 0xbfb8aa3b, v84
    v_mul_f32 v109, 0xbfb8aa3b, v85
    v_mfma_f32_16x16x32_bf16 v[32:35], v[112:115], a[128:131], v[32:35]
    buffer_load_dwordx4 v[112:115], v235, s[40:43], s66 offen offset:2048 sc1
    v_mfma_f32_16x16x32_bf16 v[36:39], v[116:119], a[148:151], v[36:39]
    s_add_u32 s66, s66, 59392
    v_mul_f32 v110, 0xbfb8aa3b, v86
    v_mul_f32 v111, 0xbfb8aa3b, v87
    v_mfma_f32_16x16x32_bf16 v[40:43], v[116:119], a[152:155], v[40:43]
    s_waitcnt vmcnt(11)
    v_exp_f32 v108, v108
    v_mfma_f32_16x16x32_bf16 v[44:47], v[116:119], a[156:159], v[44:47]
    v_exp_f32 v109, v109
    v_mfma_f32_16x16x32_bf16 v[32:35], v[116:119], a[144:147], v[32:35]
    buffer_load_dwordx4 v[116:119], v235, s[40:43], s66 offen offset:2048 sc1
    v_mfma_f32_16x16x32_bf16 v[36:39], v[120:123], a[164:167], v[36:39]
    s_add_u32 s66, s66, 59392
    v_exp_f32 v110, v110
    v_mfma_f32_16x16x32_bf16 v[40:43], v[120:123], a[168:171], v[40:43]
    s_waitcnt vmcnt(11)
    v_exp_f32 v111, v111
    v_mfma_f32_16x16x32_bf16 v[44:47], v[120:123], a[172:175], v[44:47]
    v_add_f32 v108, 1.0, v108
    v_add_f32 v109, 1.0, v109
    v_mfma_f32_16x16x32_bf16 v[32:35], v[120:123], a[160:163], v[32:35]
    buffer_load_dwordx4 v[120:123], v235, s[40:43], s66 offen offset:2048 sc1
    v_mfma_f32_16x16x32_bf16 v[36:39], v[124:127], a[180:183], v[36:39]
    s_add_u32 s66, s66, 59392
    v_add_f32 v110, 1.0, v110
    v_add_f32 v111, 1.0, v111
    v_mfma_f32_16x16x32_bf16 v[40:43], v[124:127], a[184:187], v[40:43]
    s_waitcnt vmcnt(11)
    v_rcp_f32 v108, v108
    v_mfma_f32_16x16x32_bf16 v[44:47], v[124:127], a[188:191], v[44:47]
    v_rcp_f32 v109, v109
    v_mfma_f32_16x16x32_bf16 v[32:35], v[124:127], a[176:179], v[32:35]
    buffer_load_dwordx4 v[124:127], v235, s[40:43], s66 offen offset:2048 sc1
    v_mfma_f32_16x16x32_bf16 v[36:39], v[128:131], a[196:199], v[36:39]
    s_add_u32 s66, s66, 59392
    v_rcp_f32 v110, v110
    v_mfma_f32_16x16x32_bf16 v[40:43], v[128:131], a[200:203], v[40:43]
    s_waitcnt vmcnt(11)
    v_rcp_f32 v111, v111
    v_mfma_f32_16x16x32_bf16 v[44:47], v[128:131], a[204:207], v[44:47]
    v_mul_f32 v84, v108, v84
    v_mul_f32 v85, v109, v85
    v_mfma_f32_16x16x32_bf16 v[32:35], v[128:131], a[192:195], v[32:35]
    buffer_load_dwordx4 v[128:131], v235, s[40:43], s66 offen offset:2048 sc1
    v_mfma_f32_16x16x32_bf16 v[36:39], v[132:135], a[212:215], v[36:39]
    s_add_u32 s66, s66, 59392
    v_mul_f32 v86, v110, v86
    v_mul_f32 v87, v111, v87
    v_mfma_f32_16x16x32_bf16 v[40:43], v[132:135], a[216:219], v[40:43]
    s_waitcnt vmcnt(11)
    v_mfma_f32_16x16x32_bf16 v[44:47], v[132:135], a[220:223], v[44:47]
    v_mfma_f32_16x16x32_bf16 v[32:35], v[132:135], a[208:211], v[32:35]
    buffer_load_dwordx4 v[132:135], v235, s[40:43], s66 offen offset:2048 sc1
    v_mfma_f32_16x16x32_bf16 v[52:55], v[136:139], a[4:7], 0
    s_add_u32 s66, s66, 59392
    s_waitcnt vmcnt(11)
    v_mfma_f32_16x16x32_bf16 v[56:59], v[136:139], a[8:11], 0
    v_mfma_f32_16x16x32_bf16 v[60:63], v[136:139], a[12:15], 0
    ds_write_b128 v24, v[36:39] offset:1024
    v_mfma_f32_16x16x32_bf16 v[48:51], v[136:139], a[0:3], v[20:23]
    buffer_load_dwordx4 v[136:139], v235, s[40:43], s66 offen offset:2048 sc1
    v_mfma_f32_16x16x32_bf16 v[52:55], v[140:143], a[20:23], v[52:55]
    s_add_u32 s66, s66, 59392
    ds_read_b64_tr_b16 a[0:1], v244 offset:21504
    v_mfma_f32_16x16x32_bf16 v[56:59], v[140:143], a[24:27], v[56:59]
    ds_write_b128 v24, v[40:43] offset:2048
    v_mfma_f32_16x16x32_bf16 v[60:63], v[140:143], a[28:31], v[60:63]
    s_waitcnt vmcnt(11)
    ds_read_b64_tr_b16 a[2:3], v244 offset:23552
    v_mfma_f32_16x16x32_bf16 v[48:51], v[140:143], a[16:19], v[48:51]
    buffer_load_dwordx4 v[140:143], v235, s[40:43], s66 offen offset:2048 sc1
    v_mfma_f32_16x16x32_bf16 v[52:55], v[144:147], a[36:39], v[52:55]
    ds_write_b128 v24, v[44:47] offset:3072
    v_mfma_f32_16x16x32_bf16 v[56:59], v[144:147], a[40:43], v[56:59]
    s_waitcnt vmcnt(10)
    ds_read_b64_tr_b16 a[4:5], v245 offset:21504
    v_mfma_f32_16x16x32_bf16 v[60:63], v[144:147], a[44:47], v[60:63]
    ds_read_b64_tr_b16 a[6:7], v245 offset:23552
    ds_read_b64_tr_b16 a[8:9], v246 offset:21504
    v_mfma_f32_16x16x32_bf16 v[48:51], v[144:147], a[32:35], v[48:51]
    v_cmp_ne_u64 vcc, s[44:45], v[232:233]
    s_mov_b32 s65, 0
    s_cbranch_vccz L_polled_58
L_poll_57:
    buffer_load_dwordx2 v[232:233], v229, s[40:43], 0 offen sc1
    s_waitcnt vmcnt(0)
    v_cmp_ne_u64 vcc, s[44:45], v[232:233]
    s_add_u32 s65, s65, 1
    s_cbranch_vccz L_polled_58
    s_cmp_lt_u32 s65, 200000
    s_cbranch_scc1 L_poll_57
L_polled_58:
    buffer_load_dwordx4 v[144:147], v230, s[40:43], s73 offen sc1
    v_mfma_f32_16x16x32_bf16 v[52:55], v[148:151], a[52:55], v[52:55]
    ds_write_b128 v24, v[32:35] offset:0
    v_mfma_f32_16x16x32_bf16 v[56:59], v[148:151], a[56:59], v[56:59]
    s_waitcnt vmcnt(10)
    ds_read_b64_tr_b16 a[10:11], v246 offset:23552
    v_mfma_f32_16x16x32_bf16 v[60:63], v[148:151], a[60:63], v[60:63]
    ds_read_b64_tr_b16 a[12:13], v247 offset:21504
    ds_read_b64_tr_b16 a[14:15], v247 offset:23552
    v_mfma_f32_16x16x32_bf16 v[48:51], v[148:151], a[48:51], v[48:51]
    buffer_load_dwordx4 v[148:151], v230, s[40:43], s73 offen offset:1024 sc1
    v_mfma_f32_16x16x32_bf16 v[52:55], v[152:155], a[68:71], v[52:55]
    s_waitcnt vmcnt(10)
    ds_read_b64_tr_b16 a[16:17], v246 offset:25088
    v_mfma_f32_16x16x32_bf16 v[56:59], v[152:155], a[72:75], v[56:59]
    s_waitcnt lgkmcnt(4)
    s_barrier
    v_mfma_f32_16x16x32_bf16 v[60:63], v[152:155], a[76:79], v[60:63]
    ds_read_b128 v[88:91], v25 offset:0
    ds_read_b128 v[96:99], v26 offset:0
    v_mfma_f32_16x16x32_bf16 v[48:51], v[152:155], a[64:67], v[48:51]
    buffer_load_dwordx4 v[152:155], v230, s[40:43], s73 offen offset:2048 sc1
    v_mfma_f32_16x16x32_bf16 v[52:55], v[156:159], a[84:87], v[52:55]
    s_waitcnt vmcnt(10)
    ds_read_b128 v[100:103], v27 offset:0
    v_mfma_f32_16x16x32_bf16 v[56:59], v[156:159], a[88:91], v[56:59]
    ds_read_b128 v[104:107], v28 offset:0
    v_mfma_f32_16x16x32_bf16 v[60:63], v[156:159], a[92:95], v[60:63]
    ds_read_b64_tr_b16 a[18:19], v246 offset:27136
    ds_read_b64_tr_b16 a[20:21], v247 offset:25088
    v_mfma_f32_16x16x32_bf16 v[48:51], v[156:159], a[80:83], v[48:51]
    buffer_load_dwordx4 v[156:159], v230, s[40:43], s73 offen offset:3072 sc1
    v_mfma_f32_16x16x32_bf16 v[52:55], v[112:115], a[100:103], v[52:55]
    s_waitcnt vmcnt(10)
    ds_read_b64_tr_b16 a[22:23], v247 offset:27136
    v_mfma_f32_16x16x32_bf16 v[56:59], v[112:115], a[104:107], v[56:59]
    ds_read_b64_tr_b16 a[24:25], v244 offset:25088
    ds_read_b64_tr_b16 a[26:27], v244 offset:27136
    v_mfma_f32_16x16x32_bf16 v[60:63], v[112:115], a[108:111], v[60:63]
    s_waitcnt lgkmcnt(5)
    v_add_f32 v88, v88, v96
    v_add_f32 v89, v89, v97
    v_mfma_f32_16x16x32_bf16 v[48:51], v[112:115], a[96:99], v[48:51]
    s_add_u32 s73, s73, 4096
    buffer_load_dwordx4 v[112:115], v230, s[40:43], s73 offen sc1
    v_mfma_f32_16x16x32_bf16 v[52:55], v[116:119], a[116:119], v[52:55]
    s_waitcnt vmcnt(10)
    v_add_f32 v90, v90, v98
    v_add_f32 v91, v91, v99
    v_mfma_f32_16x16x32_bf16 v[56:59], v[116:119], a[120:123], v[56:59]
    v_add_f32 v88, v88, v100
    v_add_f32 v89, v89, v101
    v_mfma_f32_16x16x32_bf16 v[60:63], v[116:119], a[124:127], v[60:63]
    v_add_f32 v90, v90, v102
    v_add_f32 v91, v91, v103
    v_mfma_f32_16x16x32_bf16 v[48:51], v[116:119], a[112:115], v[48:51]
    buffer_load_dwordx4 v[116:119], v230, s[40:43], s73 offen offset:1024 sc1
    v_mfma_f32_16x16x32_bf16 v[52:55], v[120:123], a[132:135], v[52:55]
    s_waitcnt vmcnt(10)
    v_add_f32 v88, v88, v104
    v_add_f32 v89, v89, v105
    v_mfma_f32_16x16x32_bf16 v[56:59], v[120:123], a[136:139], v[56:59]
    v_add_f32 v90, v90, v106
    v_add_f32 v91, v91, v107
    v_mfma_f32_16x16x32_bf16 v[60:63], v[120:123], a[140:143], v[60:63]
    v_mul_f32 v108, 0xbfb8aa3b, v88
    v_mul_f32 v109, 0xbfb8aa3b, v89
    v_mfma_f32_16x16x32_bf16 v[48:51], v[120:123], a[128:131], v[48:51]
    buffer_load_dwordx4 v[120:123], v230, s[40:43], s73 offen offset:2048 sc1
    v_mfma_f32_16x16x32_bf16 v[52:55], v[124:127], a[148:151], v[52:55]
    s_waitcnt vmcnt(10)
    v_mul_f32 v110, 0xbfb8aa3b, v90
    v_mul_f32 v111, 0xbfb8aa3b, v91
    v_mfma_f32_16x16x32_bf16 v[56:59], v[124:127], a[152:155], v[56:59]
    v_exp_f32 v108, v108
    v_mfma_f32_16x16x32_bf16 v[60:63], v[124:127], a[156:159], v[60:63]
    v_exp_f32 v109, v109
    v_mfma_f32_16x16x32_bf16 v[48:51], v[124:127], a[144:147], v[48:51]
    buffer_load_dwordx4 v[124:127], v230, s[40:43], s73 offen offset:3072 sc1
    v_mfma_f32_16x16x32_bf16 v[52:55], v[128:131], a[164:167], v[52:55]
    s_waitcnt vmcnt(10)
    v_exp_f32 v110, v110
    v_mfma_f32_16x16x32_bf16 v[56:59], v[128:131], a[168:171], v[56:59]
    v_exp_f32 v111, v111
    v_mfma_f32_16x16x32_bf16 v[60:63], v[128:131], a[172:175], v[60:63]
    v_add_f32 v108, 1.0, v108
    v_add_f32 v109, 1.0, v109
    v_mfma_f32_16x16x32_bf16 v[48:51], v[128:131], a[160:163], v[48:51]
    s_add_u32 s73, s73, 4096
    buffer_load_dwordx4 v[128:131], v230, s[40:43], s73 offen sc1
    v_mfma_f32_16x16x32_bf16 v[52:55], v[132:135], a[180:183], v[52:55]
    s_waitcnt vmcnt(10)
    v_add_f32 v110, 1.0, v110
    v_add_f32 v111, 1.0, v111
    v_mfma_f32_16x16x32_bf16 v[56:59], v[132:135], a[184:187], v[56:59]
    v_rcp_f32 v108, v108
    v_mfma_f32_16x16x32_bf16 v[60:63], v[132:135], a[188:191], v[60:63]
    v_rcp_f32 v109, v109
    v_mfma_f32_16x16x32_bf16 v[48:51], v[132:135], a[176:179], v[48:51]
    buffer_load_dwordx4 v[132:135], v230, s[40:43], s73 offen offset:1024 sc1
    v_mfma_f32_16x16x32_bf16 v[52:55], v[136:139], a[196:199], v[52:55]
    ds_read_b64_tr_b16 a[28:29], v245 offset:25088
    ds_read_b64_tr_b16 a[30:31], v245 offset:27136
    v_mfma_f32_16x16x32_bf16 v[56:59], v[136:139], a[200:203], v[56:59]
    ds_read_b64_tr_b16 a[32:33], v244 offset:28672
    ds_read_b64_tr_b16 a[34:35], v244 offset:30720
    v_mfma_f32_16x16x32_bf16 v[60:63], v[136:139], a[204:207], v[60:63]
    s_waitcnt vmcnt(10)
    v_rcp_f32 v110, v110
    v_mfma_f32_16x16x32_bf16 v[48:51], v[136:139], a[192:195], v[48:51]
    buffer_load_dwordx4 v[136:139], v230, s[40:43], s73 offen offset:2048 sc1
    v_mfma_f32_16x16x32_bf16 v[52:55], v[140:143], a[212:215], v[52:55]
    ds_read_b64_tr_b16 a[36:37], v245 offset:28672
    ds_read_b64_tr_b16 a[38:39], v245 offset:30720
    v_mfma_f32_16x16x32_bf16 v[56:59], v[140:143], a[216:219], v[56:59]
    ds_read_b64_tr_b16 a[40:41], v246 offset:28672
    ds_read_b64_tr_b16 a[42:43], v246 offset:30720
    v_mfma_f32_16x16x32_bf16 v[60:63], v[140:143], a[220:223], v[60:63]
    s_waitcnt vmcnt(10)
    v_rcp_f32 v111, v111
    v_mfma_f32_16x16x32_bf16 v[48:51], v[140:143], a[208:211], v[48:51]
    buffer_load_dwordx4 v[140:143], v230, s[40:43], s73 offen offset:3072 sc1
    v_mfma_f32_16x16x32_bf16 v[64:67], a[224:227], v[144:147], 0
    ds_read_b64_tr_b16 a[44:45], v247 offset:28672
    ds_read_b64_tr_b16 a[46:47], v247 offset:30720
    v_mfma_f32_16x16x32_bf16 v[68:71], a[228:231], v[144:147], 0
    ds_read_b64_tr_b16 a[48:49], v246 offset:32256
    ds_read_b64_tr_b16 a[50:51], v246 offset:34304
    v_mfma_f32_16x16x32_bf16 v[72:75], a[232:235], v[144:147], 0
    s_waitcnt vmcnt(10)
    v_mul_f32 v88, v108, v88
    v_mul_f32 v89, v109, v89
    v_mfma_f32_16x16x32_bf16 v[76:79], a[236:239], v[144:147], 0
    s_add_u32 s73, s73, 4096
    buffer_load_dwordx4 v[144:147], v230, s[40:43], s73 offen sc1
    v_mfma_f32_16x16x32_bf16 v[64:67], a[240:243], v[148:151], v[64:67]
    ds_write_b128 v24, v[52:55] offset:17408
    v_mfma_f32_16x16x32_bf16 v[68:71], a[244:247], v[148:151], v[68:71]
    ds_read_b64_tr_b16 a[52:53], v247 offset:32256
    ds_read_b64_tr_b16 a[54:55], v247 offset:34304
    v_mfma_f32_16x16x32_bf16 v[72:75], a[248:251], v[148:151], v[72:75]
    s_waitcnt vmcnt(10)
    ds_read_b64_tr_b16 a[56:57], v244 offset:32256
    v_mfma_f32_16x16x32_bf16 v[76:79], a[252:255], v[148:151], v[76:79]
    buffer_load_dwordx4 v[148:151], v230, s[40:43], s73 offen offset:1024 sc1
    v_mfma_f32_16x16x32_bf16 v[64:67], v[160:163], v[152:155], v[64:67]
    ds_write_b128 v24, v[56:59] offset:18432
    v_mfma_f32_16x16x32_bf16 v[68:71], v[164:167], v[152:155], v[68:71]
    ds_read_b64_tr_b16 a[58:59], v244 offset:34304
    ds_read_b64_tr_b16 a[60:61], v245 offset:32256
    v_mfma_f32_16x16x32_bf16 v[72:75], v[168:171], v[152:155], v[72:75]
    s_waitcnt vmcnt(10)
    ds_read_b64_tr_b16 a[62:63], v245 offset:34304
    v_mfma_f32_16x16x32_bf16 v[76:79], v[172:175], v[152:155], v[76:79]
    buffer_load_dwordx4 v[152:155], v230, s[40:43], s73 offen offset:2048 sc1
    v_mfma_f32_16x16x32_bf16 v[64:67], v[176:179], v[156:159], v[64:67]
    ds_write_b128 v24, v[60:63] offset:19456
    v_mfma_f32_16x16x32_bf16 v[68:71], v[180:183], v[156:159], v[68:71]
    ds_read_b64_tr_b16 a[64:65], v244 offset:35840
    ds_read_b64_tr_b16 a[66:67], v244 offset:37888
    v_mfma_f32_16x16x32_bf16 v[72:75], v[184:187], v[156:159], v[72:75]
L_pad_5:
    s_cbranch_execz L_ret
    s_waitcnt vmcnt(10)
    ds_read_b64_tr_b16 a[68:69], v245 offset:35840
    v_mfma_f32_16x16x32_bf16 v[76:79], v[188:191], v[156:159], v[76:79]
    buffer_load_dwordx4 v[156:159], v230, s[40:43], s73 offen offset:3072 sc1
    v_mfma_f32_16x16x32_bf16 v[64:67], v[192:195], v[112:115], v[64:67]
    ds_write_b128 v24, v[48:51] offset:16384
    v_mfma_f32_16x16x32_bf16 v[68:71], v[196:199], v[112:115], v[68:71]
    ds_read_b64_tr_b16 a[70:71], v245 offset:37888
    ds_read_b64_tr_b16 a[72:73], v246 offset:35840
    v_mfma_f32_16x16x32_bf16 v[72:75], v[200:203], v[112:115], v[72:75]
    s_waitcnt vmcnt(10)
    ds_read_b64_tr_b16 a[74:75], v246 offset:37888
    v_mfma_f32_16x16x32_bf16 v[76:79], v[204:207], v[112:115], v[76:79]
    ds_read_b64_tr_b16 a[76:77], v247 offset:35840
    ds_read_b64_tr_b16 a[78:79], v247 offset:37888
    v_mfma_f32_16x16x32_bf16 v[64:67], v[208:211], v[116:119], v[64:67]
    ds_read_b64_tr_b16 a[80:81], v246 offset:39424
    ds_read_b64_tr_b16 a[82:83], v246 offset:41472
    v_mfma_f32_16x16x32_bf16 v[68:71], v[212:215], v[116:119], v[68:71]
    s_waitcnt lgkmcnt(7)
    s_barrier
    v_mfma_f32_16x16x32_bf16 v[72:75], v[216:219], v[116:119], v[72:75]
    s_waitcnt vmcnt(9)
    ds_read_b64_tr_b16 a[84:85], v247 offset:39424
    v_mfma_f32_16x16x32_bf16 v[76:79], v[220:223], v[116:119], v[76:79]
    ds_read_b64_tr_b16 a[86:87], v247 offset:41472
    ds_read_b64_tr_b16 a[88:89], v244 offset:39424
    v_mfma_f32_16x16x32_bf16 v[64:67], a[0:3], v[120:123], v[64:67]
    ds_read_b64_tr_b16 a[90:91], v244 offset:41472
    ds_read_b64_tr_b16 a[92:93], v245 offset:39424
    v_mfma_f32_16x16x32_bf16 v[68:71], a[4:7], v[120:123], v[68:71]
    ds_read_b64_tr_b16 a[94:95], v245 offset:41472
    ds_read_b64_tr_b16 a[96:97], v244 offset:43008
    v_mfma_f32_16x16x32_bf16 v[72:75], a[8:11], v[120:123], v[72:75]
    s_waitcnt vmcnt(8)
    ds_read_b128 v[92:95], v25 offset:16384
    v_mfma_f32_16x16x32_bf16 v[76:79], a[12:15], v[120:123], v[76:79]
    ds_read_b64_tr_b16 a[98:99], v244 offset:45056
    ds_read_b64_tr_b16 a[100:101], v245 offset:43008
    v_mfma_f32_16x16x32_bf16 v[64:67], a[16:19], v[124:127], v[64:67]
    ds_read_b64_tr_b16 a[102:103], v245 offset:45056
    ds_read_b64_tr_b16 a[104:105], v246 offset:43008
    v_mfma_f32_16x16x32_bf16 v[68:71], a[20:23], v[124:127], v[68:71]
    ds_read_b64_tr_b16 a[106:107], v246 offset:45056
    ds_read_b64_tr_b16 a[108:109], v247 offset:43008
    v_mfma_f32_16x16x32_bf16 v[72:75], a[24:27], v[124:127], v[72:75]
    s_waitcnt vmcnt(7)
    ds_read_b128 v[96:99], v26 offset:16384
    v_mfma_f32_16x16x32_bf16 v[76:79], a[28:31], v[124:127], v[76:79]
    ds_read_b64_tr_b16 a[110:111], v247 offset:45056
    ds_read_b64_tr_b16 a[112:113], v246 offset:46592
    v_mfma_f32_16x16x32_bf16 v[64:67], a[32:35], v[128:131], v[64:67]
    ds_read_b64_tr_b16 a[114:115], v246 offset:48640
    ds_read_b64_tr_b16 a[116:117], v247 offset:46592
    v_mfma_f32_16x16x32_bf16 v[68:71], a[36:39], v[128:131], v[68:71]
    ds_read_b64_tr_b16 a[118:119], v247 offset:48640
    ds_read_b64_tr_b16 a[120:121], v244 offset:46592
    v_mfma_f32_16x16x32_bf16 v[72:75], a[40:43], v[128:131], v[72:75]
    s_waitcnt vmcnt(6)
    ds_read_b128 v[100:103], v27 offset:16384
    v_mfma_f32_16x16x32_bf16 v[76:79], a[44:47], v[128:131], v[76:79]
    ds_read_b64_tr_b16 a[122:123], v244 offset:48640
    ds_read_b64_tr_b16 a[124:125], v245 offset:46592
    v_mfma_f32_16x16x32_bf16 v[64:67], a[48:51], v[132:135], v[64:67]
    ds_read_b64_tr_b16 a[126:127], v245 offset:48640
    ds_read_b64_tr_b16 a[128:129], v244 offset:50176
    v_mfma_f32_16x16x32_bf16 v[68:71], a[52:55], v[132:135], v[68:71]
    ds_read_b64_tr_b16 a[130:131], v244 offset:52224
    ds_read_b64_tr_b16 a[132:133], v245 offset:50176
    v_mfma_f32_16x16x32_bf16 v[72:75], a[56:59], v[132:135], v[72:75]
    s_waitcnt vmcnt(5)
    ds_read_b128 v[104:107], v28 offset:16384
    v_mfma_f32_16x16x32_bf16 v[76:79], a[60:63], v[132:135], v[76:79]
    ds_read_b64_tr_b16 a[134:135], v245 offset:52224
    ds_read_b64_tr_b16 a[136:137], v246 offset:50176
    s_waitcnt lgkmcnt(15)
    v_mfma_f32_16x16x32_bf16 v[64:67], a[64:67], v[136:139], v[64:67]
    ds_read_b64_tr_b16 a[138:139], v246 offset:52224
    ds_read_b64_tr_b16 a[140:141], v247 offset:50176
    v_mfma_f32_16x16x32_bf16 v[68:71], a[68:71], v[136:139], v[68:71]
    ds_read_b64_tr_b16 a[142:143], v247 offset:52224
    ds_read_b64_tr_b16 a[144:145], v246 offset:53760
    v_mfma_f32_16x16x32_bf16 v[72:75], a[72:75], v[136:139], v[72:75]
    s_waitcnt vmcnt(4)
    v_mul_f32 v90, v110, v90
    v_mul_f32 v91, v111, v91
    v_mfma_f32_16x16x32_bf16 v[76:79], a[76:79], v[136:139], v[76:79]
    ds_read_b64_tr_b16 a[146:147], v246 offset:55808
    ds_read_b64_tr_b16 a[148:149], v247 offset:53760
    v_mfma_f32_16x16x32_bf16 v[64:67], a[80:83], v[140:143], v[64:67]
    ds_read_b64_tr_b16 a[150:151], v247 offset:55808
    ds_read_b64_tr_b16 a[152:153], v244 offset:53760
    v_mfma_f32_16x16x32_bf16 v[68:71], a[84:87], v[140:143], v[68:71]
    ds_read_b64_tr_b16 a[154:155], v244 offset:55808
    ds_read_b64_tr_b16 a[156:157], v245 offset:53760
    v_mfma_f32_16x16x32_bf16 v[72:75], a[88:91], v[140:143], v[72:75]
    s_waitcnt vmcnt(3)
    s_waitcnt lgkmcnt(12)
    v_add_f32 v92, v92, v96
    v_mfma_f32_16x16x32_bf16 v[76:79], a[92:95], v[140:143], v[76:79]
    ds_read_b64_tr_b16 a[158:159], v245 offset:55808
    v_add_f32 v93, v93, v97
    v_mfma_f32_16x16x32_bf16 v[64:67], a[96:99], v[144:147], v[64:67]
    s_waitcnt vmcnt(2)
    v_add_f32 v94, v94, v98
    v_add_f32 v95, v95, v99
    v_mfma_f32_16x16x32_bf16 v[68:71], a[100:103], v[144:147], v[68:71]
    v_add_f32 v92, v92, v100
    v_add_f32 v93, v93, v101
    v_mfma_f32_16x16x32_bf16 v[72:75], a[104:107], v[144:147], v[72:75]
    v_add_f32 v94, v94, v102
    v_add_f32 v95, v95, v103
    v_mfma_f32_16x16x32_bf16 v[76:79], a[108:111], v[144:147], v[76:79]
    v_add_f32 v92, v92, v104
    v_add_f32 v93, v93, v105
    v_mfma_f32_16x16x32_bf16 v[64:67], a[112:115], v[148:151], v[64:67]
    s_waitcnt vmcnt(1)
    v_add_f32 v94, v94, v106
    v_add_f32 v95, v95, v107
    v_mfma_f32_16x16x32_bf16 v[68:71], a[116:119], v[148:151], v[68:71]
    v_mul_f32 v108, 0xbfb8aa3b, v92
    v_mul_f32 v109, 0xbfb8aa3b, v93
    v_mfma_f32_16x16x32_bf16 v[72:75], a[120:123], v[148:151], v[72:75]
    v_mul_f32 v110, 0xbfb8aa3b, v94
    v_mul_f32 v111, 0xbfb8aa3b, v95
    v_mfma_f32_16x16x32_bf16 v[76:79], a[124:127], v[148:151], v[76:79]
    v_exp_f32 v108, v108
    s_waitcnt lgkmcnt(8)
    v_mfma_f32_16x16x32_bf16 v[64:67], a[128:131], v[152:155], v[64:67]
    s_waitcnt vmcnt(0)
    v_exp_f32 v109, v109
    v_mfma_f32_16x16x32_bf16 v[68:71], a[132:135], v[152:155], v[68:71]
    v_exp_f32 v110, v110
    v_mfma_f32_16x16x32_bf16 v[72:75], a[136:139], v[152:155], v[72:75]
    v_exp_f32 v111, v111
    v_mfma_f32_16x16x32_bf16 v[76:79], a[140:143], v[152:155], v[76:79]
    v_add_f32 v108, 1.0, v108
    v_add_f32 v109, 1.0, v109
    s_waitcnt lgkmcnt(0)
    v_mfma_f32_16x16x32_bf16 v[64:67], a[144:147], v[156:159], v[64:67]
    v_add_f32 v110, 1.0, v110
    v_add_f32 v111, 1.0, v111
    v_mfma_f32_16x16x32_bf16 v[68:71], a[148:151], v[156:159], v[68:71]
    v_rcp_f32 v108, v108
    v_mfma_f32_16x16x32_bf16 v[72:75], a[152:155], v[156:159], v[72:75]
    v_rcp_f32 v109, v109
    v_mfma_f32_16x16x32_bf16 v[76:79], a[156:159], v[156:159], v[76:79]
    v_rcp_f32 v110, v110
    v_rcp_f32 v111, v111
    v_mul_f32 v92, v108, v92
    v_mul_f32 v93, v109, v93
    v_mul_f32 v94, v110, v94
    v_mul_f32 v95, v111, v95
    v_pk_fma_f32 v[80:81], v[80:81], v[64:65], v[2:3]
    v_pk_fma_f32 v[82:83], v[82:83], v[66:67], v[4:5]
    v_cvt_pk_bf16_f32 v236, v80, v81
    v_cvt_pk_bf16_f32 v237, v82, v83
    ds_write_b64 v252, v[236:237]
    v_pk_fma_f32 v[84:85], v[84:85], v[68:69], v[6:7]
    v_pk_fma_f32 v[86:87], v[86:87], v[70:71], v[8:9]
    v_cvt_pk_bf16_f32 v238, v84, v85
    v_cvt_pk_bf16_f32 v239, v86, v87
    ds_write_b64 v253, v[238:239]
    v_pk_fma_f32 v[88:89], v[88:89], v[72:73], v[10:11]
    v_pk_fma_f32 v[90:91], v[90:91], v[74:75], v[12:13]
    v_cvt_pk_bf16_f32 v240, v88, v89
    v_cvt_pk_bf16_f32 v241, v90, v91
    ds_write_b64 v254, v[240:241]
    v_pk_fma_f32 v[92:93], v[92:93], v[76:77], v[14:15]
    v_pk_fma_f32 v[94:95], v[94:95], v[78:79], v[16:17]
    v_cvt_pk_bf16_f32 v242, v92, v93
    v_cvt_pk_bf16_f32 v243, v94, v95
    ds_write_b64 v255, v[242:243]
    ds_read_b128 v[32:35], v18
    ds_read_b64 v[36:37], v18 offset:1032
    ds_read_b64 v[38:39], v18 offset:1024
    s_waitcnt lgkmcnt(2)
    buffer_store_dwordx4 v[32:35], v225, s[36:39], s71 offen sc1
    s_waitcnt lgkmcnt(0)
    buffer_store_dwordx4 v[36:39], v225, s[36:39], s72 offen sc1
L_fin:
L_end:
    s_endpgm
L_m3:
    buffer_load_dwordx4 v5, s[20:23], s53 offen offset:3072 lds
    s_waitcnt vmcnt(9)
    ds_read_b64_tr_b16 a[208:209], v248 offset:16384
    ds_read_b64_tr_b16 a[210:211], v248 offset:18432
    s_waitcnt vmcnt(8)
    v_cmp_ne_u64 vcc, s[44:45], v[28:29]
    s_mov_b32 s65, 0
    s_cbranch_vccz L_polled_20
L_poll_19:
    buffer_load_dwordx2 v[28:29], v26, s[40:43], 0 offen sc1
    s_waitcnt vmcnt(0)
    v_cmp_ne_u64 vcc, s[44:45], v[28:29]
    s_add_u32 s65, s65, 1
    s_cbranch_vccz L_polled_20
    s_cmp_lt_u32 s65, 200000
    s_cbranch_scc1 L_poll_19
L_polled_20:
    v_lshlrev_b32 v12, 16, v24
    v_and_b32 v13, 0xffff0000, v24
    v_lshlrev_b32 v14, 16, v25
    v_and_b32 v15, 0xffff0000, v25
    buffer_load_dwordx4 v[112:115], v234, s[40:43], s56 offen sc1
    s_bfe_u32 s56, s55, 0x40004
    s_mul_i32 s56, s56, 59392
    s_add_u32 s56, s56, s57
    ds_read_b64_tr_b16 a[212:213], v249 offset:16384
    ds_read_b64_tr_b16 a[214:215], v249 offset:18432
    buffer_load_dwordx4 v[116:119], v234, s[40:43], s56 offen sc1
    s_bfe_u32 s56, s55, 0x40008
    s_mul_i32 s56, s56, 59392
    s_add_u32 s56, s56, s57
    ds_read_b64_tr_b16 a[216:217], v250 offset:16384
    ds_read_b64_tr_b16 a[218:219], v250 offset:18432
    buffer_load_dwordx4 v[120:123], v234, s[40:43], s56 offen sc1
    s_bfe_u32 s56, s55, 0x4000c
    s_mul_i32 s56, s56, 59392
    s_add_u32 s56, s56, s57
    ds_read_b64_tr_b16 a[220:221], v251 offset:16384
    ds_read_b64_tr_b16 a[222:223], v251 offset:18432
    buffer_load_dwordx4 v[124:127], v234, s[40:43], s56 offen sc1
    s_bfe_u32 s56, s55, 0x40010
    s_mul_i32 s56, s56, 59392
    s_add_u32 s56, s56, s57
    buffer_load_dwordx4 v[128:131], v234, s[40:43], s56 offen sc1
    s_bfe_u32 s56, s55, 0x40014
    s_mul_i32 s56, s56, 59392
    s_add_u32 s56, s56, s57
    s_waitcnt vmcnt(9)
    ds_read_b64_tr_b16 a[224:225], v248 offset:32768
    ds_read_b64_tr_b16 a[226:227], v248 offset:34816
    buffer_load_dwordx4 v[132:135], v234, s[40:43], s56 offen sc1
    s_bfe_u32 s56, s55, 0x40018
    s_mul_i32 s56, s56, 59392
    s_add_u32 s56, s56, s57
    ds_read_b64_tr_b16 a[228:229], v249 offset:32768
    ds_read_b64_tr_b16 a[230:231], v249 offset:34816
    buffer_load_dwordx4 v[136:139], v234, s[40:43], s56 offen sc1
    s_bfe_u32 s56, s55, 0x4001c
    s_mul_i32 s56, s56, 59392
    s_add_u32 s56, s56, s57
    ds_read_b64_tr_b16 a[232:233], v250 offset:32768
    ds_read_b64_tr_b16 a[234:235], v250 offset:34816
    buffer_load_dwordx4 v[140:143], v234, s[40:43], s56 offen sc1
    s_bfe_u32 s56, s58, 0x40000
    s_mul_i32 s56, s56, 59392
    s_add_u32 s56, s56, s57
    ds_read_b64_tr_b16 a[236:237], v251 offset:32768
    ds_read_b64_tr_b16 a[238:239], v251 offset:34816
    buffer_load_dwordx4 v[144:147], v234, s[40:43], s56 offen sc1
    s_bfe_u32 s56, s58, 0x40004
    s_mul_i32 s56, s56, 59392
    s_add_u32 s56, s56, s57
    s_waitcnt vmcnt(9)
    ds_read_b64_tr_b16 a[240:241], v248 offset:49152
    ds_read_b64_tr_b16 a[242:243], v248 offset:51200
    buffer_load_dwordx4 v[148:151], v234, s[40:43], s56 offen sc1
    s_bfe_u32 s56, s58, 0x40008
    s_mul_i32 s56, s56, 59392
    s_add_u32 s56, s56, s57
    ds_read_b64_tr_b16 a[244:245], v249 offset:49152
    ds_read_b64_tr_b16 a[246:247], v249 offset:51200
    buffer_load_dwordx4 v[152:155], v234, s[40:43], s56 offen sc1
    s_bfe_u32 s56, s58, 0x4000c
    s_mul_i32 s56, s56, 59392
    s_add_u32 s56, s56, s57
    ds_read_b64_tr_b16 a[248:249], v250 offset:49152
    ds_read_b64_tr_b16 a[250:251], v250 offset:51200
    buffer_load_dwordx4 v[156:159], v234, s[40:43], s56 offen sc1
    ds_read_b64_tr_b16 a[252:253], v251 offset:49152
    ds_read_b64_tr_b16 a[254:255], v251 offset:51200
    s_waitcnt vmcnt(11)
    v_mfma_f32_16x16x32_bf16 v[36:39], a[4:7], v[112:115], 0
    s_bfe_u32 s56, s58, 0x40010
    v_and_b32 v29, 7, v1
    v_bfe_u32 v31, v1, 3, 1
    v_mfma_f32_16x16x32_bf16 v[40:43], a[8:11], v[112:115], 0
    s_mul_i32 s56, s56, 59392
    v_lshl_add_u32 v29, v29, 1, v31
    s_lshr_b32 s74, s52, 1
    v_mfma_f32_16x16x32_bf16 v[44:47], a[12:15], v[112:115], 0
    s_add_u32 s56, s56, s57
    s_waitcnt vmcnt(10)
    s_add_u32 s74, s74, 149504
    v_mfma_f32_16x16x32_bf16 v[32:35], a[0:3], v[112:115], v[12:15]
    buffer_load_dwordx4 v[112:115], v234, s[40:43], s56 offen sc1
    v_mfma_f32_16x16x32_bf16 v[36:39], a[20:23], v[116:119], v[36:39]
    s_bfe_u32 s56, s58, 0x40014
    v_add_u32 v18, s74, v231
    v_lshl_add_u32 v31, v29, 7, s74
    v_mfma_f32_16x16x32_bf16 v[40:43], a[24:27], v[116:119], v[40:43]
    s_mul_i32 s56, s56, 59392
    v_lshrrev_b32 v28, 4, v1
    v_bfe_u32 v16, v29, 1, 2
    v_mfma_f32_16x16x32_bf16 v[44:47], a[28:31], v[116:119], v[44:47]
    s_add_u32 s56, s56, s57
    s_waitcnt vmcnt(10)
    v_lshl_add_u32 v16, v16, 2, v28
    v_mfma_f32_16x16x32_bf16 v[32:35], a[16:19], v[116:119], v[32:35]
    buffer_load_dwordx4 v[116:119], v234, s[40:43], s56 offen sc1
    v_mfma_f32_16x16x32_bf16 v[36:39], a[36:39], v[120:123], v[36:39]
    s_bfe_u32 s56, s58, 0x40018
    v_lshl_add_u32 v16, v16, 3, v31
    v_and_b32 v19, 7, v29
    v_mfma_f32_16x16x32_bf16 v[40:43], a[40:43], v[120:123], v[40:43]
    s_mul_i32 s56, s56, 59392
    v_lshrrev_b32 v29, 3, v29
    v_lshl_or_b32 v19, v19, 1, v29
    v_mfma_f32_16x16x32_bf16 v[44:47], a[44:47], v[120:123], v[44:47]
    s_add_u32 s56, s56, s57
    s_waitcnt vmcnt(10)
    v_xor_b32 v19, v19, v28
    v_mfma_f32_16x16x32_bf16 v[32:35], a[32:35], v[120:123], v[32:35]
    buffer_load_dwordx4 v[120:123], v234, s[40:43], s56 offen sc1
    v_mfma_f32_16x16x32_bf16 v[36:39], a[52:55], v[124:127], v[36:39]
    s_bfe_u32 s56, s58, 0x4001c
    v_lshl_add_u32 v19, v19, 3, v31
    v_and_b32 v29, 8, v1
    v_mfma_f32_16x16x32_bf16 v[40:43], a[56:59], v[124:127], v[40:43]
    s_mul_i32 s56, s56, 59392
    v_lshlrev_b32 v29, 1, v29
    v_xor_b32 v225, v224, v29
    v_mfma_f32_16x16x32_bf16 v[44:47], a[60:63], v[124:127], v[44:47]
    s_add_u32 s56, s56, s57
    s_waitcnt vmcnt(10)
    v_add_u32 v24, s52, v231
    v_mfma_f32_16x16x32_bf16 v[32:35], a[48:51], v[124:127], v[32:35]
    buffer_load_dwordx4 v[124:127], v234, s[40:43], s56 offen sc1
    v_mfma_f32_16x16x32_bf16 v[36:39], a[68:71], v[128:131], v[36:39]
    s_bfe_u32 s56, s55, 0x40000
    v_and_b32 v29, 7, v1
    v_bfe_u32 v28, v1, 3, 1
    v_mfma_f32_16x16x32_bf16 v[40:43], a[72:75], v[128:131], v[40:43]
    s_mul_i32 s56, s56, 59392
    v_lshl_add_u32 v29, v29, 1, v28
    v_and_b32 v28, 48, v1
    v_mfma_f32_16x16x32_bf16 v[44:47], a[76:79], v[128:131], v[44:47]
    s_add_u32 s56, s56, s57
    s_waitcnt vmcnt(10)
    v_add_lshl_u32 v29, v29, v28, 4
    v_mfma_f32_16x16x32_bf16 v[32:35], a[64:67], v[128:131], v[32:35]
    buffer_load_dwordx4 v[128:131], v234, s[40:43], s56 offen offset:2048 sc1
    v_mfma_f32_16x16x32_bf16 v[36:39], a[84:87], v[132:135], v[36:39]
    s_bfe_u32 s56, s55, 0x40004
    s_sub_u32 s74, s3, 0
    s_and_b32 s74, s74, 3
    v_mfma_f32_16x16x32_bf16 v[40:43], a[88:91], v[132:135], v[40:43]
    s_mul_i32 s56, s56, 59392
    s_lshl_b32 s74, s74, 12
    s_add_u32 s74, s74, 0
    v_mfma_f32_16x16x32_bf16 v[44:47], a[92:95], v[132:135], v[44:47]
    s_add_u32 s56, s56, s57
    s_waitcnt vmcnt(10)
    v_add_u32 v25, s74, v29
    v_mfma_f32_16x16x32_bf16 v[32:35], a[80:83], v[132:135], v[32:35]
    buffer_load_dwordx4 v[132:135], v234, s[40:43], s56 offen offset:2048 sc1
    v_mfma_f32_16x16x32_bf16 v[36:39], a[100:103], v[136:139], v[36:39]
    s_bfe_u32 s56, s55, 0x40008
    s_sub_u32 s74, s3, 1
    s_and_b32 s74, s74, 3
    v_mfma_f32_16x16x32_bf16 v[40:43], a[104:107], v[136:139], v[40:43]
    s_mul_i32 s56, s56, 59392
    s_lshl_b32 s74, s74, 12
    s_add_u32 s74, s74, 1024
    v_mfma_f32_16x16x32_bf16 v[44:47], a[108:111], v[136:139], v[44:47]
    s_add_u32 s56, s56, s57
    s_waitcnt vmcnt(10)
    v_add_u32 v26, s74, v29
    v_mfma_f32_16x16x32_bf16 v[32:35], a[96:99], v[136:139], v[32:35]
    buffer_load_dwordx4 v[136:139], v234, s[40:43], s56 offen offset:2048 sc1
    v_mfma_f32_16x16x32_bf16 v[36:39], a[116:119], v[140:143], v[36:39]
    s_bfe_u32 s56, s55, 0x4000c
    s_sub_u32 s74, s3, 2
    s_and_b32 s74, s74, 3
    v_mfma_f32_16x16x32_bf16 v[40:43], a[120:123], v[140:143], v[40:43]
    s_mul_i32 s56, s56, 59392
    s_lshl_b32 s74, s74, 12
    s_add_u32 s74, s74, 2048
    v_mfma_f32_16x16x32_bf16 v[44:47], a[124:127], v[140:143], v[44:47]
    s_add_u32 s56, s56, s57
    s_waitcnt vmcnt(10)
    v_add_u32 v27, s74, v29
    v_mfma_f32_16x16x32_bf16 v[32:35], a[112:115], v[140:143], v[32:35]
    buffer_load_dwordx4 v[140:143], v234, s[40:43], s56 offen offset:2048 sc1
    v_mfma_f32_16x16x32_bf16 v[36:39], a[132:135], v[144:147], v[36:39]
    s_bfe_u32 s56, s55, 0x40010
    s_sub_u32 s74, s3, 3
    s_and_b32 s74, s74, 3
    v_mfma_f32_16x16x32_bf16 v[40:43], a[136:139], v[144:147], v[40:43]
    s_mul_i32 s56, s56, 59392
    s_lshl_b32 s74, s74, 12
    s_add_u32 s74, s74, 3072
    v_mfma_f32_16x16x32_bf16 v[44:47], a[140:143], v[144:147], v[44:47]
    s_add_u32 s56, s56, s57
    s_waitcnt vmcnt(10)
    v_add_u32 v28, s74, v29
    v_mfma_f32_16x16x32_bf16 v[32:35], a[128:131], v[144:147], v[32:35]
    buffer_load_dwordx4 v[144:147], v234, s[40:43], s56 offen offset:2048 sc1
    v_mfma_f32_16x16x32_bf16 v[36:39], a[148:151], v[148:151], v[36:39]
    s_bfe_u32 s56, s55, 0x40014
    s_mul_i32 s56, s56, 59392
    s_add_u32 s56, s56, s57
    v_mfma_f32_16x16x32_bf16 v[40:43], a[152:155], v[148:151], v[40:43]
    s_waitcnt vmcnt(10)
    v_mfma_f32_16x16x32_bf16 v[44:47], a[156:159], v[148:151], v[44:47]
    v_mfma_f32_16x16x32_bf16 v[32:35], a[144:147], v[148:151], v[32:35]
    buffer_load_dwordx4 v[148:151], v234, s[40:43], s56 offen offset:2048 sc1
    v_mfma_f32_16x16x32_bf16 v[36:39], a[164:167], v[152:155], v[36:39]
    s_bfe_u32 s56, s55, 0x40018
    s_mul_i32 s56, s56, 59392
    s_add_u32 s56, s56, s57
    v_mfma_f32_16x16x32_bf16 v[40:43], a[168:171], v[152:155], v[40:43]
    s_waitcnt vmcnt(10)
    v_mfma_f32_16x16x32_bf16 v[44:47], a[172:175], v[152:155], v[44:47]
    v_mfma_f32_16x16x32_bf16 v[32:35], a[160:163], v[152:155], v[32:35]
    buffer_load_dwordx4 v[152:155], v234, s[40:43], s56 offen offset:2048 sc1
    v_mfma_f32_16x16x32_bf16 v[36:39], a[180:183], v[156:159], v[36:39]
    s_bfe_u32 s56, s55, 0x4001c
    s_mul_i32 s56, s56, 59392
    s_add_u32 s56, s56, s57
    v_mfma_f32_16x16x32_bf16 v[40:43], a[184:187], v[156:159], v[40:43]
    s_waitcnt vmcnt(10)
    v_mfma_f32_16x16x32_bf16 v[44:47], a[188:191], v[156:159], v[44:47]
    v_mfma_f32_16x16x32_bf16 v[32:35], a[176:179], v[156:159], v[32:35]
    buffer_load_dwordx4 v[156:159], v234, s[40:43], s56 offen offset:2048 sc1
    s_waitcnt lgkmcnt(15)
    v_mfma_f32_16x16x32_bf16 v[36:39], a[196:199], v[112:115], v[36:39]
    s_bfe_u32 s56, s58, 0x40000
    s_mul_i32 s56, s56, 59392
    s_add_u32 s56, s56, s57
    v_mfma_f32_16x16x32_bf16 v[40:43], a[200:203], v[112:115], v[40:43]
    s_waitcnt vmcnt(10)
    v_mfma_f32_16x16x32_bf16 v[44:47], a[204:207], v[112:115], v[44:47]
    v_mfma_f32_16x16x32_bf16 v[32:35], a[192:195], v[112:115], v[32:35]
    buffer_load_dwordx4 v[112:115], v234, s[40:43], s56 offen offset:2048 sc1
    v_mfma_f32_16x16x32_bf16 v[36:39], a[212:215], v[116:119], v[36:39]
    s_bfe_u32 s56, s58, 0x40004
    s_mul_i32 s56, s56, 59392
    s_add_u32 s56, s56, s57
    v_mfma_f32_16x16x32_bf16 v[40:43], a[216:219], v[116:119], v[40:43]
    s_waitcnt vmcnt(10)
    v_mfma_f32_16x16x32_bf16 v[44:47], a[220:223], v[116:119], v[44:47]
    v_mfma_f32_16x16x32_bf16 v[32:35], a[208:211], v[116:119], v[32:35]
    buffer_load_dwordx4 v[116:119], v234, s[40:43], s56 offen offset:2048 sc1
    s_waitcnt lgkmcnt(8)
    v_mfma_f32_16x16x32_bf16 v[36:39], a[228:231], v[120:123], v[36:39]
    s_bfe_u32 s56, s58, 0x40008
    s_mul_i32 s56, s56, 59392
    s_add_u32 s56, s56, s57
    v_mfma_f32_16x16x32_bf16 v[40:43], a[232:235], v[120:123], v[40:43]
    s_waitcnt vmcnt(10)
    v_mfma_f32_16x16x32_bf16 v[44:47], a[236:239], v[120:123], v[44:47]
    v_mfma_f32_16x16x32_bf16 v[32:35], a[224:227], v[120:123], v[32:35]
    buffer_load_dwordx4 v[120:123], v234, s[40:43], s56 offen offset:2048 sc1
    s_waitcnt lgkmcnt(0)
    v_mfma_f32_16x16x32_bf16 v[36:39], a[244:247], v[124:127], v[36:39]
    s_bfe_u32 s56, s58, 0x4000c
    s_mul_i32 s56, s56, 59392
    s_add_u32 s56, s56, s57
    v_mfma_f32_16x16x32_bf16 v[40:43], a[248:251], v[124:127], v[40:43]
    s_waitcnt vmcnt(10)
    v_mfma_f32_16x16x32_bf16 v[44:47], a[252:255], v[124:127], v[44:47]
    v_mfma_f32_16x16x32_bf16 v[32:35], a[240:243], v[124:127], v[32:35]
    buffer_load_dwordx4 v[124:127], v234, s[40:43], s56 offen offset:2048 sc1
    v_mfma_f32_16x16x32_bf16 v[52:55], a[4:7], v[128:131], 0
    s_bfe_u32 s56, s58, 0x40010
    s_mul_i32 s56, s56, 59392
    s_add_u32 s56, s56, s57
    v_mfma_f32_16x16x32_bf16 v[56:59], a[8:11], v[128:131], 0
    s_waitcnt vmcnt(10)
    v_mfma_f32_16x16x32_bf16 v[60:63], a[12:15], v[128:131], 0
    ds_write_b128 v6, v[36:39] offset:0
    v_mfma_f32_16x16x32_bf16 v[48:51], a[0:3], v[128:131], v[12:15]
    buffer_load_dwordx4 v[128:131], v234, s[40:43], s56 offen offset:2048 sc1
    v_mfma_f32_16x16x32_bf16 v[52:55], a[20:23], v[132:135], v[52:55]
    s_bfe_u32 s56, s58, 0x40014
    s_mul_i32 s56, s56, 59392
    s_add_u32 s56, s56, s57
    v_mfma_f32_16x16x32_bf16 v[56:59], a[24:27], v[132:135], v[56:59]
    ds_write_b128 v6, v[40:43] offset:1024
    v_mfma_f32_16x16x32_bf16 v[60:63], a[28:31], v[132:135], v[60:63]
    s_waitcnt vmcnt(10)
    v_mfma_f32_16x16x32_bf16 v[48:51], a[16:19], v[132:135], v[48:51]
    buffer_load_dwordx4 v[132:135], v234, s[40:43], s56 offen offset:2048 sc1
    v_mfma_f32_16x16x32_bf16 v[52:55], a[36:39], v[136:139], v[52:55]
    ds_write_b128 v6, v[44:47] offset:2048
    v_mfma_f32_16x16x32_bf16 v[56:59], a[40:43], v[136:139], v[56:59]
    s_bfe_u32 s56, s58, 0x40018
    s_mul_i32 s56, s56, 59392
    s_add_u32 s56, s56, s57
    v_mfma_f32_16x16x32_bf16 v[60:63], a[44:47], v[136:139], v[60:63]
    s_waitcnt vmcnt(10)
    v_mfma_f32_16x16x32_bf16 v[48:51], a[32:35], v[136:139], v[48:51]
    buffer_load_dwordx4 v[136:139], v234, s[40:43], s56 offen offset:2048 sc1
    v_mfma_f32_16x16x32_bf16 v[52:55], a[52:55], v[140:143], v[52:55]
    s_bfe_u32 s56, s58, 0x4001c
    s_mul_i32 s56, s56, 59392
    s_add_u32 s56, s56, s57
    v_mfma_f32_16x16x32_bf16 v[56:59], a[56:59], v[140:143], v[56:59]
    s_waitcnt lgkmcnt(0)
    s_barrier
    v_mfma_f32_16x16x32_bf16 v[60:63], a[60:63], v[140:143], v[60:63]
    s_waitcnt vmcnt(10)
    ds_read_b128 v[64:67], v7 offset:0
    v_mfma_f32_16x16x32_bf16 v[48:51], a[48:51], v[140:143], v[48:51]
    buffer_load_dwordx4 v[140:143], v234, s[40:43], s56 offen offset:2048 sc1
    v_mfma_f32_16x16x32_bf16 v[52:55], a[68:71], v[144:147], v[52:55]
    s_bfe_u32 s56, s55, 0x40000
    ds_read_b128 v[68:71], v8 offset:0
    v_mfma_f32_16x16x32_bf16 v[56:59], a[72:75], v[144:147], v[56:59]
    s_mul_i32 s56, s56, 59392
    ds_read_b128 v[72:75], v9 offset:0
    v_mfma_f32_16x16x32_bf16 v[60:63], a[76:79], v[144:147], v[60:63]
    s_add_u32 s56, s56, s57
    s_waitcnt vmcnt(10)
    v_mfma_f32_16x16x32_bf16 v[48:51], a[64:67], v[144:147], v[48:51]
    buffer_load_dwordx4 v[144:147], v235, s[40:43], s56 offen sc1
    v_mfma_f32_16x16x32_bf16 v[52:55], a[84:87], v[148:151], v[52:55]
    s_bfe_u32 s56, s55, 0x40004
    s_mul_i32 s56, s56, 59392
    s_add_u32 s56, s56, s57
    v_mfma_f32_16x16x32_bf16 v[56:59], a[88:91], v[148:151], v[56:59]
    s_waitcnt vmcnt(10)
    v_mfma_f32_16x16x32_bf16 v[60:63], a[92:95], v[148:151], v[60:63]
    s_waitcnt lgkmcnt(0)
    v_add_f32 v92, v32, v64
    v_add_f32 v93, v33, v65
    v_mfma_f32_16x16x32_bf16 v[48:51], a[80:83], v[148:151], v[48:51]
    buffer_load_dwordx4 v[148:151], v235, s[40:43], s56 offen sc1
    v_mfma_f32_16x16x32_bf16 v[52:55], a[100:103], v[152:155], v[52:55]
    s_bfe_u32 s56, s55, 0x40008
    v_add_f32 v94, v34, v66
    v_add_f32 v95, v35, v67
    v_mfma_f32_16x16x32_bf16 v[56:59], a[104:107], v[152:155], v[56:59]
    s_mul_i32 s56, s56, 59392
    v_add_f32 v92, v92, v68
    v_add_f32 v93, v93, v69
    v_mfma_f32_16x16x32_bf16 v[60:63], a[108:111], v[152:155], v[60:63]
    s_add_u32 s56, s56, s57
    s_waitcnt vmcnt(10)
    v_add_f32 v94, v94, v70
    v_mfma_f32_16x16x32_bf16 v[48:51], a[96:99], v[152:155], v[48:51]
    buffer_load_dwordx4 v[152:155], v235, s[40:43], s56 offen sc1
    v_mfma_f32_16x16x32_bf16 v[52:55], a[116:119], v[156:159], v[52:55]
    s_bfe_u32 s56, s55, 0x4000c
    v_add_f32 v95, v95, v71
    v_add_f32 v92, v92, v72
    v_mfma_f32_16x16x32_bf16 v[56:59], a[120:123], v[156:159], v[56:59]
    s_mul_i32 s56, s56, 59392
    v_add_f32 v93, v93, v73
    v_add_f32 v94, v94, v74
    v_mfma_f32_16x16x32_bf16 v[60:63], a[124:127], v[156:159], v[60:63]
    s_add_u32 s56, s56, s57
    s_waitcnt vmcnt(10)
    v_add_f32 v95, v95, v75
    v_mfma_f32_16x16x32_bf16 v[48:51], a[112:115], v[156:159], v[48:51]
    buffer_load_dwordx4 v[156:159], v235, s[40:43], s56 offen sc1
    v_mfma_f32_16x16x32_bf16 v[52:55], a[132:135], v[112:115], v[52:55]
    s_bfe_u32 s56, s55, 0x40010
    v_mul_f32 v76, v92, v92
    v_mul_f32 v77, v93, v93
    v_mfma_f32_16x16x32_bf16 v[56:59], a[136:139], v[112:115], v[56:59]
    s_mul_i32 s56, s56, 59392
    v_mul_f32 v78, v94, v94
    v_mul_f32 v79, v95, v95
    v_mfma_f32_16x16x32_bf16 v[60:63], a[140:143], v[112:115], v[60:63]
    s_add_u32 s56, s56, s57
    s_waitcnt vmcnt(10)
    v_fma_f32 v76, v76, s1, v30
    v_mfma_f32_16x16x32_bf16 v[48:51], a[128:131], v[112:115], v[48:51]
    buffer_load_dwordx4 v[112:115], v235, s[40:43], s56 offen sc1
    v_mfma_f32_16x16x32_bf16 v[52:55], a[148:151], v[116:119], v[52:55]
    s_bfe_u32 s56, s55, 0x40014
    v_fma_f32 v77, v77, s1, v30
    v_fma_f32 v78, v78, s1, v30
    v_mfma_f32_16x16x32_bf16 v[56:59], a[152:155], v[116:119], v[56:59]
    s_mul_i32 s56, s56, 59392
    v_fma_f32 v79, v79, s1, v30
    v_mul_f32 v76, v76, v92
    v_mfma_f32_16x16x32_bf16 v[60:63], a[156:159], v[116:119], v[60:63]
    s_add_u32 s56, s56, s57
    s_waitcnt vmcnt(10)
    v_mul_f32 v77, v77, v93
    v_mfma_f32_16x16x32_bf16 v[48:51], a[144:147], v[116:119], v[48:51]
    buffer_load_dwordx4 v[116:119], v235, s[40:43], s56 offen sc1
    v_mfma_f32_16x16x32_bf16 v[52:55], a[164:167], v[120:123], v[52:55]
    s_bfe_u32 s56, s55, 0x40018
    v_mul_f32 v78, v78, v94
    v_mul_f32 v79, v79, v95
    v_mfma_f32_16x16x32_bf16 v[56:59], a[168:171], v[120:123], v[56:59]
    s_mul_i32 s56, s56, 59392
    v_exp_f32 v76, v76
    v_mfma_f32_16x16x32_bf16 v[60:63], a[172:175], v[120:123], v[60:63]
    s_add_u32 s56, s56, s57
    s_waitcnt vmcnt(10)
    v_mfma_f32_16x16x32_bf16 v[48:51], a[160:163], v[120:123], v[48:51]
    buffer_load_dwordx4 v[120:123], v235, s[40:43], s56 offen sc1
    v_mfma_f32_16x16x32_bf16 v[52:55], a[180:183], v[124:127], v[52:55]
    s_bfe_u32 s56, s55, 0x4001c
    v_exp_f32 v77, v77
    v_mfma_f32_16x16x32_bf16 v[56:59], a[184:187], v[124:127], v[56:59]
    s_mul_i32 s56, s56, 59392
    v_exp_f32 v78, v78
    v_mfma_f32_16x16x32_bf16 v[60:63], a[188:191], v[124:127], v[60:63]
    s_add_u32 s56, s56, s57
    s_waitcnt vmcnt(10)
    v_mfma_f32_16x16x32_bf16 v[48:51], a[176:179], v[124:127], v[48:51]
    buffer_load_dwordx4 v[124:127], v235, s[40:43], s56 offen sc1
    v_mfma_f32_16x16x32_bf16 v[52:55], a[196:199], v[128:131], v[52:55]
L_pad_6:
    s_cbranch_execz L_ret
    s_bfe_u32 s56, s58, 0x40000
    v_exp_f32 v79, v79
    v_mfma_f32_16x16x32_bf16 v[56:59], a[200:203], v[128:131], v[56:59]
    s_mul_i32 s56, s56, 59392
    v_add_f32 v76, 1.0, v76
    v_add_f32 v77, 1.0, v77
    v_mfma_f32_16x16x32_bf16 v[60:63], a[204:207], v[128:131], v[60:63]
    s_add_u32 s56, s56, s57
    s_waitcnt vmcnt(10)
    v_add_f32 v78, 1.0, v78
    v_mfma_f32_16x16x32_bf16 v[48:51], a[192:195], v[128:131], v[48:51]
    buffer_load_dwordx4 v[128:131], v235, s[40:43], s56 offen sc1
    v_mfma_f32_16x16x32_bf16 v[52:55], a[212:215], v[132:135], v[52:55]
    s_bfe_u32 s56, s58, 0x40004
    v_add_f32 v79, 1.0, v79
    s_mul_i32 s56, s56, 59392
    v_mfma_f32_16x16x32_bf16 v[56:59], a[216:219], v[132:135], v[56:59]
    s_add_u32 s56, s56, s57
    v_rcp_f32 v76, v76
    v_mfma_f32_16x16x32_bf16 v[60:63], a[220:223], v[132:135], v[60:63]
    s_waitcnt vmcnt(10)
    v_rcp_f32 v77, v77
    v_mfma_f32_16x16x32_bf16 v[48:51], a[208:211], v[132:135], v[48:51]
    buffer_load_dwordx4 v[132:135], v235, s[40:43], s56 offen sc1
    v_mfma_f32_16x16x32_bf16 v[52:55], a[228:231], v[136:139], v[52:55]
    s_bfe_u32 s56, s58, 0x40008
    v_rcp_f32 v78, v78
    v_mfma_f32_16x16x32_bf16 v[56:59], a[232:235], v[136:139], v[56:59]
    s_mul_i32 s56, s56, 59392
    v_rcp_f32 v79, v79
    v_mfma_f32_16x16x32_bf16 v[60:63], a[236:239], v[136:139], v[60:63]
    s_add_u32 s56, s56, s57
    s_waitcnt vmcnt(10)
    v_mul_f32 v76, v76, v92
    v_mfma_f32_16x16x32_bf16 v[48:51], a[224:227], v[136:139], v[48:51]
    buffer_load_dwordx4 v[136:139], v235, s[40:43], s56 offen sc1
    v_mfma_f32_16x16x32_bf16 v[52:55], a[244:247], v[140:143], v[52:55]
    s_bfe_u32 s56, s58, 0x4000c
    v_mul_f32 v77, v77, v93
    v_mul_f32 v78, v78, v94
    v_mfma_f32_16x16x32_bf16 v[56:59], a[248:251], v[140:143], v[56:59]
    s_mul_i32 s56, s56, 59392
    v_mul_f32 v79, v79, v95
    v_cvt_pk_bf16_f32 v80, v76, v77
    v_mfma_f32_16x16x32_bf16 v[60:63], a[252:255], v[140:143], v[60:63]
    s_add_u32 s56, s56, s57
    s_waitcnt vmcnt(10)
    v_cvt_pk_bf16_f32 v81, v78, v79
    v_mfma_f32_16x16x32_bf16 v[48:51], a[240:243], v[140:143], v[48:51]
    buffer_load_dwordx4 v[140:143], v235, s[40:43], s56 offen sc1
    v_mfma_f32_16x16x32_bf16 v[36:39], a[4:7], v[144:147], 0
    s_bfe_u32 s56, s58, 0x40010
    s_mul_i32 s56, s56, 59392
    s_add_u32 s56, s56, s57
    v_mfma_f32_16x16x32_bf16 v[40:43], a[8:11], v[144:147], 0
    s_waitcnt vmcnt(10)
    v_mfma_f32_16x16x32_bf16 v[44:47], a[12:15], v[144:147], 0
    ds_write_b128 v6, v[52:55] offset:12288
    v_mfma_f32_16x16x32_bf16 v[32:35], a[0:3], v[144:147], v[12:15]
    buffer_load_dwordx4 v[144:147], v235, s[40:43], s56 offen sc1
    v_mfma_f32_16x16x32_bf16 v[36:39], a[20:23], v[148:151], v[36:39]
    s_bfe_u32 s56, s58, 0x40014
    s_mul_i32 s56, s56, 59392
    s_add_u32 s56, s56, s57
    v_mfma_f32_16x16x32_bf16 v[40:43], a[24:27], v[148:151], v[40:43]
    ds_write_b128 v6, v[56:59] offset:13312
    v_mfma_f32_16x16x32_bf16 v[44:47], a[28:31], v[148:151], v[44:47]
    s_waitcnt vmcnt(10)
    v_mfma_f32_16x16x32_bf16 v[32:35], a[16:19], v[148:151], v[32:35]
    buffer_load_dwordx4 v[148:151], v235, s[40:43], s56 offen sc1
    v_mfma_f32_16x16x32_bf16 v[36:39], a[36:39], v[152:155], v[36:39]
    ds_write_b128 v6, v[60:63] offset:14336
    v_mfma_f32_16x16x32_bf16 v[40:43], a[40:43], v[152:155], v[40:43]
    s_bfe_u32 s56, s58, 0x40018
    s_mul_i32 s56, s56, 59392
    s_add_u32 s56, s56, s57
    v_mfma_f32_16x16x32_bf16 v[44:47], a[44:47], v[152:155], v[44:47]
    s_waitcnt vmcnt(10)
    v_mfma_f32_16x16x32_bf16 v[32:35], a[32:35], v[152:155], v[32:35]
    buffer_load_dwordx4 v[152:155], v235, s[40:43], s56 offen sc1
    v_mfma_f32_16x16x32_bf16 v[36:39], a[52:55], v[156:159], v[36:39]
    s_bfe_u32 s56, s58, 0x4001c
    s_mul_i32 s56, s56, 59392
    s_add_u32 s56, s56, s57
    v_mfma_f32_16x16x32_bf16 v[40:43], a[56:59], v[156:159], v[40:43]
    s_waitcnt lgkmcnt(0)
    s_barrier
    v_mfma_f32_16x16x32_bf16 v[44:47], a[60:63], v[156:159], v[44:47]
    s_waitcnt vmcnt(10)
    ds_read_b128 v[64:67], v7 offset:12288
    v_mfma_f32_16x16x32_bf16 v[32:35], a[48:51], v[156:159], v[32:35]
    buffer_load_dwordx4 v[156:159], v235, s[40:43], s56 offen sc1
    v_mfma_f32_16x16x32_bf16 v[36:39], a[68:71], v[112:115], v[36:39]
    s_waitcnt vmcnt(10)
    ds_read_b128 v[68:71], v8 offset:12288
    v_mfma_f32_16x16x32_bf16 v[40:43], a[72:75], v[112:115], v[40:43]
    ds_read_b128 v[72:75], v9 offset:12288
    v_mfma_f32_16x16x32_bf16 v[44:47], a[76:79], v[112:115], v[44:47]
    v_mfma_f32_16x16x32_bf16 v[32:35], a[64:67], v[112:115], v[32:35]
    buffer_load_ushort v227, v226, s[32:35], s72 offen
    v_mfma_f32_16x16x32_bf16 v[36:39], a[84:87], v[116:119], v[36:39]
    s_waitcnt vmcnt(10)
    v_mfma_f32_16x16x32_bf16 v[40:43], a[88:91], v[116:119], v[40:43]
    v_mfma_f32_16x16x32_bf16 v[44:47], a[92:95], v[116:119], v[44:47]
    s_waitcnt lgkmcnt(0)
    v_add_f32 v96, v48, v64
    v_add_f32 v97, v49, v65
    v_mfma_f32_16x16x32_bf16 v[32:35], a[80:83], v[116:119], v[32:35]
    s_lshr_b32 m0, s52, 1
    s_add_u32 m0, m0, 149504
    s_nop 0
    buffer_load_dwordx4 v224, s[8:11], s71 offen lds
    v_mfma_f32_16x16x32_bf16 v[36:39], a[100:103], v[120:123], v[36:39]
    s_waitcnt vmcnt(10)
    v_add_f32 v98, v50, v66
    v_add_f32 v99, v51, v67
    v_mfma_f32_16x16x32_bf16 v[40:43], a[104:107], v[120:123], v[40:43]
    v_add_f32 v96, v96, v68
    v_add_f32 v97, v97, v69
    v_mfma_f32_16x16x32_bf16 v[44:47], a[108:111], v[120:123], v[44:47]
    v_add_f32 v98, v98, v70
    v_add_f32 v99, v99, v71
    v_mfma_f32_16x16x32_bf16 v[32:35], a[96:99], v[120:123], v[32:35]
    s_lshr_b32 m0, s52, 1
    s_add_u32 m0, m0, 150528
    s_add_u32 s72, s71, 7168
    buffer_load_dwordx4 v224, s[8:11], s72 offen lds
    v_mfma_f32_16x16x32_bf16 v[36:39], a[116:119], v[124:127], v[36:39]
    s_waitcnt vmcnt(10)
    v_add_f32 v96, v96, v72
    v_add_f32 v97, v97, v73
    v_mfma_f32_16x16x32_bf16 v[40:43], a[120:123], v[124:127], v[40:43]
    v_add_f32 v98, v98, v74
    v_add_f32 v99, v99, v75
    v_mfma_f32_16x16x32_bf16 v[44:47], a[124:127], v[124:127], v[44:47]
    v_mul_f32 v76, v96, v96
    v_mul_f32 v77, v97, v97
    v_mfma_f32_16x16x32_bf16 v[32:35], a[112:115], v[124:127], v[32:35]
    s_add_u32 m0, s52, 0
    s_nop 0
    buffer_load_dwordx4 v252, s[24:27], s59 offen lds
    v_mfma_f32_16x16x32_bf16 v[36:39], a[132:135], v[128:131], v[36:39]
    s_waitcnt vmcnt(10)
    v_mul_f32 v78, v98, v98
    v_mul_f32 v79, v99, v99
    v_mfma_f32_16x16x32_bf16 v[40:43], a[136:139], v[128:131], v[40:43]
    v_fma_f32 v76, v76, s1, v30
    v_fma_f32 v77, v77, s1, v30
    v_mfma_f32_16x16x32_bf16 v[44:47], a[140:143], v[128:131], v[44:47]
    v_fma_f32 v78, v78, s1, v30
    v_fma_f32 v79, v79, s1, v30
    v_mfma_f32_16x16x32_bf16 v[32:35], a[128:131], v[128:131], v[32:35]
    buffer_load_dwordx4 v253, s[24:27], s59 offen offset:1024 lds
    v_mfma_f32_16x16x32_bf16 v[36:39], a[148:151], v[132:135], v[36:39]
    s_waitcnt vmcnt(10)
    v_mul_f32 v76, v76, v96
    v_mul_f32 v77, v77, v97
    v_mfma_f32_16x16x32_bf16 v[40:43], a[152:155], v[132:135], v[40:43]
    v_mul_f32 v78, v78, v98
    v_mul_f32 v79, v79, v99
    v_mfma_f32_16x16x32_bf16 v[44:47], a[156:159], v[132:135], v[44:47]
    v_exp_f32 v76, v76
    v_mfma_f32_16x16x32_bf16 v[32:35], a[144:147], v[132:135], v[32:35]
    buffer_load_dwordx4 v254, s[24:27], s59 offen offset:2048 lds
    v_mfma_f32_16x16x32_bf16 v[36:39], a[164:167], v[136:139], v[36:39]
    s_waitcnt vmcnt(10)
    v_exp_f32 v77, v77
    v_mfma_f32_16x16x32_bf16 v[40:43], a[168:171], v[136:139], v[40:43]
    v_exp_f32 v78, v78
    v_mfma_f32_16x16x32_bf16 v[44:47], a[172:175], v[136:139], v[44:47]
    v_exp_f32 v79, v79
    v_mfma_f32_16x16x32_bf16 v[32:35], a[160:163], v[136:139], v[32:35]
    buffer_load_dwordx4 v255, s[24:27], s59 offen offset:3072 lds
    v_mfma_f32_16x16x32_bf16 v[36:39], a[180:183], v[140:143], v[36:39]
    s_waitcnt vmcnt(10)
    v_add_f32 v76, 1.0, v76
    v_add_f32 v77, 1.0, v77
    v_mfma_f32_16x16x32_bf16 v[40:43], a[184:187], v[140:143], v[40:43]
    v_add_f32 v78, 1.0, v78
    v_add_f32 v79, 1.0, v79
    v_mfma_f32_16x16x32_bf16 v[44:47], a[188:191], v[140:143], v[44:47]
    v_rcp_f32 v76, v76
    v_mfma_f32_16x16x32_bf16 v[32:35], a[176:179], v[140:143], v[32:35]
    s_add_u32 m0, s52, 16384
    s_add_u32 s59, s59, 131072
    buffer_load_dwordx4 v252, s[24:27], s59 offen lds
    v_mfma_f32_16x16x32_bf16 v[36:39], a[196:199], v[144:147], v[36:39]
    s_waitcnt vmcnt(10)
    v_rcp_f32 v77, v77
    v_mfma_f32_16x16x32_bf16 v[40:43], a[200:203], v[144:147], v[40:43]
    v_rcp_f32 v78, v78
    v_mfma_f32_16x16x32_bf16 v[44:47], a[204:207], v[144:147], v[44:47]
    v_rcp_f32 v79, v79
    v_mfma_f32_16x16x32_bf16 v[32:35], a[192:195], v[144:147], v[32:35]
    buffer_load_dwordx4 v253, s[24:27], s59 offen offset:1024 lds
    v_mfma_f32_16x16x32_bf16 v[36:39], a[212:215], v[148:151], v[36:39]
    s_waitcnt vmcnt(10)
    v_mul_f32 v76, v76, v96
    v_mul_f32 v77, v77, v97
    v_mfma_f32_16x16x32_bf16 v[40:43], a[216:219], v[148:151], v[40:43]
    v_mul_f32 v78, v78, v98
    v_mul_f32 v79, v79, v99
    v_mfma_f32_16x16x32_bf16 v[44:47], a[220:223], v[148:151], v[44:47]
    v_cvt_pk_bf16_f32 v82, v76, v77
    v_cvt_pk_bf16_f32 v83, v78, v79
    v_mfma_f32_16x16x32_bf16 v[32:35], a[208:211], v[148:151], v[32:35]
    buffer_load_dwordx4 v254, s[24:27], s59 offen offset:2048 lds
    v_mfma_f32_16x16x32_bf16 v[36:39], a[228:231], v[152:155], v[36:39]
    s_waitcnt vmcnt(10)
    v_permlane16_swap_b32 v80, v82
    v_mfma_f32_16x16x32_bf16 v[40:43], a[232:235], v[152:155], v[40:43]
    v_permlane16_swap_b32 v81, v83
    v_mfma_f32_16x16x32_bf16 v[44:47], a[236:239], v[152:155], v[44:47]
    v_mfma_f32_16x16x32_bf16 v[32:35], a[224:227], v[152:155], v[32:35]
    buffer_load_dwordx4 v255, s[24:27], s59 offen offset:3072 lds
    v_mfma_f32_16x16x32_bf16 v[36:39], a[244:247], v[156:159], v[36:39]
    v_mfma_f32_16x16x32_bf16 v[40:43], a[248:251], v[156:159], v[40:43]
    v_mfma_f32_16x16x32_bf16 v[44:47], a[252:255], v[156:159], v[44:47]
    v_mfma_f32_16x16x32_bf16 v[32:35], a[240:243], v[156:159], v[32:35]
    s_add_u32 m0, s52, 32768
    s_add_u32 s59, s59, 131072
    buffer_load_dwordx4 v252, s[24:27], s59 offen lds
    buffer_load_dwordx4 v253, s[24:27], s59 offen offset:1024 lds
    buffer_store_dwordx4 v[80:83], v20, s[40:43], s0 offen sc1
    ds_write_b128 v6, v[36:39] offset:0
    buffer_load_dwordx4 v254, s[24:27], s59 offen offset:2048 lds
    ds_write_b128 v6, v[40:43] offset:1024
    buffer_load_dwordx4 v255, s[24:27], s59 offen offset:3072 lds
    ds_write_b128 v6, v[44:47] offset:2048
    s_add_u32 m0, s52, 49152
    s_add_u32 s59, s59, 131072
    buffer_load_dwordx4 v252, s[24:27], s59 offen lds
    s_waitcnt vmcnt(10)
    ds_read_b64_tr_b16 a[0:1], v248 offset:0
    ds_read_b64_tr_b16 a[2:3], v248 offset:2048
    s_waitcnt lgkmcnt(2)
    s_barrier
    ds_read_b128 v[64:67], v7 offset:0
    ds_read_b128 v[68:71], v8 offset:0
    ds_read_b128 v[72:75], v9 offset:0
    buffer_load_dwordx4 v253, s[24:27], s59 offen offset:1024 lds
    ds_read_b64_tr_b16 a[4:5], v249 offset:0
    ds_read_b64_tr_b16 a[6:7], v249 offset:2048
    s_waitcnt lgkmcnt(2)
    v_add_f32 v92, v32, v64
    v_add_f32 v93, v33, v65
    v_add_f32 v94, v34, v66
    v_add_f32 v95, v35, v67
    v_add_f32 v92, v92, v68
    v_add_f32 v93, v93, v69
    v_add_f32 v94, v94, v70
    v_add_f32 v95, v95, v71
    v_add_f32 v92, v92, v72
    v_add_f32 v93, v93, v73
    v_add_f32 v94, v94, v74
    v_add_f32 v95, v95, v75
    v_mul_f32 v76, v92, v92
    v_mul_f32 v77, v93, v93
    v_mul_f32 v78, v94, v94
    v_mul_f32 v79, v95, v95
    v_fma_f32 v76, v76, s1, v30
    v_fma_f32 v77, v77, s1, v30
    v_fma_f32 v78, v78, s1, v30
    v_fma_f32 v79, v79, s1, v30
    v_mul_f32 v76, v76, v92
    v_mul_f32 v77, v77, v93
    v_mul_f32 v78, v78, v94
    v_mul_f32 v79, v79, v95
    v_exp_f32 v76, v76
    v_exp_f32 v77, v77
    v_exp_f32 v78, v78
    v_exp_f32 v79, v79
    buffer_load_dwordx4 v254, s[24:27], s59 offen offset:2048 lds
    ds_read_b64_tr_b16 a[8:9], v250 offset:0
    ds_read_b64_tr_b16 a[10:11], v250 offset:2048
    v_add_f32 v76, 1.0, v76
    v_add_f32 v77, 1.0, v77
    v_add_f32 v78, 1.0, v78
    v_add_f32 v79, 1.0, v79
    v_rcp_f32 v76, v76
    v_rcp_f32 v77, v77
    v_rcp_f32 v78, v78
    v_rcp_f32 v79, v79
    v_mul_f32 v76, v76, v92
    v_mul_f32 v77, v77, v93
    v_mul_f32 v78, v78, v94
    v_mul_f32 v79, v79, v95
    v_cvt_pk_bf16_f32 v84, v76, v77
    v_cvt_pk_bf16_f32 v85, v78, v79
    s_nop 0
    v_permlane16_swap_b32 v84, v86
    v_permlane16_swap_b32 v85, v87
    buffer_load_dwordx4 v255, s[24:27], s59 offen offset:3072 lds
    ds_read_b64_tr_b16 a[12:13], v251 offset:0
    ds_read_b64_tr_b16 a[14:15], v251 offset:2048
    buffer_store_dwordx4 v[84:87], v21, s[40:43], s0 offen sc1
    s_waitcnt lgkmcnt(0)
    s_add_u32 m0, s52, 0
    s_add_u32 s59, s59, 131072
    buffer_load_dwordx4 v252, s[24:27], s59 offen lds
    s_waitcnt vmcnt(11)
    ds_read_b64_tr_b16 a[16:17], v248 offset:16384
    ds_read_b64_tr_b16 a[18:19], v248 offset:18432
    buffer_load_dwordx4 v253, s[24:27], s59 offen offset:1024 lds
    ds_read_b64_tr_b16 a[20:21], v249 offset:16384
    ds_read_b64_tr_b16 a[22:23], v249 offset:18432
    buffer_load_dwordx4 v254, s[24:27], s59 offen offset:2048 lds
    ds_read_b64_tr_b16 a[24:25], v250 offset:16384
    ds_read_b64_tr_b16 a[26:27], v250 offset:18432
    buffer_load_dwordx4 v255, s[24:27], s59 offen offset:3072 lds
    ds_read_b64_tr_b16 a[28:29], v251 offset:16384
    ds_read_b64_tr_b16 a[30:31], v251 offset:18432
    s_waitcnt lgkmcnt(0)
    s_add_u32 m0, s52, 16384
    s_add_u32 s59, s59, 131072
    buffer_load_dwordx4 v252, s[24:27], s59 offen lds
    s_waitcnt vmcnt(10)
    ds_read_b64_tr_b16 a[32:33], v248 offset:32768
    ds_read_b64_tr_b16 a[34:35], v248 offset:34816
    buffer_load_dwordx4 v253, s[24:27], s59 offen offset:1024 lds
    ds_read_b64_tr_b16 a[36:37], v249 offset:32768
    ds_read_b64_tr_b16 a[38:39], v249 offset:34816
    buffer_load_dwordx4 v254, s[24:27], s59 offen offset:2048 lds
    ds_read_b64_tr_b16 a[40:41], v250 offset:32768
    ds_read_b64_tr_b16 a[42:43], v250 offset:34816
    buffer_load_dwordx4 v255, s[24:27], s59 offen offset:3072 lds
    ds_read_b64_tr_b16 a[44:45], v251 offset:32768
    ds_read_b64_tr_b16 a[46:47], v251 offset:34816
    s_waitcnt lgkmcnt(0)
    s_add_u32 m0, s52, 32768
    s_add_u32 s59, s59, 131072
    buffer_load_dwordx4 v252, s[24:27], s59 offen lds
    s_waitcnt vmcnt(10)
    ds_read_b64_tr_b16 a[48:49], v248 offset:49152
    ds_read_b64_tr_b16 a[50:51], v248 offset:51200
    buffer_load_dwordx4 v253, s[24:27], s59 offen offset:1024 lds
    ds_read_b64_tr_b16 a[52:53], v249 offset:49152
    ds_read_b64_tr_b16 a[54:55], v249 offset:51200
    buffer_load_dwordx4 v254, s[24:27], s59 offen offset:2048 lds
    ds_read_b64_tr_b16 a[56:57], v250 offset:49152
    ds_read_b64_tr_b16 a[58:59], v250 offset:51200
    buffer_load_dwordx4 v255, s[24:27], s59 offen offset:3072 lds
    ds_read_b64_tr_b16 a[60:61], v251 offset:49152
    ds_read_b64_tr_b16 a[62:63], v251 offset:51200
    s_waitcnt vmcnt(12)
    s_barrier
    s_cmp_lg_u32 s3, 0
    s_cbranch_scc1 L_flag_21
    v_cmp_eq_u32 vcc, 0, v1
    v_bfrev_b32 v101, 1
    v_mov_b32 v102, s44
    v_mov_b32 v103, s45
    v_cndmask_b32 v101, v101, 0, vcc
    s_mul_i32 s74, s50, 6
    s_add_u32 s74, s74, s51
    s_mul_i32 s74, s74, 128
    s_add_u32 s74, s74, 36864
    buffer_store_dwordx2 v[102:103], v101, s[40:43], s74 offen sc1
L_flag_21:
    s_waitcnt lgkmcnt(0)
    s_add_u32 m0, s52, 49152
    s_add_u32 s59, s59, 131072
    buffer_load_dwordx4 v252, s[24:27], s59 offen lds
    s_waitcnt vmcnt(9)
    ds_read_b64_tr_b16 a[64:65], v248 offset:0
    ds_read_b64_tr_b16 a[66:67], v248 offset:2048
    buffer_load_dwordx4 v253, s[24:27], s59 offen offset:1024 lds
    ds_read_b64_tr_b16 a[68:69], v249 offset:0
    ds_read_b64_tr_b16 a[70:71], v249 offset:2048
    buffer_load_dwordx4 v254, s[24:27], s59 offen offset:2048 lds
    ds_read_b64_tr_b16 a[72:73], v250 offset:0
    ds_read_b64_tr_b16 a[74:75], v250 offset:2048
    buffer_load_dwordx4 v255, s[24:27], s59 offen offset:3072 lds
    ds_read_b64_tr_b16 a[76:77], v251 offset:0
    ds_read_b64_tr_b16 a[78:79], v251 offset:2048
    v_xor_b32 v13, 32, v16
    s_waitcnt lgkmcnt(0)
    s_add_u32 m0, s52, 0
    s_add_u32 s59, s59, 131072
    buffer_load_dwordx4 v252, s[24:27], s59 offen lds
    s_waitcnt vmcnt(9)
    ds_read_b64_tr_b16 a[80:81], v248 offset:16384
    ds_read_b64_tr_b16 a[82:83], v248 offset:18432
    v_xor_b32 v14, 64, v16
    buffer_load_dwordx4 v253, s[24:27], s59 offen offset:1024 lds
    ds_read_b64_tr_b16 a[84:85], v249 offset:16384
    ds_read_b64_tr_b16 a[86:87], v249 offset:18432
    v_xor_b32 v15, 0x60, v16
    buffer_load_dwordx4 v254, s[24:27], s59 offen offset:2048 lds
    ds_read_b64_tr_b16 a[88:89], v250 offset:16384
    ds_read_b64_tr_b16 a[90:91], v250 offset:18432
    ds_read_b64 v[236:237], v16
    buffer_load_dwordx4 v255, s[24:27], s59 offen offset:3072 lds
    ds_read_b64_tr_b16 a[92:93], v251 offset:16384
    ds_read_b64_tr_b16 a[94:95], v251 offset:18432
    ds_read_b64 v[238:239], v13
    s_waitcnt lgkmcnt(1)
    s_add_u32 m0, s52, 16384
    s_add_u32 s59, s59, 131072
    buffer_load_dwordx4 v252, s[24:27], s59 offen lds
    s_waitcnt vmcnt(9)
    ds_read_b64_tr_b16 a[96:97], v248 offset:32768
    ds_read_b64_tr_b16 a[98:99], v248 offset:34816
    ds_read_b64 v[240:241], v14
    buffer_load_dwordx4 v253, s[24:27], s59 offen offset:1024 lds
    ds_read_b64_tr_b16 a[100:101], v249 offset:32768
    ds_read_b64_tr_b16 a[102:103], v249 offset:34816
    ds_read_b64 v[242:243], v15
    buffer_load_dwordx4 v254, s[24:27], s59 offen offset:2048 lds
    ds_read_b64_tr_b16 a[104:105], v250 offset:32768
    ds_read_b64_tr_b16 a[106:107], v250 offset:34816
    v_lshlrev_b32 v20, 16, v227
    buffer_load_dwordx4 v255, s[24:27], s59 offen offset:3072 lds
    ds_read_b64_tr_b16 a[108:109], v251 offset:32768
    ds_read_b64_tr_b16 a[110:111], v251 offset:34816
    v_lshlrev_b32 v21, 16, v227
    s_waitcnt lgkmcnt(0)
    s_add_u32 m0, s52, 32768
    s_add_u32 s59, s59, 131072
    buffer_load_dwordx4 v252, s[24:27], s59 offen lds
    s_waitcnt vmcnt(9)
    ds_read_b64_tr_b16 a[112:113], v248 offset:49152
    ds_read_b64_tr_b16 a[114:115], v248 offset:51200
    v_lshlrev_b32 v22, 16, v227
    buffer_load_dwordx4 v253, s[24:27], s59 offen offset:1024 lds
    ds_read_b64_tr_b16 a[116:117], v249 offset:49152
    ds_read_b64_tr_b16 a[118:119], v249 offset:51200
    v_lshlrev_b32 v23, 16, v227
    buffer_load_dwordx4 v254, s[24:27], s59 offen offset:2048 lds
    ds_read_b64_tr_b16 a[120:121], v250 offset:49152
    ds_read_b64_tr_b16 a[122:123], v250 offset:51200
    buffer_load_dwordx4 v255, s[24:27], s59 offen offset:3072 lds
    ds_read_b64_tr_b16 a[124:125], v251 offset:49152
    ds_read_b64_tr_b16 a[126:127], v251 offset:51200
    s_waitcnt lgkmcnt(0)
    s_add_u32 m0, s52, 49152
    s_add_u32 s59, s59, 131072
    buffer_load_dwordx4 v252, s[24:27], s59 offen lds
    s_waitcnt vmcnt(9)
    ds_read_b64_tr_b16 a[128:129], v248 offset:0
    ds_read_b64_tr_b16 a[130:131], v248 offset:2048
    buffer_load_dwordx4 v253, s[24:27], s59 offen offset:1024 lds
    ds_read_b64_tr_b16 a[132:133], v249 offset:0
    ds_read_b64_tr_b16 a[134:135], v249 offset:2048
    buffer_load_dwordx4 v254, s[24:27], s59 offen offset:2048 lds
    ds_read_b64_tr_b16 a[136:137], v250 offset:0
    ds_read_b64_tr_b16 a[138:139], v250 offset:2048
    buffer_load_dwordx4 v255, s[24:27], s59 offen offset:3072 lds
    ds_read_b64_tr_b16 a[140:141], v251 offset:0
    ds_read_b64_tr_b16 a[142:143], v251 offset:2048
    s_waitcnt lgkmcnt(0)
    s_add_u32 m0, s52, 0
    s_add_u32 s59, s59, 131072
    buffer_load_dwordx4 v252, s[24:27], s59 offen lds
    s_waitcnt vmcnt(9)
    ds_read_b64_tr_b16 a[144:145], v248 offset:16384
    ds_read_b64_tr_b16 a[146:147], v248 offset:18432
    buffer_load_dwordx4 v253, s[24:27], s59 offen offset:1024 lds
    ds_read_b64_tr_b16 a[148:149], v249 offset:16384
    ds_read_b64_tr_b16 a[150:151], v249 offset:18432
    buffer_load_dwordx4 v254, s[24:27], s59 offen offset:2048 lds
    ds_read_b64_tr_b16 a[152:153], v250 offset:16384
    ds_read_b64_tr_b16 a[154:155], v250 offset:18432
    buffer_load_dwordx4 v255, s[24:27], s59 offen offset:3072 lds
    ds_read_b64_tr_b16 a[156:157], v251 offset:16384
    ds_read_b64_tr_b16 a[158:159], v251 offset:18432
    s_waitcnt lgkmcnt(0)
    s_add_u32 m0, s52, 16384
    s_add_u32 s59, s59, 131072
    buffer_load_dwordx4 v252, s[24:27], s59 offen lds
    s_waitcnt vmcnt(9)
    ds_read_b64_tr_b16 a[160:161], v248 offset:32768
    ds_read_b64_tr_b16 a[162:163], v248 offset:34816
    buffer_load_dwordx4 v253, s[24:27], s59 offen offset:1024 lds
    ds_read_b64_tr_b16 a[164:165], v249 offset:32768
    ds_read_b64_tr_b16 a[166:167], v249 offset:34816
    buffer_load_dwordx4 v254, s[24:27], s59 offen offset:2048 lds
    ds_read_b64_tr_b16 a[168:169], v250 offset:32768
    ds_read_b64_tr_b16 a[170:171], v250 offset:34816
    buffer_load_dwordx4 v255, s[24:27], s59 offen offset:3072 lds
    ds_read_b64_tr_b16 a[172:173], v251 offset:32768
    ds_read_b64_tr_b16 a[174:175], v251 offset:34816
    s_add_u32 m0, s70, 0
    s_nop 0
    buffer_load_dwordx4 v224, s[16:19], s69 offen lds
    s_waitcnt vmcnt(9)
    ds_read_b64_tr_b16 a[176:177], v248 offset:49152
    ds_read_b64_tr_b16 a[178:179], v248 offset:51200
    s_add_u32 m0, s70, 1024
    s_add_u32 s69, s69, 7168
    buffer_load_dwordx4 v224, s[16:19], s69 offen lds
    ds_read_b64_tr_b16 a[180:181], v249 offset:49152
    ds_read_b64_tr_b16 a[182:183], v249 offset:51200
    s_add_u32 m0, s70, 2048
    s_add_u32 s69, s69, 7168
    buffer_load_dwordx4 v224, s[16:19], s69 offen lds
    ds_read_b64_tr_b16 a[184:185], v250 offset:49152
    ds_read_b64_tr_b16 a[186:187], v250 offset:51200
    s_add_u32 m0, s70, 3072
    s_add_u32 s69, s69, 7168
    buffer_load_dwordx4 v224, s[16:19], s69 offen lds
    ds_read_b64_tr_b16 a[188:189], v251 offset:49152
    ds_read_b64_tr_b16 a[190:191], v251 offset:51200
    s_add_u32 m0, s70, 4096
    s_add_u32 s69, s69, 7168
    buffer_load_dwordx4 v224, s[16:19], s69 offen lds
    s_waitcnt vmcnt(9)
    ds_read_b64_tr_b16 a[192:193], v248 offset:0
    ds_read_b64_tr_b16 a[194:195], v248 offset:2048
    s_add_u32 m0, s70, 5120
    s_add_u32 s69, s69, 7168
    buffer_load_dwordx4 v224, s[16:19], s69 offen lds
    ds_read_b64_tr_b16 a[196:197], v249 offset:0
    ds_read_b64_tr_b16 a[198:199], v249 offset:2048
    s_add_u32 m0, s70, 6144
    s_add_u32 s69, s69, 7168
    buffer_load_dwordx4 v224, s[16:19], s69 offen lds
    ds_read_b64_tr_b16 a[200:201], v250 offset:0
    ds_read_b64_tr_b16 a[202:203], v250 offset:2048
    s_add_u32 m0, s70, 7168
    s_add_u32 s69, s69, 7168
    buffer_load_dwordx4 v224, s[16:19], s69 offen lds
    ds_read_b64_tr_b16 a[204:205], v251 offset:0
    ds_read_b64_tr_b16 a[206:207], v251 offset:2048
    s_add_u32 m0, s70, 8192
    s_add_u32 s69, s69, 7168
    buffer_load_dwordx4 v224, s[16:19], s69 offen lds
    s_waitcnt vmcnt(9)
    ds_read_b64_tr_b16 a[208:209], v248 offset:16384
    ds_read_b64_tr_b16 a[210:211], v248 offset:18432
    s_add_u32 m0, s70, 9216
    s_add_u32 s69, s69, 7168
    buffer_load_dwordx4 v224, s[16:19], s69 offen lds
    ds_read_b64_tr_b16 a[212:213], v249 offset:16384
    ds_read_b64_tr_b16 a[214:215], v249 offset:18432
    s_add_u32 m0, s70, 10240
    s_add_u32 s69, s69, 7168
    buffer_load_dwordx4 v224, s[16:19], s69 offen lds
    ds_read_b64_tr_b16 a[216:217], v250 offset:16384
    ds_read_b64_tr_b16 a[218:219], v250 offset:18432
    s_add_u32 m0, s70, 11264
    s_add_u32 s69, s69, 7168
    buffer_load_dwordx4 v224, s[16:19], s69 offen lds
    ds_read_b64_tr_b16 a[220:221], v251 offset:16384
    ds_read_b64_tr_b16 a[222:223], v251 offset:18432
    s_add_u32 m0, s70, 12288
    s_add_u32 s69, s69, 7168
    buffer_load_dwordx4 v224, s[16:19], s69 offen lds
    s_add_u32 m0, s70, 13312
    s_add_u32 s69, s69, 7168
    buffer_load_dwordx4 v224, s[16:19], s69 offen lds
    buffer_load_dwordx2 v[232:233], v228, s[40:43], 0 offen sc1
    s_waitcnt vmcnt(0)
    v_cmp_ne_u64 vcc, s[44:45], v[232:233]
    s_mov_b32 s65, 0
    s_cbranch_vccz L_polled_23
L_poll_22:
    buffer_load_dwordx2 v[232:233], v228, s[40:43], 0 offen sc1
    s_waitcnt vmcnt(0)
    v_cmp_ne_u64 vcc, s[44:45], v[232:233]
    s_add_u32 s65, s65, 1
    s_cbranch_vccz L_polled_23
    s_cmp_lt_u32 s65, 200000
    s_cbranch_scc1 L_poll_22
L_polled_23:
    buffer_load_dwordx4 v[112:115], v234, s[40:43], s66 offen sc1
    s_add_u32 s66, s66, 59392
    buffer_load_dwordx4 v[116:119], v234, s[40:43], s66 offen sc1
    s_add_u32 s66, s66, 59392
    buffer_load_dwordx4 v[120:123], v234, s[40:43], s66 offen sc1
    s_add_u32 s66, s66, 59392
    buffer_load_dwordx4 v[124:127], v234, s[40:43], s66 offen sc1
    s_add_u32 s66, s66, 59392
    buffer_load_dwordx4 v[128:131], v234, s[40:43], s66 offen sc1
    s_add_u32 s66, s66, 59392
    buffer_load_dwordx4 v[132:135], v234, s[40:43], s66 offen sc1
    s_add_u32 s66, s66, 59392
    buffer_load_dwordx4 v[136:139], v234, s[40:43], s66 offen sc1
    s_add_u32 s66, s66, 59392
    buffer_load_dwordx4 v[140:143], v234, s[40:43], s66 offen sc1
    s_add_u32 s66, s66, 59392
    buffer_load_dwordx4 v[144:147], v234, s[40:43], s66 offen sc1
    s_add_u32 s66, s66, 59392
    buffer_load_dwordx4 v[148:151], v234, s[40:43], s66 offen sc1
    s_add_u32 s66, s66, 59392
    buffer_load_dwordx4 v[152:155], v234, s[40:43], s66 offen sc1
    s_add_u32 s66, s66, 59392
    buffer_load_dwordx4 v[156:159], v234, s[40:43], s66 offen sc1
    s_branch L_p2
L_attn:
    s_mul_i32 s58, s64, 11
    s_add_u32 s58, s58, 8
    s_lshl_b32 s74, s58, 3
    s_add_u32 s74, s74, s77
    s_sub_u32 s74, s74, 8
    v_lshrrev_b32 v12, 3, v1
    v_add_u32 v13, s74, v12
    s_lshl_b32 s75, s76, 2
    v_lshrrev_b32 v12, 1, v12
    v_add_u32 v12, s75, v12
    v_and_b32 v14, 7, v1
    v_xor_b32 v12, v12, v14
    v_lshlrev_b32 v12, 4, v12
    s_mul_i32 s75, s63, 896
    v_add_u32 v12, s75, v12
    s_movk_i32 s76, 1023
    s_movk_i32 s77, 1792
    s_cmp_eq_u32 s3, 0
    s_cselect_b32 s4, 0xffffff00, -1
    s_mov_b32 s5, -1
    v_add_u32 v14, 0, v13
    v_med3_i32 v14, v14, 0, s76
    v_mad_u32_u24 v3, v14, s77, v12
    v_add_u32 v14, 32, v13
    v_med3_i32 v14, v14, 0, s76
    v_mad_u32_u24 v4, v14, s77, v12
    v_add_u32 v14, 64, v13
    v_med3_i32 v14, v14, 0, s76
L_pad_7:
    s_cbranch_execz L_ret
    v_mad_u32_u24 v5, v14, s77, v12
    s_add_u32 m0, s57, 8192
    s_nop 0
    buffer_load_dwordx4 v5, s[8:11], s55 offen lds
    s_add_u32 m0, s57, 4096
    s_nop 0
    buffer_load_dwordx4 v4, s[8:11], s55 offen lds
    s_add_u32 m0, s57, 0
    s_mov_b64 exec, s[4:5]
    buffer_load_dwordx4 v3, s[8:11], s55 offen lds
    s_mov_b64 exec, -1
    s_add_u32 m0, s56, 73728
    s_add_u32 s53, s53, 86016
    buffer_load_dwordx4 v2, s[12:15], s53 offen lds
    s_load_dword s44, s[40:41], 0
    s_load_dword s45, s[40:41], 81792
    s_load_dwordx2 s[16:17], s[0:1], 16
    s_load_dwordx2 s[24:25], s[0:1], 48
    s_load_dwordx2 s[32:33], s[0:1], 56
    s_load_dwordx2 s[36:37], s[0:1], 64
    s_mov_b32 s42, 12058624
    s_mov_b32 s43, 0x20000
    s_mov_b32 s18, 401408
    s_mov_b32 s19, 0x20000
    s_mov_b32 s26, 7340032
    s_mov_b32 s27, 0x20000
    s_mov_b32 s34, 4096
    s_mov_b32 s35, 0x20000
    s_mov_b32 s38, 1835008
    s_mov_b32 s39, 0x20000
    v_mov_b32 v20, 0x3f803f80
    v_and_b32 v13, 31, v0
    v_lshlrev_b32 v13, 2, v13
    v_add_u32 v13, 98304, v13
    ds_write_b32 v13, v20 offset:0
    ds_write_b32 v13, v20 offset:12288
    ds_write_b32 v13, v20 offset:24576
    v_and_b32 v12, 15, v1
    v_lshrrev_b32 v13, 4, v1
    v_lshrrev_b32 v14, 1, v12
    v_xor_b32 v14, v14, v13
    v_lshlrev_b32 v14, 4, v14
    v_lshl_add_u32 v14, v12, 7, v14
    v_add_u32 v8, 98304, v14
    v_xor_b32 v9, 64, v8
    s_nop 0
    v_lshrrev_b32 v14, 2, v1
    v_lshlrev_b32 v12, 8, v14
    v_and_b32 v14, 7, v14
    v_lshlrev_b32 v14, 5, v14
    v_and_b32 v15, 3, v1
    s_and_b32 s75, s62, 1
    s_lshl_b32 s74, s75, 5
    s_mul_i32 s76, s3, 56
    s_add_u32 s74, s74, s76
    v_lshl_add_u32 v13, v15, 3, s74
    v_cmp_eq_u32 s[6:7], 3, v15
    s_xor_b32 s75, s75, 1
    s_mul_i32 s75, s75, 224
    v_add_u32 v15, 32, v13
    v_and_b32 v16, 24, v15
    v_add_u32 v16, s75, v16
    v_cndmask_b32 v15, v15, v16, s[6:7]
    v_xor_b32 v13, v13, v14
    v_xor_b32 v15, v15, v14
    v_add_u32 v30, v12, v13
    v_add_u32 v32, v12, v15
    v_add_u32 v31, 49152, v30
    v_add_u32 v33, 49152, v32
    s_waitcnt lgkmcnt(0)
    s_mov_b64 exec, 0
    s_cmp_lg_u32 s3, 0
    s_cbranch_scc1 L_w_24
    s_call_b64 s[70:71], L_pad_8
    s_call_b64 s[70:71], L_pad_4
L_w_24:
    s_cmp_lg_u32 s3, 1
    s_cbranch_scc1 L_w_25
    s_call_b64 s[70:71], L_pad_9
    s_call_b64 s[70:71], L_pad_5
L_w_25:
    s_cmp_lg_u32 s3, 2
    s_cbranch_scc1 L_w_26
    s_call_b64 s[70:71], L_pad_10
    s_call_b64 s[70:71], L_ret
L_w_26:
    s_cmp_lg_u32 s3, 3
    s_cbranch_scc1 L_w_27
    s_call_b64 s[70:71], L_pad_3
    s_call_b64 s[70:71], L_ret
L_w_27:
    s_mov_b64 exec, -1
L_site_duty:
    s_lshl_b32 s74, s58, 1
    s_sub_u32 s74, s74, 2
    v_and_b32 v12, 31, v1
    v_min_u32 v12, 23, v12
    v_add_u32 v12, s74, v12
    s_movk_i32 s75, 255
    v_med3_i32 v12, v12, 0, s75
    v_lshrrev_b32 v13, 1, v12
    v_mul_u32_u24 v13, 32, v13
    v_add_u32 v24, 4096, v13
    v_lshrrev_b32 v13, 5, v1
    v_lshlrev_b32 v13, 13, v13
    v_lshl_add_u32 v25, v12, 4, v13
    s_lshl_b32 s0, s63, 12
    s_add_u32 s0, s0, 81920
    s_lshl_b32 s74, s3, 10
    s_add_u32 m0, s56, 77824
    s_add_u32 s54, s53, 10752
    buffer_load_dwordx4 v2, s[12:15], s54 offen lds
    s_add_u32 s74, s74, 157696
    v_lshl_add_u32 v26, v1, 4, s74
    v_and_b32 v12, 15, v1
    v_lshl_add_u32 v34, v12, 2, s74
    v_lshrrev_b32 v13, 4, v1
    v_lshl_add_u32 v35, v13, 4, s74
    v_mov_b32 v21, v20
    v_mov_b32 v22, v20
    v_mov_b32 v23, v20
    v_mov_b32 v138, 0
    v_mov_b32 v139, 0
    v_mov_b32 v166, 0
    v_mov_b32 v167, 0
    s_lshl_b32 s52, s3, 12
    v_bfe_u32 v12, v1, 2, 3
    v_lshrrev_b32 v13, 5, v1
    s_add_u32 m0, s56, 81024
    s_nop 0
    buffer_load_dwordx4 v2, s[12:15], s53 offen offset:896 lds
    v_lshlrev_b32 v13, 10, v13
    v_lshl_add_u32 v13, v12, 7, v13
    v_and_b32 v14, 3, v1
    v_lshl_add_u32 v13, v14, 3, v13
    v_add_u32 v13, s52, v13
    v_lshrrev_b32 v12, 1, v12
    s_add_u32 s74, s3, 0
    s_and_b32 s74, s74, 3
    v_xor_b32 v14, s74, v12
    v_lshl_add_u32 v248, v14, 5, v13
    s_add_u32 s74, s3, 1
    s_and_b32 s74, s74, 3
    v_xor_b32 v14, s74, v12
    v_lshl_add_u32 v249, v14, 5, v13
    s_add_u32 s74, s3, 2
    s_and_b32 s74, s74, 3
    s_add_u32 m0, s56, 85120
    s_nop 0
    buffer_load_dwordx4 v2, s[12:15], s54 offen offset:896 lds
    v_xor_b32 v14, s74, v12
    v_lshl_add_u32 v250, v14, 5, v13
    s_add_u32 s74, s3, 3
    s_and_b32 s74, s74, 3
    v_xor_b32 v14, s74, v12
    v_lshl_add_u32 v251, v14, 5, v13
    s_mul_i32 s74, s47, 37
    s_lshr_b32 s74, s74, 8
    s_mul_i32 s75, s74, 7
    s_sub_u32 s49, s47, s75
    s_xor_b32 s74, s74, 0
    s_xor_b32 s48, s46, 1
    s_lshl_b32 s48, s48, 2
    s_add_u32 s48, s48, s74
    s_lshl_b32 s74, s74, 2
    s_lshr_b32 s74, 0x0, s74
    s_add_u32 m0, s56, 88320
    s_nop 0
    buffer_load_dwordx4 v2, s[12:15], s53 offen offset:1792 lds
    s_and_b32 s74, s74, 15
    s_lshl_b32 s75, s49, 2
    s_lshr_b32 s75, 0x0, s75
    s_and_b32 s75, s75, 15
    s_add_u32 s74, s74, s75
    s_sub_u32 s75, s74, 14
    s_min_u32 s74, s74, s75
    s_mul_i32 s60, s3, 1835008
    s_lshl_b32 s75, s48, 7
    s_add_u32 s60, s60, s75
    s_add_u32 s61, s60, 1835008
    s_mul_i32 s75, s74, 131072
    s_add_u32 s59, s60, s75
    s_mul_i32 s67, s3, 831488
    s_lshl_b32 s75, s49, 13
    s_add_u32 s67, s67, s75
    s_add_u32 m0, s56, 92416
    s_nop 0
    buffer_load_dwordx4 v2, s[12:15], s54 offen offset:1792 lds
    s_add_u32 s67, s67, 4194304
    s_add_u32 s68, s67, 831488
    s_mul_i32 s75, s74, 59392
    s_add_u32 s66, s67, s75
    v_lshrrev_b32 v12, 3, v1
    v_lshrrev_b32 v13, 5, v1
    v_and_b32 v14, 3, v12
    v_lshl_add_u32 v13, v13, 3, v14
    v_mul_u32_u24 v13, 4096, v13
    v_and_b32 v14, 6, v12
    v_and_b32 v15, 7, v1
    v_xor_b32 v14, v14, v15
    v_lshl_add_u32 v252, v14, 4, v13
    v_add_u32 v253, 64512, v252
    v_add_u32 v254, 14336, v252
    v_add_u32 v255, 78848, v252
    s_add_u32 m0, s57, 20480
    s_add_u32 s55, s55, 128
    s_cmp_ge_u32 s55, 896
    s_cselect_b32 s55, 0, s55
    buffer_load_dwordx4 v5, s[8:11], s55 offen lds
    v_bfe_u32 v12, v1, 3, 2
    v_add_u32 v13, 1, v12
    v_lshrrev_b32 v13, 2, v13
    v_add_u32 v12, v12, v13
    v_and_b32 v13, 7, v1
    v_lshlrev_b32 v13, 4, v13
    v_lshl_add_u32 v12, v12, 7, v13
    v_lshrrev_b32 v13, 5, v1
    v_lshl_add_u32 v234, v13, 10, v12
    v_add_u32 v235, 4096, v234
    v_lshlrev_b32 v231, 4, v1
    v_lshrrev_b32 v12, 3, v1
    v_mul_u32_u24 v13, 896, v12
    v_and_b32 v14, 6, v12
    v_and_b32 v15, 7, v1
    v_xor_b32 v14, v14, v15
    s_add_u32 m0, s57, 16384
    s_nop 0
    buffer_load_dwordx4 v4, s[8:11], s55 offen lds
    v_lshl_add_u32 v224, v14, 4, v13
    s_mul_i32 s69, s3, 100352
    s_lshl_b32 s76, s49, 7
    s_add_u32 s69, s69, s76
    s_mul_i32 s70, s3, 14336
    s_add_u32 s70, s70, 65536
    v_and_b32 v12, 15, v1
    v_lshlrev_b32 v226, 1, v12
    s_lshl_b32 s74, s48, 2
    s_add_u32 s74, s74, s3
    s_mul_i32 s71, s74, 14336
    s_add_u32 s71, s71, s76
    s_lshl_b32 s72, s74, 5
    s_lshl_b32 s73, s74, 14
    s_add_u32 s73, s73, 7602176
    s_mul_i32 s75, s74, 79
    s_add_u32 m0, s57, 12288
    s_mov_b64 exec, s[4:5]
    buffer_load_dwordx4 v3, s[8:11], s55 offen lds
    s_mov_b64 exec, -1
    s_lshr_b32 s75, s75, 10
    s_min_u32 s75, s75, 4
    s_max_u32 s77, s74, 52
    s_sub_u32 s77, s77, 52
    s_mul_i32 s77, s77, 94
    s_lshr_b32 s77, s77, 10
    s_add_u32 s77, s77, s75
    v_lshrrev_b32 v12, 2, v1
    v_min_u32 v12, 13, v12
    v_and_b32 v13, 1, v12
    v_mul_u32_u24 v13, 3, v13
    s_lshl_b32 s75, s49, 2
    v_add_u32 v13, s75, v13
    v_mul_u32_u24 v13, 52, v13
    v_lshrrev_b32 v13, 8, v13
    v_lshrrev_b32 v12, 1, v12
    s_add_u32 m0, s56, 0
    s_add_u32 s53, s53, 86016
    s_cmp_ge_u32 s53, 1204224
    s_cselect_b32 s53, 0, s53
    buffer_load_dwordx4 v2, s[12:15], s53 offen lds
    s_mul_i32 s75, s3, 7
    v_add_u32 v12, s75, v12
    v_mad_u32_u24 v12, v12, 6, v13
    v_mul_u32_u24 v12, 128, v12
    v_add_u32 v228, 36864, v12
    v_bfe_u32 v12, v1, 3, 3
    v_lshl_add_u32 v12, v12, 4, s77
    v_mul_u32_u24 v12, 128, v12
    v_add_u32 v229, 61440, v12
    v_bfe_u32 v12, v1, 3, 1
    v_mul_u32_u24 v12, 2162688, v12
    v_lshrrev_b32 v13, 4, v1
    v_add_u32 v14, 1, v13
    v_lshrrev_b32 v14, 2, v14
    v_add_u32 v13, v13, v14
    v_lshl_add_u32 v12, v13, 7, v12
    s_add_u32 m0, s56, 4096
    s_add_u32 s54, s53, 10752
    buffer_load_dwordx4 v2, s[12:15], s54 offen lds
    v_bfe_u32 v13, v1, 0, 3
    v_lshl_add_u32 v230, v13, 4, v12
    v_lshrrev_b32 v12, 2, v1
    v_lshlrev_b32 v13, 7, v12
    v_and_b32 v14, 3, v1
    v_lshl_add_u32 v13, v14, 3, v13
    v_add_u32 v13, 65536, v13
    v_bfe_u32 v12, v1, 3, 2
    v_xor_b32 v14, 0, v12
    v_lshl_add_u32 v244, v14, 5, v13
    v_xor_b32 v14, 1, v12
    v_lshl_add_u32 v245, v14, 5, v13
    v_xor_b32 v14, 2, v12
    v_lshl_add_u32 v246, v14, 5, v13
    v_xor_b32 v14, 3, v12
    v_lshl_add_u32 v247, v14, 5, v13
    s_add_u32 m0, s56, 7296
    s_nop 0
    buffer_load_dwordx4 v2, s[12:15], s53 offen offset:896 lds
    s_and_b32 s74, s46, 1
    s_mul_i32 s75, s74, 6
    s_and_b32 s74, s46, 1
    s_xor_b32 s75, s74, 1
    s_mul_i32 s76, s74, 0
    s_xor_b32 s76, s76, 3
    s_xor_b32 s77, s46, 1
    s_lshl_b32 s77, s77, 2
    s_lshl_b32 s75, s75, 0
    s_add_u32 s76, s76, s77
    s_lshl_b32 s76, s76, 7
    s_mul_i32 s77, s3, 1835008
    s_add_u32 s76, s76, s77
    v_lshl_add_u32 v37, v1, 12, s76
    s_lshl_b32 s76, s74, 1
    s_sub_u32 s76, s64, s76
    s_add_u32 m0, s56, 11392
    s_nop 0
    buffer_load_dwordx4 v2, s[12:15], s54 offen offset:896 lds
    s_sub_u32 s76, s76, 4
    s_add_u32 s77, s62, 1
    s_and_b32 s77, s77, 2
    s_lshl_b32 s77, s77, 2
    s_add_u32 s76, s76, s77
    s_add_u32 s76, s76, s75
    s_add_u32 s77, s76, 1
    s_lshr_b32 s77, s77, 3
    s_waitcnt lgkmcnt(0)
    s_mul_i32 s45, s45, 0x2c9277b5
    s_mul_i32 s44, s44, 0x9e3779b1
    s_add_u32 s45, s45, 0x5bd1e995
    s_add_u32 s44, s44, 0x7f4a7c15
    s_waitcnt vmcnt(13)
    s_barrier
    ds_read_b128 a[160:163], v8 offset:0
    ds_read_b64_tr_b16 a[184:185], v31 offset:0
    ds_read_b64_tr_b16 a[186:187], v31 offset:4096
    ds_read_b64_tr_b16 a[188:189], v33 offset:0
    ds_read_b64_tr_b16 a[190:191], v33 offset:4096
    ds_read_b64_tr_b16 a[192:193], v31 offset:8192
    ds_read_b64_tr_b16 a[194:195], v31 offset:12288
    ds_read_b64_tr_b16 a[196:197], v33 offset:8192
    ds_read_b64_tr_b16 a[198:199], v33 offset:12288
    ds_read_b64_tr_b16 a[200:201], v31 offset:16384
    ds_read_b64_tr_b16 a[202:203], v31 offset:20480
    ds_read_b64_tr_b16 a[204:205], v33 offset:16384
    ds_read_b64_tr_b16 a[206:207], v33 offset:20480
    ds_read_b128 a[164:167], v8 offset:2048
    ds_read_b128 a[168:171], v8 offset:4096
    ds_read_b128 a[172:175], v8 offset:6144
    ds_read_b128 a[176:179], v8 offset:8192
    ds_read_b128 a[180:183], v8 offset:10240
    s_cmp_lg_u32 s3, 0
    s_cbranch_scc1 L_flag_28
    v_cmp_eq_u32 vcc, 0, v1
    v_bfrev_b32 v17, 1
    v_mov_b32 v18, s44
    v_mov_b32 v19, s45
    v_cndmask_b32 v17, v17, 0, vcc
    s_mul_i32 s65, s65, 32
    s_add_u32 s65, s65, 4096
    buffer_store_dwordx2 v[18:19], v17, s[40:43], s65 offen sc1
L_flag_28:
    s_lshl_b32 s77, s77, 29
    s_lshl_b32 s76, s76, 18
    s_add_u32 s76, s76, s77
    v_add_u32 v37, s76, v37
    v_lshrrev_b32 v12, 4, v1
    v_lshlrev_b32 v12, 2, v12
    v_and_b32 v13, 15, v1
    v_sub_u32 v12, v12, v13
    v_mov_b32 v14, 0xff800000
    s_min_u32 s74, s64, 1
    s_sub_u32 s74, s74, 1
    s_mov_b32 s75, 0
    s_add_u32 m0, s56, 14592
    s_nop 0
    buffer_load_dwordx4 v2, s[12:15], s53 offen offset:1792 lds
    v_add_u32 v13, 7, v12
    v_cmp_gt_u32 s[76:77], 8, v13
    v_cmp_lt_i32 s[6:7], 15, v13
    s_nop 0
    v_cndmask_b32 v212, v14, 0, s[76:77]
    v_cndmask_b32 v216, v212, v14, s[74:75]
    v_add_u32 v13, 8, v12
    v_cmp_gt_u32 s[76:77], 8, v13
    v_cmp_lt_i32 s[46:47], 15, v13
    s_nop 0
    v_cndmask_b32 v213, v14, 0, s[76:77]
    v_cndmask_b32 v217, v213, v14, s[74:75]
    v_add_u32 v13, 9, v12
    v_cmp_gt_u32 s[76:77], 8, v13
    s_add_u32 m0, s56, 18688
    s_nop 0
    buffer_load_dwordx4 v2, s[12:15], s54 offen offset:1792 lds
    v_cmp_lt_i32 s[48:49], 15, v13
    v_cndmask_b32 v214, v14, 0, s[76:77]
    v_cndmask_b32 v218, v214, v14, s[74:75]
    v_add_u32 v13, 10, v12
    v_cmp_gt_u32 s[76:77], 8, v13
    v_cmp_lt_i32 s[50:51], 15, v13
    s_nop 0
    v_cndmask_b32 v215, v14, 0, s[76:77]
    v_cndmask_b32 v219, v215, v14, s[74:75]
    v_mov_b32 v14, 0xffff
    v_mov_b32 v15, 0xffff0000
    v_cndmask_b32 v10, 0, v14, s[6:7]
    v_cndmask_b32 v13, 0, v15, s[46:47]
    v_or_b32 v10, v10, v13
    v_cndmask_b32 v11, 0, v14, s[48:49]
    v_cndmask_b32 v13, 0, v15, s[50:51]
    v_or_b32 v11, v11, v13
    v_bfe_u32 v12, v1, 3, 1
    v_lshrrev_b32 v13, 4, v1
    v_add_u32 v14, 1, v13
    v_lshrrev_b32 v14, 2, v14
    v_add_u32 v13, v13, v14
    v_lshlrev_b32 v13, 7, v13
    v_and_b32 v14, 7, v1
    v_lshl_add_u32 v13, v14, 4, v13
    v_lshl_add_u32 v7, v12, 14, v13
    v_xor_b32 v12, 1, v12
    v_lshl_or_b32 v27, v12, 31, v7
    s_mul_i32 s1, s63, 2162688
    s_lshl_b32 s74, s58, 14
    s_add_u32 s1, s1, s74
    s_lshl_b32 s74, s62, 2
    s_add_u32 s74, s74, s3
    s_lshl_b32 s74, s74, 10
    s_add_u32 s1, s1, s74
    s_add_u32 s1, s1, 7585792
    s_waitcnt vmcnt(9)
    s_waitcnt lgkmcnt(0)
    s_barrier
    v_mfma_f32_16x16x32_bf16 v[40:43], a[184:187], a[160:163], 0
    s_add_u32 m0, s56, 24576
    s_add_u32 s53, s53, 86016
    ds_read_b128 a[208:211], v9 offset:0
    v_mfma_f32_16x16x32_bf16 v[44:47], a[188:191], a[160:163], 0
    buffer_load_dwordx4 v2, s[12:15], s53 offen lds
    v_mfma_f32_16x16x32_bf16 v[88:91], a[192:195], a[160:163], 0
    ds_read_b64_tr_b16 a[232:233], v31 offset:24576
    v_mfma_f32_16x16x32_bf16 v[92:95], a[196:199], a[160:163], 0
    s_add_u32 m0, s56, 28672
    s_add_u32 s54, s53, 10752
    ds_read_b64_tr_b16 a[234:235], v31 offset:28672
    v_mfma_f32_16x16x32_bf16 v[140:143], a[160:163], a[200:203], 0
    buffer_load_dwordx4 v2, s[12:15], s54 offen lds
    v_mfma_f32_16x16x32_bf16 v[168:171], a[160:163], a[204:207], 0
    ds_read_b64_tr_b16 a[236:237], v33 offset:24576
    v_mfma_f32_16x16x32_bf16 v[48:51], a[184:187], a[164:167], 0
    ds_read_b64_tr_b16 a[238:239], v33 offset:28672
    v_mfma_f32_16x16x32_bf16 v[52:55], a[188:191], a[164:167], 0
    s_add_u32 m0, s56, 31872
    ds_read_b64_tr_b16 a[240:241], v31 offset:32768
    v_mfma_f32_16x16x32_bf16 v[96:99], a[192:195], a[164:167], 0
    buffer_load_dwordx4 v2, s[12:15], s53 offen offset:896 lds
    v_mfma_f32_16x16x32_bf16 v[100:103], a[196:199], a[164:167], 0
    ds_read_b64_tr_b16 a[242:243], v31 offset:36864
    v_mfma_f32_16x16x32_bf16 v[144:147], a[164:167], a[200:203], 0
    ds_read_b64_tr_b16 a[244:245], v33 offset:32768
    v_mfma_f32_16x16x32_bf16 v[172:175], a[164:167], a[204:207], 0
    s_add_u32 m0, s56, 35968
    ds_read_b64_tr_b16 a[246:247], v33 offset:36864
    v_mfma_f32_16x16x32_bf16 v[56:59], a[184:187], a[168:171], 0
    buffer_load_dwordx4 v2, s[12:15], s54 offen offset:896 lds
    v_mfma_f32_16x16x32_bf16 v[60:63], a[188:191], a[168:171], 0
    ds_read_b64_tr_b16 a[248:249], v31 offset:40960
    v_mfma_f32_16x16x32_bf16 v[104:107], a[192:195], a[168:171], 0
    ds_read_b64_tr_b16 a[250:251], v31 offset:45056
    v_mfma_f32_16x16x32_bf16 v[108:111], a[196:199], a[168:171], 0
    s_add_u32 m0, s56, 39168
    ds_read_b64_tr_b16 a[252:253], v33 offset:40960
    v_mfma_f32_16x16x32_bf16 v[148:151], a[168:171], a[200:203], 0
    buffer_load_dwordx4 v2, s[12:15], s53 offen offset:1792 lds
    v_mfma_f32_16x16x32_bf16 v[176:179], a[168:171], a[204:207], 0
    ds_read_b64_tr_b16 a[254:255], v33 offset:45056
    v_mfma_f32_16x16x32_bf16 v[64:67], a[184:187], a[172:175], 0
    s_add_u32 m0, s56, 43264
    ds_read_b128 a[212:215], v9 offset:2048
    v_mfma_f32_16x16x32_bf16 v[68:71], a[188:191], a[172:175], 0
    buffer_load_dwordx4 v2, s[12:15], s54 offen offset:1792 lds
    v_mfma_f32_16x16x32_bf16 v[112:115], a[192:195], a[172:175], 0
    ds_read_b128 a[216:219], v9 offset:4096
    v_mfma_f32_16x16x32_bf16 v[116:119], a[196:199], a[172:175], 0
    ds_read_b128 a[220:223], v9 offset:6144
    v_mfma_f32_16x16x32_bf16 v[152:155], a[172:175], a[200:203], 0
    s_add_u32 m0, s57, 32768
    s_add_u32 s55, s55, 128
    s_cmp_ge_u32 s55, 896
    s_cselect_b32 s55, 0, s55
    v_mfma_f32_16x16x32_bf16 v[180:183], a[172:175], a[204:207], 0
    buffer_load_dwordx4 v5, s[8:11], s55 offen lds
    v_mfma_f32_16x16x32_bf16 v[72:75], a[184:187], a[176:179], 0
    ds_read_b128 a[224:227], v9 offset:8192
    v_mfma_f32_16x16x32_bf16 v[76:79], a[188:191], a[176:179], 0
    ds_read_b128 a[228:231], v9 offset:10240
    v_mfma_f32_16x16x32_bf16 v[120:123], a[192:195], a[176:179], 0
    s_add_u32 m0, s57, 28672
    v_mfma_f32_16x16x32_bf16 v[124:127], a[196:199], a[176:179], 0
    buffer_load_dwordx4 v4, s[8:11], s55 offen lds
    v_mfma_f32_16x16x32_bf16 v[156:159], a[176:179], a[200:203], 0
    v_mfma_f32_16x16x32_bf16 v[184:187], a[176:179], a[204:207], 0
    v_mfma_f32_16x16x32_bf16 v[80:83], a[184:187], a[180:183], 0
    s_add_u32 m0, s57, 24576
    v_mfma_f32_16x16x32_bf16 v[84:87], a[188:191], a[180:183], 0
    s_mov_b64 exec, s[4:5]
    buffer_load_dwordx4 v3, s[8:11], s55 offen lds
    s_mov_b64 exec, -1
    v_mfma_f32_16x16x32_bf16 v[128:131], a[192:195], a[180:183], 0
    v_mfma_f32_16x16x32_bf16 v[132:135], a[196:199], a[180:183], 0
    v_mfma_f32_16x16x32_bf16 v[160:163], a[180:183], a[200:203], 0
    v_mfma_f32_16x16x32_bf16 v[188:191], a[180:183], a[204:207], 0
    s_waitcnt vmcnt(9)
    s_waitcnt lgkmcnt(0)
    s_barrier
    v_mfma_f32_16x16x32_bf16 v[40:43], a[232:235], a[208:211], v[40:43]
    s_add_u32 m0, s56, 49152
    s_add_u32 s53, s53, 86016
    s_cmp_ge_u32 s53, 1204224
    s_cselect_b32 s53, 0, s53
    v_mfma_f32_16x16x32_bf16 v[44:47], a[236:239], a[208:211], v[44:47]
    buffer_load_dwordx4 v2, s[12:15], s53 offen lds
    v_mfma_f32_16x16x32_bf16 v[88:91], a[240:243], a[208:211], v[88:91]
    ds_read_b128 a[160:163], v8 offset:12288
    v_mfma_f32_16x16x32_bf16 v[92:95], a[244:247], a[208:211], v[92:95]
    s_add_u32 m0, s56, 53248
    s_add_u32 s54, s53, 10752
    ds_read_b64_tr_b16 a[184:185], v30 offset:0
    v_mfma_f32_16x16x32_bf16 v[140:143], a[208:211], a[248:251], v[140:143]
    buffer_load_dwordx4 v2, s[12:15], s54 offen lds
    v_mfma_f32_16x16x32_bf16 v[168:171], a[208:211], a[252:255], v[168:171]
    ds_read_b64_tr_b16 a[186:187], v30 offset:4096
    v_mfma_f32_16x16x32_bf16 v[48:51], a[232:235], a[212:215], v[48:51]
    ds_read_b64_tr_b16 a[188:189], v32 offset:0
    v_mfma_f32_16x16x32_bf16 v[52:55], a[236:239], a[212:215], v[52:55]
    s_add_u32 m0, s56, 56448
    ds_read_b64_tr_b16 a[190:191], v32 offset:4096
    v_mfma_f32_16x16x32_bf16 v[96:99], a[240:243], a[212:215], v[96:99]
    buffer_load_dwordx4 v2, s[12:15], s53 offen offset:896 lds
    v_mfma_f32_16x16x32_bf16 v[100:103], a[244:247], a[212:215], v[100:103]
    ds_read_b64_tr_b16 a[192:193], v30 offset:8192
    v_mfma_f32_16x16x32_bf16 v[144:147], a[212:215], a[248:251], v[144:147]
    ds_read_b64_tr_b16 a[194:195], v30 offset:12288
    v_mfma_f32_16x16x32_bf16 v[172:175], a[212:215], a[252:255], v[172:175]
    s_add_u32 m0, s56, 60544
    ds_read_b64_tr_b16 a[196:197], v32 offset:8192
    v_mfma_f32_16x16x32_bf16 v[56:59], a[232:235], a[216:219], v[56:59]
    buffer_load_dwordx4 v2, s[12:15], s54 offen offset:896 lds
    v_mfma_f32_16x16x32_bf16 v[60:63], a[236:239], a[216:219], v[60:63]
    ds_read_b64_tr_b16 a[198:199], v32 offset:12288
    v_mfma_f32_16x16x32_bf16 v[104:107], a[240:243], a[216:219], v[104:107]
    ds_read_b64_tr_b16 a[200:201], v30 offset:16384
    v_mfma_f32_16x16x32_bf16 v[108:111], a[244:247], a[216:219], v[108:111]
    s_add_u32 m0, s56, 63744
    ds_read_b64_tr_b16 a[202:203], v30 offset:20480
    v_mfma_f32_16x16x32_bf16 v[148:151], a[216:219], a[248:251], v[148:151]
    buffer_load_dwordx4 v2, s[12:15], s53 offen offset:1792 lds
    v_mfma_f32_16x16x32_bf16 v[176:179], a[216:219], a[252:255], v[176:179]
    ds_read_b64_tr_b16 a[204:205], v32 offset:16384
    v_mfma_f32_16x16x32_bf16 v[64:67], a[232:235], a[220:223], v[64:67]
    s_add_u32 m0, s56, 67840
    ds_read_b64_tr_b16 a[206:207], v32 offset:20480
    v_mfma_f32_16x16x32_bf16 v[68:71], a[236:239], a[220:223], v[68:71]
    buffer_load_dwordx4 v2, s[12:15], s54 offen offset:1792 lds
    v_mfma_f32_16x16x32_bf16 v[112:115], a[240:243], a[220:223], v[112:115]
    ds_read_b128 a[164:167], v8 offset:14336
    v_mfma_f32_16x16x32_bf16 v[116:119], a[244:247], a[220:223], v[116:119]
    ds_read_b128 a[168:171], v8 offset:16384
    v_mfma_f32_16x16x32_bf16 v[152:155], a[220:223], a[248:251], v[152:155]
    s_add_u32 m0, s56, 73728
    s_add_u32 s53, s53, 86016
    ds_read_b128 a[172:175], v8 offset:18432
    v_mfma_f32_16x16x32_bf16 v[180:183], a[220:223], a[252:255], v[180:183]
    buffer_load_dwordx4 v2, s[12:15], s53 offen lds
    v_mfma_f32_16x16x32_bf16 v[72:75], a[232:235], a[224:227], v[72:75]
    ds_read_b128 a[176:179], v8 offset:20480
    v_mfma_f32_16x16x32_bf16 v[76:79], a[236:239], a[224:227], v[76:79]
    ds_read_b128 a[180:183], v8 offset:22528
    v_mfma_f32_16x16x32_bf16 v[120:123], a[240:243], a[224:227], v[120:123]
    s_add_u32 m0, s56, 77824
    s_add_u32 s54, s53, 10752
    v_mfma_f32_16x16x32_bf16 v[124:127], a[244:247], a[224:227], v[124:127]
    buffer_load_dwordx4 v2, s[12:15], s54 offen lds
    v_mfma_f32_16x16x32_bf16 v[156:159], a[224:227], a[248:251], v[156:159]
    v_mfma_f32_16x16x32_bf16 v[184:187], a[224:227], a[252:255], v[184:187]
    v_mfma_f32_16x16x32_bf16 v[80:83], a[232:235], a[228:231], v[80:83]
    s_add_u32 m0, s56, 81024
    v_mfma_f32_16x16x32_bf16 v[84:87], a[236:239], a[228:231], v[84:87]
    buffer_load_dwordx4 v2, s[12:15], s53 offen offset:896 lds
    v_mfma_f32_16x16x32_bf16 v[128:131], a[240:243], a[228:231], v[128:131]
    v_mfma_f32_16x16x32_bf16 v[132:135], a[244:247], a[228:231], v[132:135]
    v_mfma_f32_16x16x32_bf16 v[160:163], a[228:231], a[248:251], v[160:163]
    v_mfma_f32_16x16x32_bf16 v[188:191], a[228:231], a[252:255], v[188:191]
    s_waitcnt vmcnt(12)
    s_waitcnt lgkmcnt(0)
    s_barrier
    v_mfma_f32_16x16x32_bf16 v[40:43], a[184:187], a[160:163], v[40:43]
    s_add_u32 m0, s56, 85120
    ds_read_b128 a[208:211], v9 offset:12288
    v_mfma_f32_16x16x32_bf16 v[44:47], a[188:191], a[160:163], v[44:47]
    buffer_load_dwordx4 v2, s[12:15], s54 offen offset:896 lds
    v_mfma_f32_16x16x32_bf16 v[88:91], a[192:195], a[160:163], v[88:91]
    ds_read_b64_tr_b16 a[232:233], v30 offset:24576
    v_mfma_f32_16x16x32_bf16 v[92:95], a[196:199], a[160:163], v[92:95]
    s_add_u32 m0, s56, 88320
    ds_read_b64_tr_b16 a[234:235], v30 offset:28672
    v_mfma_f32_16x16x32_bf16 v[140:143], a[160:163], a[200:203], v[140:143]
    buffer_load_dwordx4 v2, s[12:15], s53 offen offset:1792 lds
    v_mfma_f32_16x16x32_bf16 v[168:171], a[160:163], a[204:207], v[168:171]
    ds_read_b64_tr_b16 a[236:237], v32 offset:24576
    v_mfma_f32_16x16x32_bf16 v[48:51], a[184:187], a[164:167], v[48:51]
    ds_read_b64_tr_b16 a[238:239], v32 offset:28672
    v_mfma_f32_16x16x32_bf16 v[52:55], a[188:191], a[164:167], v[52:55]
    s_add_u32 m0, s56, 92416
    ds_read_b64_tr_b16 a[240:241], v30 offset:32768
    v_mfma_f32_16x16x32_bf16 v[96:99], a[192:195], a[164:167], v[96:99]
    buffer_load_dwordx4 v2, s[12:15], s54 offen offset:1792 lds
    v_mfma_f32_16x16x32_bf16 v[100:103], a[196:199], a[164:167], v[100:103]
    ds_read_b64_tr_b16 a[242:243], v30 offset:36864
    v_mfma_f32_16x16x32_bf16 v[144:147], a[164:167], a[200:203], v[144:147]
    ds_read_b64_tr_b16 a[244:245], v32 offset:32768
    v_mfma_f32_16x16x32_bf16 v[172:175], a[164:167], a[204:207], v[172:175]
    s_add_u32 m0, s57, 8192
    s_add_u32 s55, s55, 128
    s_cmp_ge_u32 s55, 896
    s_cselect_b32 s55, 0, s55
    v_mfma_f32_16x16x32_bf16 v[56:59], a[184:187], a[168:171], v[56:59]
    buffer_load_dwordx4 v5, s[8:11], s55 offen lds
    v_mfma_f32_16x16x32_bf16 v[60:63], a[188:191], a[168:171], v[60:63]
    ds_read_b64_tr_b16 a[246:247], v32 offset:36864
    v_mfma_f32_16x16x32_bf16 v[104:107], a[192:195], a[168:171], v[104:107]
    ds_read_b64_tr_b16 a[248:249], v30 offset:40960
    v_mfma_f32_16x16x32_bf16 v[108:111], a[196:199], a[168:171], v[108:111]
    s_add_u32 m0, s57, 4096
    ds_read_b64_tr_b16 a[250:251], v30 offset:45056
    v_mfma_f32_16x16x32_bf16 v[148:151], a[168:171], a[200:203], v[148:151]
    buffer_load_dwordx4 v4, s[8:11], s55 offen lds
    v_mfma_f32_16x16x32_bf16 v[176:179], a[168:171], a[204:207], v[176:179]
    ds_read_b64_tr_b16 a[252:253], v32 offset:40960
L_pad_8:
    s_cbranch_execz L_ret
    v_mfma_f32_16x16x32_bf16 v[64:67], a[184:187], a[172:175], v[64:67]
    s_add_u32 m0, s57, 0
    ds_read_b64_tr_b16 a[254:255], v32 offset:45056
    v_mfma_f32_16x16x32_bf16 v[68:71], a[188:191], a[172:175], v[68:71]
    s_mov_b64 exec, s[4:5]
    buffer_load_dwordx4 v3, s[8:11], s55 offen lds
    s_mov_b64 exec, -1
    v_mfma_f32_16x16x32_bf16 v[112:115], a[192:195], a[172:175], v[112:115]
    ds_read_b128 a[212:215], v9 offset:14336
    v_mfma_f32_16x16x32_bf16 v[116:119], a[196:199], a[172:175], v[116:119]
    ds_read_b128 a[216:219], v9 offset:16384
    v_mfma_f32_16x16x32_bf16 v[152:155], a[172:175], a[200:203], v[152:155]
    s_add_u32 m0, s56, 0
    s_add_u32 s53, s53, 86016
    s_cmp_ge_u32 s53, 1204224
    s_cselect_b32 s53, 0, s53
    v_mfma_f32_16x16x32_bf16 v[180:183], a[172:175], a[204:207], v[180:183]
    buffer_load_dwordx4 v2, s[12:15], s53 offen lds
    v_mfma_f32_16x16x32_bf16 v[72:75], a[184:187], a[176:179], v[72:75]
    ds_read_b128 a[220:223], v9 offset:18432
    v_mfma_f32_16x16x32_bf16 v[76:79], a[188:191], a[176:179], v[76:79]
    ds_read_b128 a[224:227], v9 offset:20480
    v_mfma_f32_16x16x32_bf16 v[120:123], a[192:195], a[176:179], v[120:123]
    s_add_u32 m0, s56, 4096
    s_add_u32 s54, s53, 10752
    ds_read_b128 a[228:231], v9 offset:22528
    v_mfma_f32_16x16x32_bf16 v[124:127], a[196:199], a[176:179], v[124:127]
    buffer_load_dwordx4 v2, s[12:15], s54 offen lds
    v_mfma_f32_16x16x32_bf16 v[156:159], a[176:179], a[200:203], v[156:159]
    v_mfma_f32_16x16x32_bf16 v[184:187], a[176:179], a[204:207], v[184:187]
    v_mfma_f32_16x16x32_bf16 v[80:83], a[184:187], a[180:183], v[80:83]
    s_add_u32 m0, s56, 7296
    v_mfma_f32_16x16x32_bf16 v[84:87], a[188:191], a[180:183], v[84:87]
    buffer_load_dwordx4 v2, s[12:15], s53 offen offset:896 lds
    v_mfma_f32_16x16x32_bf16 v[128:131], a[192:195], a[180:183], v[128:131]
    v_mfma_f32_16x16x32_bf16 v[132:135], a[196:199], a[180:183], v[132:135]
    v_mfma_f32_16x16x32_bf16 v[160:163], a[180:183], a[200:203], v[160:163]
    v_mfma_f32_16x16x32_bf16 v[188:191], a[180:183], a[204:207], v[188:191]
    s_waitcnt vmcnt(12)
    s_waitcnt lgkmcnt(0)
    s_barrier
    v_mfma_f32_16x16x32_bf16 v[40:43], a[232:235], a[208:211], v[40:43]
    s_add_u32 m0, s56, 11392
    ds_read_b128 a[160:163], v8 offset:24576
    v_mfma_f32_16x16x32_bf16 v[44:47], a[236:239], a[208:211], v[44:47]
    buffer_load_dwordx4 v2, s[12:15], s54 offen offset:896 lds
    v_mfma_f32_16x16x32_bf16 v[88:91], a[240:243], a[208:211], v[88:91]
    ds_read_b64_tr_b16 a[184:185], v31 offset:0
    v_mfma_f32_16x16x32_bf16 v[92:95], a[244:247], a[208:211], v[92:95]
    s_add_u32 m0, s56, 14592
    ds_read_b64_tr_b16 a[186:187], v31 offset:4096
    v_mfma_f32_16x16x32_bf16 v[140:143], a[208:211], a[248:251], v[140:143]
    buffer_load_dwordx4 v2, s[12:15], s53 offen offset:1792 lds
    v_mfma_f32_16x16x32_bf16 v[168:171], a[208:211], a[252:255], v[168:171]
    ds_read_b64_tr_b16 a[188:189], v33 offset:0
    v_mfma_f32_16x16x32_bf16 v[48:51], a[232:235], a[212:215], v[48:51]
    ds_read_b64_tr_b16 a[190:191], v33 offset:4096
    v_mfma_f32_16x16x32_bf16 v[52:55], a[236:239], a[212:215], v[52:55]
    s_add_u32 m0, s56, 18688
    ds_read_b64_tr_b16 a[192:193], v31 offset:8192
    v_mfma_f32_16x16x32_bf16 v[96:99], a[240:243], a[212:215], v[96:99]
    buffer_load_dwordx4 v2, s[12:15], s54 offen offset:1792 lds
    v_mfma_f32_16x16x32_bf16 v[100:103], a[244:247], a[212:215], v[100:103]
    ds_read_b64_tr_b16 a[194:195], v31 offset:12288
    v_mfma_f32_16x16x32_bf16 v[144:147], a[212:215], a[248:251], v[144:147]
    ds_read_b64_tr_b16 a[196:197], v33 offset:8192
    v_mfma_f32_16x16x32_bf16 v[172:175], a[212:215], a[252:255], v[172:175]
    s_add_u32 m0, s56, 24576
    s_add_u32 s53, s53, 86016
    ds_read_b64_tr_b16 a[198:199], v33 offset:12288
    v_mfma_f32_16x16x32_bf16 v[56:59], a[232:235], a[216:219], v[56:59]
    buffer_load_dwordx4 v2, s[12:15], s53 offen lds
    v_mfma_f32_16x16x32_bf16 v[60:63], a[236:239], a[216:219], v[60:63]
    ds_read_b64_tr_b16 a[200:201], v31 offset:16384
    v_mfma_f32_16x16x32_bf16 v[104:107], a[240:243], a[216:219], v[104:107]
    ds_read_b64_tr_b16 a[202:203], v31 offset:20480
    v_mfma_f32_16x16x32_bf16 v[108:111], a[244:247], a[216:219], v[108:111]
    s_add_u32 m0, s56, 28672
    s_add_u32 s54, s53, 10752
    ds_read_b64_tr_b16 a[204:205], v33 offset:16384
    v_mfma_f32_16x16x32_bf16 v[148:151], a[216:219], a[248:251], v[148:151]
    buffer_load_dwordx4 v2, s[12:15], s54 offen lds
    v_mfma_f32_16x16x32_bf16 v[176:179], a[216:219], a[252:255], v[176:179]
    ds_read_b64_tr_b16 a[206:207], v33 offset:20480
    v_mfma_f32_16x16x32_bf16 v[64:67], a[232:235], a[220:223], v[64:67]
    s_add_u32 m0, s56, 31872
    ds_read_b128 a[164:167], v8 offset:26624
    v_mfma_f32_16x16x32_bf16 v[68:71], a[236:239], a[220:223], v[68:71]
    buffer_load_dwordx4 v2, s[12:15], s53 offen offset:896 lds
    v_mfma_f32_16x16x32_bf16 v[112:115], a[240:243], a[220:223], v[112:115]
    ds_read_b128 a[168:171], v8 offset:28672
    v_mfma_f32_16x16x32_bf16 v[116:119], a[244:247], a[220:223], v[116:119]
    ds_read_b128 a[172:175], v8 offset:30720
    v_mfma_f32_16x16x32_bf16 v[152:155], a[220:223], a[248:251], v[152:155]
    s_add_u32 m0, s56, 35968
    ds_read_b128 a[176:179], v8 offset:32768
    v_mfma_f32_16x16x32_bf16 v[180:183], a[220:223], a[252:255], v[180:183]
    buffer_load_dwordx4 v2, s[12:15], s54 offen offset:896 lds
    v_mfma_f32_16x16x32_bf16 v[72:75], a[232:235], a[224:227], v[72:75]
    ds_read_b128 a[180:183], v8 offset:34816
    v_mfma_f32_16x16x32_bf16 v[76:79], a[236:239], a[224:227], v[76:79]
    v_mfma_f32_16x16x32_bf16 v[120:123], a[240:243], a[224:227], v[120:123]
    s_add_u32 m0, s56, 39168
    v_mfma_f32_16x16x32_bf16 v[124:127], a[244:247], a[224:227], v[124:127]
    buffer_load_dwordx4 v2, s[12:15], s53 offen offset:1792 lds
    v_mfma_f32_16x16x32_bf16 v[156:159], a[224:227], a[248:251], v[156:159]
    v_mfma_f32_16x16x32_bf16 v[184:187], a[224:227], a[252:255], v[184:187]
    v_mfma_f32_16x16x32_bf16 v[80:83], a[232:235], a[228:231], v[80:83]
    s_add_u32 m0, s56, 43264
    v_mfma_f32_16x16x32_bf16 v[84:87], a[236:239], a[228:231], v[84:87]
    buffer_load_dwordx4 v2, s[12:15], s54 offen offset:1792 lds
    v_mfma_f32_16x16x32_bf16 v[128:131], a[240:243], a[228:231], v[128:131]
    v_mfma_f32_16x16x32_bf16 v[132:135], a[244:247], a[228:231], v[132:135]
    v_mfma_f32_16x16x32_bf16 v[160:163], a[228:231], a[248:251], v[160:163]
    v_mfma_f32_16x16x32_bf16 v[188:191], a[228:231], a[252:255], v[188:191]
    s_waitcnt vmcnt(15)
    s_waitcnt lgkmcnt(0)
    s_barrier
    v_mfma_f32_16x16x32_bf16 v[40:43], a[184:187], a[160:163], v[40:43]
    s_add_u32 m0, s57, 20480
    s_add_u32 s55, s55, 128
    s_cmp_ge_u32 s55, 896
    s_cselect_b32 s55, 0, s55
    v_mfma_f32_16x16x32_bf16 v[44:47], a[188:191], a[160:163], v[44:47]
    buffer_load_dwordx4 v5, s[8:11], s55 offen lds
    v_mfma_f32_16x16x32_bf16 v[88:91], a[192:195], a[160:163], v[88:91]
    ds_read_b128 a[208:211], v9 offset:24576
    v_mfma_f32_16x16x32_bf16 v[92:95], a[196:199], a[160:163], v[92:95]
    s_add_u32 m0, s57, 16384
    ds_read_b64_tr_b16 a[232:233], v31 offset:24576
    v_mfma_f32_16x16x32_bf16 v[140:143], a[160:163], a[200:203], v[140:143]
    buffer_load_dwordx4 v4, s[8:11], s55 offen lds
    v_mfma_f32_16x16x32_bf16 v[168:171], a[160:163], a[204:207], v[168:171]
    ds_read_b64_tr_b16 a[234:235], v31 offset:28672
    v_mfma_f32_16x16x32_bf16 v[48:51], a[184:187], a[164:167], v[48:51]
    ds_read_b64_tr_b16 a[236:237], v33 offset:24576
    v_mfma_f32_16x16x32_bf16 v[52:55], a[188:191], a[164:167], v[52:55]
    s_add_u32 m0, s57, 12288
    ds_read_b64_tr_b16 a[238:239], v33 offset:28672
    v_mfma_f32_16x16x32_bf16 v[96:99], a[192:195], a[164:167], v[96:99]
    s_mov_b64 exec, s[4:5]
    buffer_load_dwordx4 v3, s[8:11], s55 offen lds
    s_mov_b64 exec, -1
    v_mfma_f32_16x16x32_bf16 v[100:103], a[196:199], a[164:167], v[100:103]
    ds_read_b64_tr_b16 a[240:241], v31 offset:32768
    v_mfma_f32_16x16x32_bf16 v[144:147], a[164:167], a[200:203], v[144:147]
    ds_read_b64_tr_b16 a[242:243], v31 offset:36864
    v_mfma_f32_16x16x32_bf16 v[172:175], a[164:167], a[204:207], v[172:175]
    s_add_u32 m0, s56, 49152
    s_add_u32 s53, s53, 86016
    s_cmp_ge_u32 s53, 1204224
    s_cselect_b32 s53, 0, s53
    v_mfma_f32_16x16x32_bf16 v[56:59], a[184:187], a[168:171], v[56:59]
    buffer_load_dwordx4 v2, s[12:15], s53 offen lds
    v_mfma_f32_16x16x32_bf16 v[60:63], a[188:191], a[168:171], v[60:63]
    ds_read_b64_tr_b16 a[244:245], v33 offset:32768
    v_mfma_f32_16x16x32_bf16 v[104:107], a[192:195], a[168:171], v[104:107]
    ds_read_b64_tr_b16 a[246:247], v33 offset:36864
    v_mfma_f32_16x16x32_bf16 v[108:111], a[196:199], a[168:171], v[108:111]
    s_add_u32 m0, s56, 53248
    s_add_u32 s54, s53, 10752
    ds_read_b64_tr_b16 a[248:249], v31 offset:40960
    v_mfma_f32_16x16x32_bf16 v[148:151], a[168:171], a[200:203], v[148:151]
    buffer_load_dwordx4 v2, s[12:15], s54 offen lds
    v_mfma_f32_16x16x32_bf16 v[176:179], a[168:171], a[204:207], v[176:179]
    ds_read_b64_tr_b16 a[250:251], v31 offset:45056
    v_mfma_f32_16x16x32_bf16 v[64:67], a[184:187], a[172:175], v[64:67]
    s_add_u32 m0, s56, 56448
    ds_read_b64_tr_b16 a[252:253], v33 offset:40960
    v_mfma_f32_16x16x32_bf16 v[68:71], a[188:191], a[172:175], v[68:71]
    buffer_load_dwordx4 v2, s[12:15], s53 offen offset:896 lds
    v_mfma_f32_16x16x32_bf16 v[112:115], a[192:195], a[172:175], v[112:115]
    ds_read_b64_tr_b16 a[254:255], v33 offset:45056
    v_mfma_f32_16x16x32_bf16 v[116:119], a[196:199], a[172:175], v[116:119]
    ds_read_b128 a[212:215], v9 offset:26624
    v_mfma_f32_16x16x32_bf16 v[152:155], a[172:175], a[200:203], v[152:155]
    s_add_u32 m0, s56, 60544
    ds_read_b128 a[216:219], v9 offset:28672
    v_mfma_f32_16x16x32_bf16 v[180:183], a[172:175], a[204:207], v[180:183]
    buffer_load_dwordx4 v2, s[12:15], s54 offen offset:896 lds
    v_mfma_f32_16x16x32_bf16 v[72:75], a[184:187], a[176:179], v[72:75]
    ds_read_b128 a[220:223], v9 offset:30720
    v_mfma_f32_16x16x32_bf16 v[76:79], a[188:191], a[176:179], v[76:79]
    ds_read_b128 a[224:227], v9 offset:32768
    v_mfma_f32_16x16x32_bf16 v[120:123], a[192:195], a[176:179], v[120:123]
    s_add_u32 m0, s56, 63744
    ds_read_b128 a[228:231], v9 offset:34816
    v_mfma_f32_16x16x32_bf16 v[124:127], a[196:199], a[176:179], v[124:127]
    buffer_load_dwordx4 v2, s[12:15], s53 offen offset:1792 lds
    v_mfma_f32_16x16x32_bf16 v[156:159], a[176:179], a[200:203], v[156:159]
    v_mfma_f32_16x16x32_bf16 v[184:187], a[176:179], a[204:207], v[184:187]
    v_mfma_f32_16x16x32_bf16 v[80:83], a[184:187], a[180:183], v[80:83]
    s_add_u32 m0, s56, 67840
    v_mfma_f32_16x16x32_bf16 v[84:87], a[188:191], a[180:183], v[84:87]
    buffer_load_dwordx4 v2, s[12:15], s54 offen offset:1792 lds
    v_mfma_f32_16x16x32_bf16 v[128:131], a[192:195], a[180:183], v[128:131]
    v_mfma_f32_16x16x32_bf16 v[132:135], a[196:199], a[180:183], v[132:135]
    v_mfma_f32_16x16x32_bf16 v[160:163], a[180:183], a[200:203], v[160:163]
    v_mfma_f32_16x16x32_bf16 v[188:191], a[180:183], a[204:207], v[188:191]
    s_waitcnt vmcnt(15)
    s_waitcnt lgkmcnt(0)
    s_barrier
    v_mfma_f32_16x16x32_bf16 v[40:43], a[232:235], a[208:211], v[40:43]
    s_add_u32 m0, s56, 73728
    s_add_u32 s53, s53, 86016
    ds_read_b128 a[160:163], v8 offset:0
    v_mfma_f32_16x16x32_bf16 v[44:47], a[236:239], a[208:211], v[44:47]
    buffer_load_dwordx4 v2, s[12:15], s53 offen lds
    v_mfma_f32_16x16x32_bf16 v[88:91], a[240:243], a[208:211], v[88:91]
    ds_read_b64_tr_b16 a[184:185], v30 offset:0
    v_mfma_f32_16x16x32_bf16 v[92:95], a[244:247], a[208:211], v[92:95]
    s_add_u32 m0, s56, 77824
    s_add_u32 s54, s53, 10752
    ds_read_b64_tr_b16 a[186:187], v30 offset:4096
    v_mfma_f32_16x16x32_bf16 v[140:143], a[208:211], a[248:251], v[140:143]
    buffer_load_dwordx4 v2, s[12:15], s54 offen lds
    v_mfma_f32_16x16x32_bf16 v[168:171], a[208:211], a[252:255], v[168:171]
    ds_read_b64_tr_b16 a[188:189], v32 offset:0
    v_mfma_f32_16x16x32_bf16 v[48:51], a[232:235], a[212:215], v[48:51]
    ds_read_b64_tr_b16 a[190:191], v32 offset:4096
    v_mfma_f32_16x16x32_bf16 v[52:55], a[236:239], a[212:215], v[52:55]
    s_add_u32 m0, s56, 81024
    ds_read_b64_tr_b16 a[192:193], v30 offset:8192
    v_mfma_f32_16x16x32_bf16 v[96:99], a[240:243], a[212:215], v[96:99]
    buffer_load_dwordx4 v2, s[12:15], s53 offen offset:896 lds
    v_mfma_f32_16x16x32_bf16 v[100:103], a[244:247], a[212:215], v[100:103]
    ds_read_b64_tr_b16 a[194:195], v30 offset:12288
    v_mfma_f32_16x16x32_bf16 v[144:147], a[212:215], a[248:251], v[144:147]
    ds_read_b64_tr_b16 a[196:197], v32 offset:8192
    v_mfma_f32_16x16x32_bf16 v[172:175], a[212:215], a[252:255], v[172:175]
    s_add_u32 m0, s56, 85120
    ds_read_b64_tr_b16 a[198:199], v32 offset:12288
    v_mfma_f32_16x16x32_bf16 v[56:59], a[232:235], a[216:219], v[56:59]
    buffer_load_dwordx4 v2, s[12:15], s54 offen offset:896 lds
    v_mfma_f32_16x16x32_bf16 v[60:63], a[236:239], a[216:219], v[60:63]
    ds_read_b64_tr_b16 a[200:201], v30 offset:16384
    v_mfma_f32_16x16x32_bf16 v[104:107], a[240:243], a[216:219], v[104:107]
    ds_read_b64_tr_b16 a[202:203], v30 offset:20480
    v_mfma_f32_16x16x32_bf16 v[108:111], a[244:247], a[216:219], v[108:111]
    s_add_u32 m0, s56, 88320
    ds_read_b64_tr_b16 a[204:205], v32 offset:16384
    v_mfma_f32_16x16x32_bf16 v[148:151], a[216:219], a[248:251], v[148:151]
    buffer_load_dwordx4 v2, s[12:15], s53 offen offset:1792 lds
    v_mfma_f32_16x16x32_bf16 v[176:179], a[216:219], a[252:255], v[176:179]
    ds_read_b64_tr_b16 a[206:207], v32 offset:20480
    v_mfma_f32_16x16x32_bf16 v[64:67], a[232:235], a[220:223], v[64:67]
    s_add_u32 m0, s56, 92416
    ds_read_b128 a[164:167], v8 offset:2048
    v_mfma_f32_16x16x32_bf16 v[68:71], a[236:239], a[220:223], v[68:71]
    buffer_load_dwordx4 v2, s[12:15], s54 offen offset:1792 lds
    v_mfma_f32_16x16x32_bf16 v[112:115], a[240:243], a[220:223], v[112:115]
    ds_read_b128 a[168:171], v8 offset:4096
    v_mfma_f32_16x16x32_bf16 v[116:119], a[244:247], a[220:223], v[116:119]
    ds_read_b128 a[172:175], v8 offset:6144
    v_mfma_f32_16x16x32_bf16 v[152:155], a[220:223], a[248:251], v[152:155]
    s_add_u32 m0, s57, 32768
    s_add_u32 s55, s55, 128
    s_cmp_ge_u32 s55, 896
    s_cselect_b32 s55, 0, s55
    v_mfma_f32_16x16x32_bf16 v[180:183], a[220:223], a[252:255], v[180:183]
    buffer_load_dwordx4 v5, s[8:11], s55 offen lds
    v_mfma_f32_16x16x32_bf16 v[72:75], a[232:235], a[224:227], v[72:75]
    ds_read_b128 a[176:179], v8 offset:8192
    v_mfma_f32_16x16x32_bf16 v[76:79], a[236:239], a[224:227], v[76:79]
    ds_read_b128 a[180:183], v8 offset:10240
    v_mfma_f32_16x16x32_bf16 v[120:123], a[240:243], a[224:227], v[120:123]
    s_add_u32 m0, s57, 28672
    v_mfma_f32_16x16x32_bf16 v[124:127], a[244:247], a[224:227], v[124:127]
    buffer_load_dwordx4 v4, s[8:11], s55 offen lds
    v_mfma_f32_16x16x32_bf16 v[156:159], a[224:227], a[248:251], v[156:159]
    v_mfma_f32_16x16x32_bf16 v[184:187], a[224:227], a[252:255], v[184:187]
    v_mfma_f32_16x16x32_bf16 v[80:83], a[232:235], a[228:231], v[80:83]
    s_add_u32 m0, s57, 24576
    v_mfma_f32_16x16x32_bf16 v[84:87], a[236:239], a[228:231], v[84:87]
    s_mov_b64 exec, s[4:5]
    buffer_load_dwordx4 v3, s[8:11], s55 offen lds
    s_mov_b64 exec, -1
    v_mfma_f32_16x16x32_bf16 v[128:131], a[240:243], a[228:231], v[128:131]
    v_mfma_f32_16x16x32_bf16 v[132:135], a[244:247], a[228:231], v[132:135]
    v_mfma_f32_16x16x32_bf16 v[160:163], a[228:231], a[248:251], v[160:163]
    v_mfma_f32_16x16x32_bf16 v[188:191], a[228:231], a[252:255], v[188:191]
    buffer_load_dwordx2 v[28:29], v24, s[40:43], 0 offen sc1
    s_waitcnt vmcnt(19)
    s_waitcnt lgkmcnt(0)
    s_barrier
    v_mfma_f32_16x16x32_bf16 v[40:43], a[184:187], a[160:163], v[40:43]
    s_add_u32 m0, s56, 0
    s_add_u32 s53, s53, 86016
    s_cmp_ge_u32 s53, 1204224
    s_cselect_b32 s53, 0, s53
    v_mfma_f32_16x16x32_bf16 v[44:47], a[188:191], a[160:163], v[44:47]
    buffer_load_dwordx4 v2, s[12:15], s53 offen lds
    v_mfma_f32_16x16x32_bf16 v[88:91], a[192:195], a[160:163], v[88:91]
    ds_read_b128 a[208:211], v9 offset:0
    v_mfma_f32_16x16x32_bf16 v[92:95], a[196:199], a[160:163], v[92:95]
    ds_read_b64_tr_b16 a[232:233], v30 offset:24576
    v_mfma_f32_16x16x32_bf16 v[140:143], a[160:163], a[200:203], v[140:143]
    ds_read_b64_tr_b16 a[234:235], v30 offset:28672
    v_mfma_f32_16x16x32_bf16 v[168:171], a[160:163], a[204:207], v[168:171]
    s_add_u32 m0, s56, 4096
    s_add_u32 s54, s53, 10752
    ds_read_b64_tr_b16 a[236:237], v32 offset:24576
    v_mfma_f32_16x16x32_bf16 v[48:51], a[184:187], a[164:167], v[48:51]
    buffer_load_dwordx4 v2, s[12:15], s54 offen lds
    v_mfma_f32_16x16x32_bf16 v[52:55], a[188:191], a[164:167], v[52:55]
    ds_read_b64_tr_b16 a[238:239], v32 offset:28672
    v_mfma_f32_16x16x32_bf16 v[96:99], a[192:195], a[164:167], v[96:99]
    ds_read_b64_tr_b16 a[240:241], v30 offset:32768
    v_mfma_f32_16x16x32_bf16 v[100:103], a[196:199], a[164:167], v[100:103]
    ds_read_b64_tr_b16 a[242:243], v30 offset:36864
    v_mfma_f32_16x16x32_bf16 v[144:147], a[164:167], a[200:203], v[144:147]
    ds_read_b64_tr_b16 a[244:245], v32 offset:32768
    v_mfma_f32_16x16x32_bf16 v[172:175], a[164:167], a[204:207], v[172:175]
    s_add_u32 m0, s56, 7296
    ds_read_b64_tr_b16 a[246:247], v32 offset:36864
    v_mfma_f32_16x16x32_bf16 v[56:59], a[184:187], a[168:171], v[56:59]
    buffer_load_dwordx4 v2, s[12:15], s53 offen offset:896 lds
    v_mfma_f32_16x16x32_bf16 v[60:63], a[188:191], a[168:171], v[60:63]
    ds_read_b64_tr_b16 a[248:249], v30 offset:40960
    v_mfma_f32_16x16x32_bf16 v[104:107], a[192:195], a[168:171], v[104:107]
    ds_read_b64_tr_b16 a[250:251], v30 offset:45056
    v_mfma_f32_16x16x32_bf16 v[108:111], a[196:199], a[168:171], v[108:111]
    ds_read_b64_tr_b16 a[252:253], v32 offset:40960
    v_mfma_f32_16x16x32_bf16 v[148:151], a[168:171], a[200:203], v[148:151]
    ds_read_b64_tr_b16 a[254:255], v32 offset:45056
    v_mfma_f32_16x16x32_bf16 v[176:179], a[168:171], a[204:207], v[176:179]
    s_add_u32 m0, s56, 11392
    ds_read_b128 a[212:215], v9 offset:2048
    v_mfma_f32_16x16x32_bf16 v[64:67], a[184:187], a[172:175], v[64:67]
    buffer_load_dwordx4 v2, s[12:15], s54 offen offset:896 lds
    v_mfma_f32_16x16x32_bf16 v[68:71], a[188:191], a[172:175], v[68:71]
    ds_read_b128 a[216:219], v9 offset:4096
    v_mfma_f32_16x16x32_bf16 v[112:115], a[192:195], a[172:175], v[112:115]
    ds_read_b128 a[220:223], v9 offset:6144
    v_mfma_f32_16x16x32_bf16 v[116:119], a[196:199], a[172:175], v[116:119]
    ds_read_b128 a[224:227], v9 offset:8192
    v_mfma_f32_16x16x32_bf16 v[152:155], a[172:175], a[200:203], v[152:155]
    s_add_u32 m0, s56, 14592
    ds_read_b128 a[228:231], v9 offset:10240
    v_mfma_f32_16x16x32_bf16 v[180:183], a[172:175], a[204:207], v[180:183]
    buffer_load_dwordx4 v2, s[12:15], s53 offen offset:1792 lds
    v_mfma_f32_16x16x32_bf16 v[72:75], a[184:187], a[176:179], v[72:75]
    v_mfma_f32_16x16x32_bf16 v[76:79], a[188:191], a[176:179], v[76:79]
    v_mfma_f32_16x16x32_bf16 v[120:123], a[192:195], a[176:179], v[120:123]
    v_mfma_f32_16x16x32_bf16 v[124:127], a[196:199], a[176:179], v[124:127]
    v_mfma_f32_16x16x32_bf16 v[156:159], a[176:179], a[200:203], v[156:159]
    s_add_u32 m0, s56, 18688
    v_mfma_f32_16x16x32_bf16 v[184:187], a[176:179], a[204:207], v[184:187]
    buffer_load_dwordx4 v2, s[12:15], s54 offen offset:1792 lds
    v_mfma_f32_16x16x32_bf16 v[80:83], a[184:187], a[180:183], v[80:83]
    v_mfma_f32_16x16x32_bf16 v[84:87], a[188:191], a[180:183], v[84:87]
    v_mfma_f32_16x16x32_bf16 v[128:131], a[192:195], a[180:183], v[128:131]
    v_mfma_f32_16x16x32_bf16 v[132:135], a[196:199], a[180:183], v[132:135]
    v_mfma_f32_16x16x32_bf16 v[160:163], a[180:183], a[200:203], v[160:163]
    v_mfma_f32_16x16x32_bf16 v[188:191], a[180:183], a[204:207], v[188:191]
    s_waitcnt vmcnt(16)
    s_waitcnt lgkmcnt(0)
    s_barrier
    v_mfma_f32_16x16x32_bf16 v[40:43], a[232:235], a[208:211], v[40:43]
    s_add_u32 m0, s56, 24576
    s_add_u32 s53, s53, 86016
    ds_read_b128 a[160:163], v8 offset:12288
    v_mfma_f32_16x16x32_bf16 v[44:47], a[236:239], a[208:211], v[44:47]
    buffer_load_dwordx4 v2, s[12:15], s53 offen lds
    v_mfma_f32_16x16x32_bf16 v[88:91], a[240:243], a[208:211], v[88:91]
    ds_read_b64_tr_b16 a[184:185], v31 offset:0
    v_mfma_f32_16x16x32_bf16 v[92:95], a[244:247], a[208:211], v[92:95]
    s_add_u32 m0, s56, 28672
    s_add_u32 s54, s53, 10752
    ds_read_b64_tr_b16 a[186:187], v31 offset:4096
    v_mfma_f32_16x16x32_bf16 v[140:143], a[208:211], a[248:251], v[140:143]
    buffer_load_dwordx4 v2, s[12:15], s54 offen lds
    v_mfma_f32_16x16x32_bf16 v[168:171], a[208:211], a[252:255], v[168:171]
    ds_read_b64_tr_b16 a[188:189], v33 offset:0
    v_mfma_f32_16x16x32_bf16 v[48:51], a[232:235], a[212:215], v[48:51]
    ds_read_b64_tr_b16 a[190:191], v33 offset:4096
    v_mfma_f32_16x16x32_bf16 v[52:55], a[236:239], a[212:215], v[52:55]
    s_add_u32 m0, s56, 31872
    ds_read_b64_tr_b16 a[192:193], v31 offset:8192
    v_mfma_f32_16x16x32_bf16 v[96:99], a[240:243], a[212:215], v[96:99]
    buffer_load_dwordx4 v2, s[12:15], s53 offen offset:896 lds
    v_mfma_f32_16x16x32_bf16 v[100:103], a[244:247], a[212:215], v[100:103]
    ds_read_b64_tr_b16 a[194:195], v31 offset:12288
    v_mfma_f32_16x16x32_bf16 v[144:147], a[212:215], a[248:251], v[144:147]
    ds_read_b64_tr_b16 a[196:197], v33 offset:8192
    v_mfma_f32_16x16x32_bf16 v[172:175], a[212:215], a[252:255], v[172:175]
    s_add_u32 m0, s56, 35968
    ds_read_b64_tr_b16 a[198:199], v33 offset:12288
    v_mfma_f32_16x16x32_bf16 v[56:59], a[232:235], a[216:219], v[56:59]
    buffer_load_dwordx4 v2, s[12:15], s54 offen offset:896 lds
    v_mfma_f32_16x16x32_bf16 v[60:63], a[236:239], a[216:219], v[60:63]
    ds_read_b64_tr_b16 a[200:201], v31 offset:16384
    v_mfma_f32_16x16x32_bf16 v[104:107], a[240:243], a[216:219], v[104:107]
    ds_read_b64_tr_b16 a[202:203], v31 offset:20480
    v_mfma_f32_16x16x32_bf16 v[108:111], a[244:247], a[216:219], v[108:111]
    s_add_u32 m0, s56, 39168
    ds_read_b64_tr_b16 a[204:205], v33 offset:16384
    v_mfma_f32_16x16x32_bf16 v[148:151], a[216:219], a[248:251], v[148:151]
    buffer_load_dwordx4 v2, s[12:15], s53 offen offset:1792 lds
    v_mfma_f32_16x16x32_bf16 v[176:179], a[216:219], a[252:255], v[176:179]
    ds_read_b64_tr_b16 a[206:207], v33 offset:20480
    v_mfma_f32_16x16x32_bf16 v[64:67], a[232:235], a[220:223], v[64:67]
    s_add_u32 m0, s56, 43264
    ds_read_b128 a[164:167], v8 offset:14336
    v_mfma_f32_16x16x32_bf16 v[68:71], a[236:239], a[220:223], v[68:71]
    buffer_load_dwordx4 v2, s[12:15], s54 offen offset:1792 lds
    v_mfma_f32_16x16x32_bf16 v[112:115], a[240:243], a[220:223], v[112:115]
    ds_read_b128 a[168:171], v8 offset:16384
    v_mfma_f32_16x16x32_bf16 v[116:119], a[244:247], a[220:223], v[116:119]
    ds_read_b128 a[172:175], v8 offset:18432
    v_mfma_f32_16x16x32_bf16 v[152:155], a[220:223], a[248:251], v[152:155]
    s_add_u32 m0, s57, 8192
    s_add_u32 s55, s55, 128
    s_cmp_ge_u32 s55, 896
    s_cselect_b32 s55, 0, s55
    v_mfma_f32_16x16x32_bf16 v[180:183], a[220:223], a[252:255], v[180:183]
    buffer_load_dwordx4 v5, s[8:11], s55 offen lds
    v_mfma_f32_16x16x32_bf16 v[72:75], a[232:235], a[224:227], v[72:75]
    ds_read_b128 a[176:179], v8 offset:20480
    v_mfma_f32_16x16x32_bf16 v[76:79], a[236:239], a[224:227], v[76:79]
    ds_read_b128 a[180:183], v8 offset:22528
    v_mfma_f32_16x16x32_bf16 v[120:123], a[240:243], a[224:227], v[120:123]
    s_add_u32 m0, s57, 4096
    v_mfma_f32_16x16x32_bf16 v[124:127], a[244:247], a[224:227], v[124:127]
    buffer_load_dwordx4 v4, s[8:11], s55 offen lds
    v_mfma_f32_16x16x32_bf16 v[156:159], a[224:227], a[248:251], v[156:159]
    v_mfma_f32_16x16x32_bf16 v[184:187], a[224:227], a[252:255], v[184:187]
    v_mfma_f32_16x16x32_bf16 v[80:83], a[232:235], a[228:231], v[80:83]
    s_add_u32 m0, s57, 0
    v_mfma_f32_16x16x32_bf16 v[84:87], a[236:239], a[228:231], v[84:87]
    s_mov_b64 exec, s[4:5]
    buffer_load_dwordx4 v3, s[8:11], s55 offen lds
    s_mov_b64 exec, -1
    v_mfma_f32_16x16x32_bf16 v[128:131], a[240:243], a[228:231], v[128:131]
    v_mfma_f32_16x16x32_bf16 v[132:135], a[244:247], a[228:231], v[132:135]
    v_mfma_f32_16x16x32_bf16 v[160:163], a[228:231], a[248:251], v[160:163]
    v_mfma_f32_16x16x32_bf16 v[188:191], a[228:231], a[252:255], v[188:191]
    s_waitcnt vmcnt(15)
    v_cmp_ne_u64 vcc, s[44:45], v[28:29]
    s_mov_b32 s65, 0
    s_cbranch_vccz L_polled_30
L_poll_29:
    buffer_load_dwordx2 v[28:29], v24, s[40:43], 0 offen sc1
    s_waitcnt vmcnt(0)
    v_cmp_ne_u64 vcc, s[44:45], v[28:29]
    s_add_u32 s65, s65, 1
    s_cbranch_vccz L_polled_30
    s_cmp_lt_u32 s65, 200000
    s_cbranch_scc1 L_poll_29
L_polled_30:
    buffer_load_dwordx4 v[16:19], v25, s[40:43], s0 offen sc1
    s_waitcnt lgkmcnt(0)
    s_barrier
    v_mfma_f32_16x16x32_bf16 v[40:43], a[184:187], a[160:163], v[40:43]
    s_add_u32 m0, s56, 49152
    s_add_u32 s53, s53, 86016
    s_cmp_ge_u32 s53, 1204224
    s_cselect_b32 s53, 0, s53
    v_mfma_f32_16x16x32_bf16 v[44:47], a[188:191], a[160:163], v[44:47]
    buffer_load_dwordx4 v2, s[12:15], s53 offen lds
    v_mfma_f32_16x16x32_bf16 v[88:91], a[192:195], a[160:163], v[88:91]
    ds_read_b128 a[208:211], v9 offset:12288
    v_mfma_f32_16x16x32_bf16 v[92:95], a[196:199], a[160:163], v[92:95]
    ds_read_b64_tr_b16 a[232:233], v31 offset:24576
    v_mfma_f32_16x16x32_bf16 v[140:143], a[160:163], a[200:203], v[140:143]
    ds_read_b64_tr_b16 a[234:235], v31 offset:28672
    v_mfma_f32_16x16x32_bf16 v[168:171], a[160:163], a[204:207], v[168:171]
    s_add_u32 m0, s56, 53248
    s_add_u32 s54, s53, 10752
    ds_read_b64_tr_b16 a[236:237], v33 offset:24576
    v_mfma_f32_16x16x32_bf16 v[48:51], a[184:187], a[164:167], v[48:51]
    buffer_load_dwordx4 v2, s[12:15], s54 offen lds
    v_mfma_f32_16x16x32_bf16 v[52:55], a[188:191], a[164:167], v[52:55]
    ds_read_b64_tr_b16 a[238:239], v33 offset:28672
    v_mfma_f32_16x16x32_bf16 v[96:99], a[192:195], a[164:167], v[96:99]
    ds_read_b64_tr_b16 a[240:241], v31 offset:32768
    v_mfma_f32_16x16x32_bf16 v[100:103], a[196:199], a[164:167], v[100:103]
    ds_read_b64_tr_b16 a[242:243], v31 offset:36864
    v_mfma_f32_16x16x32_bf16 v[144:147], a[164:167], a[200:203], v[144:147]
    ds_read_b64_tr_b16 a[244:245], v33 offset:32768
    v_mfma_f32_16x16x32_bf16 v[172:175], a[164:167], a[204:207], v[172:175]
    s_add_u32 m0, s56, 56448
    ds_read_b64_tr_b16 a[246:247], v33 offset:36864
    v_mfma_f32_16x16x32_bf16 v[56:59], a[184:187], a[168:171], v[56:59]
    buffer_load_dwordx4 v2, s[12:15], s53 offen offset:896 lds
    v_mfma_f32_16x16x32_bf16 v[60:63], a[188:191], a[168:171], v[60:63]
    ds_read_b64_tr_b16 a[248:249], v31 offset:40960
    v_mfma_f32_16x16x32_bf16 v[104:107], a[192:195], a[168:171], v[104:107]
    ds_read_b64_tr_b16 a[250:251], v31 offset:45056
    v_mfma_f32_16x16x32_bf16 v[108:111], a[196:199], a[168:171], v[108:111]
    ds_read_b64_tr_b16 a[252:253], v33 offset:40960
    v_mfma_f32_16x16x32_bf16 v[148:151], a[168:171], a[200:203], v[148:151]
    ds_read_b64_tr_b16 a[254:255], v33 offset:45056
    v_mfma_f32_16x16x32_bf16 v[176:179], a[168:171], a[204:207], v[176:179]
    s_add_u32 m0, s56, 60544
    ds_read_b128 a[212:215], v9 offset:14336
    v_mfma_f32_16x16x32_bf16 v[64:67], a[184:187], a[172:175], v[64:67]
    buffer_load_dwordx4 v2, s[12:15], s54 offen offset:896 lds
    v_mfma_f32_16x16x32_bf16 v[68:71], a[188:191], a[172:175], v[68:71]
    ds_read_b128 a[216:219], v9 offset:16384
    v_mfma_f32_16x16x32_bf16 v[112:115], a[192:195], a[172:175], v[112:115]
    ds_read_b128 a[220:223], v9 offset:18432
    v_mfma_f32_16x16x32_bf16 v[116:119], a[196:199], a[172:175], v[116:119]
    ds_read_b128 a[224:227], v9 offset:20480
    v_mfma_f32_16x16x32_bf16 v[152:155], a[172:175], a[200:203], v[152:155]
    s_add_u32 m0, s56, 63744
    ds_read_b128 a[228:231], v9 offset:22528
    v_mfma_f32_16x16x32_bf16 v[180:183], a[172:175], a[204:207], v[180:183]
    buffer_load_dwordx4 v2, s[12:15], s53 offen offset:1792 lds
    v_mfma_f32_16x16x32_bf16 v[72:75], a[184:187], a[176:179], v[72:75]
    v_mfma_f32_16x16x32_bf16 v[76:79], a[188:191], a[176:179], v[76:79]
    v_mfma_f32_16x16x32_bf16 v[120:123], a[192:195], a[176:179], v[120:123]
    v_mfma_f32_16x16x32_bf16 v[124:127], a[196:199], a[176:179], v[124:127]
    v_mfma_f32_16x16x32_bf16 v[156:159], a[176:179], a[200:203], v[156:159]
    s_add_u32 m0, s56, 67840
    v_mfma_f32_16x16x32_bf16 v[184:187], a[176:179], a[204:207], v[184:187]
    buffer_load_dwordx4 v2, s[12:15], s54 offen offset:1792 lds
    v_mfma_f32_16x16x32_bf16 v[80:83], a[184:187], a[180:183], v[80:83]
    v_mfma_f32_16x16x32_bf16 v[84:87], a[188:191], a[180:183], v[84:87]
    v_mfma_f32_16x16x32_bf16 v[128:131], a[192:195], a[180:183], v[128:131]
    v_mfma_f32_16x16x32_bf16 v[132:135], a[196:199], a[180:183], v[132:135]
    v_mfma_f32_16x16x32_bf16 v[160:163], a[180:183], a[200:203], v[160:163]
    v_mfma_f32_16x16x32_bf16 v[188:191], a[180:183], a[204:207], v[188:191]
    buffer_load_dwordx2 v[164:165], v37, s[24:27], 0 offen offset:60
    s_waitcnt vmcnt(17)
    s_waitcnt lgkmcnt(0)
    s_barrier
    v_mfma_f32_16x16x32_bf16 v[40:43], a[232:235], a[208:211], v[40:43]
    s_add_u32 m0, s56, 73728
    s_add_u32 s53, s53, 86016
    ds_read_b128 a[160:163], v8 offset:24576
    v_mfma_f32_16x16x32_bf16 v[44:47], a[236:239], a[208:211], v[44:47]
    buffer_load_dwordx4 v2, s[12:15], s53 offen lds
    v_mfma_f32_16x16x32_bf16 v[88:91], a[240:243], a[208:211], v[88:91]
    ds_read_b64_tr_b16 a[184:185], v30 offset:0
    v_mfma_f32_16x16x32_bf16 v[92:95], a[244:247], a[208:211], v[92:95]
    ds_read_b64_tr_b16 a[186:187], v30 offset:4096
L_pad_9:
    s_cbranch_execz L_ret
    v_mfma_f32_16x16x32_bf16 v[140:143], a[208:211], a[248:251], v[140:143]
    ds_read_b64_tr_b16 a[188:189], v32 offset:0
    v_mfma_f32_16x16x32_bf16 v[168:171], a[208:211], a[252:255], v[168:171]
    s_add_u32 m0, s56, 77824
    s_add_u32 s54, s53, 10752
    ds_read_b64_tr_b16 a[190:191], v32 offset:4096
    v_mfma_f32_16x16x32_bf16 v[48:51], a[232:235], a[212:215], v[48:51]
    buffer_load_dwordx4 v2, s[12:15], s54 offen lds
    v_mfma_f32_16x16x32_bf16 v[52:55], a[236:239], a[212:215], v[52:55]
    ds_read_b64_tr_b16 a[192:193], v30 offset:8192
    v_mfma_f32_16x16x32_bf16 v[96:99], a[240:243], a[212:215], v[96:99]
    ds_read_b64_tr_b16 a[194:195], v30 offset:12288
    v_mfma_f32_16x16x32_bf16 v[100:103], a[244:247], a[212:215], v[100:103]
    ds_read_b64_tr_b16 a[196:197], v32 offset:8192
    v_mfma_f32_16x16x32_bf16 v[144:147], a[212:215], a[248:251], v[144:147]
    ds_read_b64_tr_b16 a[198:199], v32 offset:12288
    v_mfma_f32_16x16x32_bf16 v[172:175], a[212:215], a[252:255], v[172:175]
    s_add_u32 m0, s56, 81024
    ds_read_b64_tr_b16 a[200:201], v30 offset:16384
    v_mfma_f32_16x16x32_bf16 v[56:59], a[232:235], a[216:219], v[56:59]
    buffer_load_dwordx4 v2, s[12:15], s53 offen offset:896 lds
    v_mfma_f32_16x16x32_bf16 v[60:63], a[236:239], a[216:219], v[60:63]
    ds_read_b64_tr_b16 a[202:203], v30 offset:20480
    v_mfma_f32_16x16x32_bf16 v[104:107], a[240:243], a[216:219], v[104:107]
    ds_read_b64_tr_b16 a[204:205], v32 offset:16384
    v_mfma_f32_16x16x32_bf16 v[108:111], a[244:247], a[216:219], v[108:111]
    ds_read_b64_tr_b16 a[206:207], v32 offset:20480
    v_mfma_f32_16x16x32_bf16 v[148:151], a[216:219], a[248:251], v[148:151]
    ds_read_b128 a[164:167], v8 offset:26624
    v_mfma_f32_16x16x32_bf16 v[176:179], a[216:219], a[252:255], v[176:179]
    s_add_u32 m0, s56, 85120
    ds_read_b128 a[168:171], v8 offset:28672
    v_mfma_f32_16x16x32_bf16 v[64:67], a[232:235], a[220:223], v[64:67]
    buffer_load_dwordx4 v2, s[12:15], s54 offen offset:896 lds
    v_mfma_f32_16x16x32_bf16 v[68:71], a[236:239], a[220:223], v[68:71]
    ds_read_b128 a[172:175], v8 offset:30720
    v_mfma_f32_16x16x32_bf16 v[112:115], a[240:243], a[220:223], v[112:115]
    ds_read_b128 a[176:179], v8 offset:32768
    v_mfma_f32_16x16x32_bf16 v[116:119], a[244:247], a[220:223], v[116:119]
    ds_read_b128 a[180:183], v8 offset:34816
    v_mfma_f32_16x16x32_bf16 v[152:155], a[220:223], a[248:251], v[152:155]
    s_add_u32 m0, s56, 88320
    v_mfma_f32_16x16x32_bf16 v[180:183], a[220:223], a[252:255], v[180:183]
    buffer_load_dwordx4 v2, s[12:15], s53 offen offset:1792 lds
    v_mfma_f32_16x16x32_bf16 v[72:75], a[232:235], a[224:227], v[72:75]
    v_mfma_f32_16x16x32_bf16 v[76:79], a[236:239], a[224:227], v[76:79]
    v_mfma_f32_16x16x32_bf16 v[120:123], a[240:243], a[224:227], v[120:123]
    v_mfma_f32_16x16x32_bf16 v[124:127], a[244:247], a[224:227], v[124:127]
    v_mfma_f32_16x16x32_bf16 v[156:159], a[224:227], a[248:251], v[156:159]
    s_add_u32 m0, s56, 92416
    v_mfma_f32_16x16x32_bf16 v[184:187], a[224:227], a[252:255], v[184:187]
    buffer_load_dwordx4 v2, s[12:15], s54 offen offset:1792 lds
    v_mfma_f32_16x16x32_bf16 v[80:83], a[232:235], a[228:231], v[80:83]
    v_mfma_f32_16x16x32_bf16 v[84:87], a[236:239], a[228:231], v[84:87]
    v_mfma_f32_16x16x32_bf16 v[128:131], a[240:243], a[228:231], v[128:131]
    v_mfma_f32_16x16x32_bf16 v[132:135], a[244:247], a[228:231], v[132:135]
    v_mfma_f32_16x16x32_bf16 v[160:163], a[228:231], a[248:251], v[160:163]
    v_mfma_f32_16x16x32_bf16 v[188:191], a[228:231], a[252:255], v[188:191]
    s_waitcnt vmcnt(13)
    ds_write_b128 v26, v[16:19]
    s_waitcnt lgkmcnt(0)
    s_barrier
    v_mfma_f32_16x16x32_bf16 v[40:43], a[184:187], a[160:163], v[40:43]
    ds_read_b128 a[208:211], v9 offset:24576
    v_mfma_f32_16x16x32_bf16 v[44:47], a[188:191], a[160:163], v[44:47]
    buffer_load_ushort v227, v226, s[32:35], s72 offen
    v_mfma_f32_16x16x32_bf16 v[88:91], a[192:195], a[160:163], v[88:91]
    ds_read_b64_tr_b16 a[232:233], v30 offset:24576
    v_mfma_f32_16x16x32_bf16 v[92:95], a[196:199], a[160:163], v[92:95]
    ds_read_b64_tr_b16 a[234:235], v30 offset:28672
    v_mfma_f32_16x16x32_bf16 v[140:143], a[160:163], a[200:203], v[140:143]
    s_lshr_b32 m0, s52, 1
    s_add_u32 m0, m0, 149504
    s_nop 0
    buffer_load_dwordx4 v224, s[8:11], s71 offen lds
    v_mfma_f32_16x16x32_bf16 v[168:171], a[160:163], a[204:207], v[168:171]
    ds_read_b64_tr_b16 a[236:237], v32 offset:24576
    v_mfma_f32_16x16x32_bf16 v[48:51], a[184:187], a[164:167], v[48:51]
    ds_read_b64_tr_b16 a[238:239], v32 offset:28672
    v_mfma_f32_16x16x32_bf16 v[52:55], a[188:191], a[164:167], v[52:55]
    ds_read_b64_tr_b16 a[240:241], v30 offset:32768
    v_mfma_f32_16x16x32_bf16 v[96:99], a[192:195], a[164:167], v[96:99]
    s_lshr_b32 m0, s52, 1
    s_add_u32 m0, m0, 150528
    s_add_u32 s72, s71, 7168
    buffer_load_dwordx4 v224, s[8:11], s72 offen lds
    v_mfma_f32_16x16x32_bf16 v[100:103], a[196:199], a[164:167], v[100:103]
    ds_read_b64_tr_b16 a[242:243], v30 offset:36864
    v_mfma_f32_16x16x32_bf16 v[144:147], a[164:167], a[200:203], v[144:147]
    ds_read_b64_tr_b16 a[244:245], v32 offset:32768
    v_mfma_f32_16x16x32_bf16 v[172:175], a[164:167], a[204:207], v[172:175]
    ds_read_b64_tr_b16 a[246:247], v32 offset:36864
    v_mfma_f32_16x16x32_bf16 v[56:59], a[184:187], a[168:171], v[56:59]
    s_add_u32 m0, s52, 0
    s_nop 0
    buffer_load_dwordx4 v252, s[24:27], s59 offen lds
    v_mfma_f32_16x16x32_bf16 v[60:63], a[188:191], a[168:171], v[60:63]
    ds_read_b64_tr_b16 a[248:249], v30 offset:40960
    v_mfma_f32_16x16x32_bf16 v[104:107], a[192:195], a[168:171], v[104:107]
    ds_read_b64_tr_b16 a[250:251], v30 offset:45056
    v_mfma_f32_16x16x32_bf16 v[108:111], a[196:199], a[168:171], v[108:111]
    ds_read_b64_tr_b16 a[252:253], v32 offset:40960
    v_mfma_f32_16x16x32_bf16 v[148:151], a[168:171], a[200:203], v[148:151]
    buffer_load_dwordx4 v253, s[24:27], s59 offen offset:1024 lds
    v_mfma_f32_16x16x32_bf16 v[176:179], a[168:171], a[204:207], v[176:179]
    ds_read_b64_tr_b16 a[254:255], v32 offset:45056
    v_mfma_f32_16x16x32_bf16 v[64:67], a[184:187], a[172:175], v[64:67]
    ds_read_b128 a[212:215], v9 offset:26624
    v_mfma_f32_16x16x32_bf16 v[68:71], a[188:191], a[172:175], v[68:71]
    buffer_load_dwordx4 v254, s[24:27], s59 offen offset:2048 lds
    v_mfma_f32_16x16x32_bf16 v[112:115], a[192:195], a[172:175], v[112:115]
    ds_read_b128 a[216:219], v9 offset:28672
    v_mfma_f32_16x16x32_bf16 v[116:119], a[196:199], a[172:175], v[116:119]
    ds_read_b128 a[220:223], v9 offset:30720
    v_mfma_f32_16x16x32_bf16 v[152:155], a[172:175], a[200:203], v[152:155]
    ds_read_b128 a[224:227], v9 offset:32768
    v_mfma_f32_16x16x32_bf16 v[180:183], a[172:175], a[204:207], v[180:183]
    buffer_load_dwordx4 v255, s[24:27], s59 offen offset:3072 lds
    v_mfma_f32_16x16x32_bf16 v[72:75], a[184:187], a[176:179], v[72:75]
    ds_read_b128 a[228:231], v9 offset:34816
    v_mfma_f32_16x16x32_bf16 v[76:79], a[188:191], a[176:179], v[76:79]
    v_mfma_f32_16x16x32_bf16 v[120:123], a[192:195], a[176:179], v[120:123]
    v_mfma_f32_16x16x32_bf16 v[124:127], a[196:199], a[176:179], v[124:127]
    v_mfma_f32_16x16x32_bf16 v[156:159], a[176:179], a[200:203], v[156:159]
    v_mfma_f32_16x16x32_bf16 v[184:187], a[176:179], a[204:207], v[184:187]
    v_mfma_f32_16x16x32_bf16 v[80:83], a[184:187], a[180:183], v[80:83]
    v_mfma_f32_16x16x32_bf16 v[84:87], a[188:191], a[180:183], v[84:87]
    v_mfma_f32_16x16x32_bf16 v[128:131], a[192:195], a[180:183], v[128:131]
    v_mfma_f32_16x16x32_bf16 v[132:135], a[196:199], a[180:183], v[132:135]
    v_mfma_f32_16x16x32_bf16 v[160:163], a[180:183], a[200:203], v[160:163]
    v_mfma_f32_16x16x32_bf16 v[188:191], a[180:183], a[204:207], v[188:191]
    s_waitcnt vmcnt(14)
    s_waitcnt lgkmcnt(0)
    s_barrier
    v_mfma_f32_16x16x32_bf16 v[40:43], a[232:235], a[208:211], v[40:43]
    ds_read_b128 a[160:163], v8 offset:0
    v_mfma_f32_16x16x32_bf16 v[44:47], a[236:239], a[208:211], v[44:47]
    s_add_u32 m0, s52, 16384
    s_add_u32 s59, s59, 131072
    buffer_load_dwordx4 v252, s[24:27], s59 offen lds
    v_mfma_f32_16x16x32_bf16 v[88:91], a[240:243], a[208:211], v[88:91]
    ds_read_b64_tr_b16 a[184:185], v31 offset:0
    v_mfma_f32_16x16x32_bf16 v[92:95], a[244:247], a[208:211], v[92:95]
    ds_read_b64_tr_b16 a[186:187], v31 offset:4096
    v_mfma_f32_16x16x32_bf16 v[140:143], a[208:211], a[248:251], v[140:143]
    buffer_load_dwordx4 v253, s[24:27], s59 offen offset:1024 lds
    v_mfma_f32_16x16x32_bf16 v[168:171], a[208:211], a[252:255], v[168:171]
    ds_read_b64_tr_b16 a[188:189], v33 offset:0
    v_mfma_f32_16x16x32_bf16 v[48:51], a[232:235], a[212:215], v[48:51]
    ds_read_b64_tr_b16 a[190:191], v33 offset:4096
    v_mfma_f32_16x16x32_bf16 v[52:55], a[236:239], a[212:215], v[52:55]
    ds_read_b64_tr_b16 a[192:193], v31 offset:8192
    v_mfma_f32_16x16x32_bf16 v[96:99], a[240:243], a[212:215], v[96:99]
    buffer_load_dwordx4 v254, s[24:27], s59 offen offset:2048 lds
    v_mfma_f32_16x16x32_bf16 v[100:103], a[244:247], a[212:215], v[100:103]
    ds_read_b64_tr_b16 a[194:195], v31 offset:12288
    v_mfma_f32_16x16x32_bf16 v[144:147], a[212:215], a[248:251], v[144:147]
    ds_read_b64_tr_b16 a[196:197], v33 offset:8192
    v_mfma_f32_16x16x32_bf16 v[172:175], a[212:215], a[252:255], v[172:175]
    ds_read_b64_tr_b16 a[198:199], v33 offset:12288
    v_mfma_f32_16x16x32_bf16 v[56:59], a[232:235], a[216:219], v[56:59]
    buffer_load_dwordx4 v255, s[24:27], s59 offen offset:3072 lds
    v_mfma_f32_16x16x32_bf16 v[60:63], a[236:239], a[216:219], v[60:63]
    ds_read_b64_tr_b16 a[200:201], v31 offset:16384
    v_mfma_f32_16x16x32_bf16 v[104:107], a[240:243], a[216:219], v[104:107]
    ds_read_b64_tr_b16 a[202:203], v31 offset:20480
    v_mfma_f32_16x16x32_bf16 v[108:111], a[244:247], a[216:219], v[108:111]
    ds_read_b64_tr_b16 a[204:205], v33 offset:16384
    v_mfma_f32_16x16x32_bf16 v[148:151], a[216:219], a[248:251], v[148:151]
    s_add_u32 m0, s52, 32768
    s_add_u32 s59, s59, 131072
    buffer_load_dwordx4 v252, s[24:27], s59 offen lds
    v_mfma_f32_16x16x32_bf16 v[176:179], a[216:219], a[252:255], v[176:179]
    ds_read_b64_tr_b16 a[206:207], v33 offset:20480
    v_mfma_f32_16x16x32_bf16 v[64:67], a[232:235], a[220:223], v[64:67]
    ds_read_b128 a[164:167], v8 offset:2048
    v_mfma_f32_16x16x32_bf16 v[68:71], a[236:239], a[220:223], v[68:71]
    buffer_load_dwordx4 v253, s[24:27], s59 offen offset:1024 lds
    v_mfma_f32_16x16x32_bf16 v[112:115], a[240:243], a[220:223], v[112:115]
    ds_read_b128 a[168:171], v8 offset:4096
    v_mfma_f32_16x16x32_bf16 v[116:119], a[244:247], a[220:223], v[116:119]
    ds_read_b128 a[172:175], v8 offset:6144
    v_mfma_f32_16x16x32_bf16 v[152:155], a[220:223], a[248:251], v[152:155]
    ds_read_b128 a[176:179], v8 offset:8192
    v_mfma_f32_16x16x32_bf16 v[180:183], a[220:223], a[252:255], v[180:183]
    buffer_load_dwordx4 v254, s[24:27], s59 offen offset:2048 lds
    v_mfma_f32_16x16x32_bf16 v[72:75], a[232:235], a[224:227], v[72:75]
    ds_read_b128 a[180:183], v8 offset:10240
    v_mfma_f32_16x16x32_bf16 v[76:79], a[236:239], a[224:227], v[76:79]
    v_mfma_f32_16x16x32_bf16 v[120:123], a[240:243], a[224:227], v[120:123]
    v_mfma_f32_16x16x32_bf16 v[124:127], a[244:247], a[224:227], v[124:127]
    buffer_load_dwordx4 v255, s[24:27], s59 offen offset:3072 lds
    v_mfma_f32_16x16x32_bf16 v[156:159], a[224:227], a[248:251], v[156:159]
    v_mfma_f32_16x16x32_bf16 v[184:187], a[224:227], a[252:255], v[184:187]
    v_mfma_f32_16x16x32_bf16 v[80:83], a[232:235], a[228:231], v[80:83]
    v_mfma_f32_16x16x32_bf16 v[84:87], a[236:239], a[228:231], v[84:87]
    v_mfma_f32_16x16x32_bf16 v[128:131], a[240:243], a[228:231], v[128:131]
    v_mfma_f32_16x16x32_bf16 v[132:135], a[244:247], a[228:231], v[132:135]
    v_mfma_f32_16x16x32_bf16 v[160:163], a[228:231], a[248:251], v[160:163]
    v_mfma_f32_16x16x32_bf16 v[188:191], a[228:231], a[252:255], v[188:191]
    s_waitcnt vmcnt(15)
    s_waitcnt lgkmcnt(0)
    s_barrier
    v_mfma_f32_16x16x32_bf16 v[40:43], a[184:187], a[160:163], v[40:43]
    ds_read_b128 a[208:211], v9 offset:0
    v_mfma_f32_16x16x32_bf16 v[44:47], a[188:191], a[160:163], v[44:47]
    s_add_u32 m0, s52, 49152
    s_add_u32 s59, s59, 131072
    buffer_load_dwordx4 v252, s[24:27], s59 offen lds
    v_mfma_f32_16x16x32_bf16 v[88:91], a[192:195], a[160:163], v[88:91]
    ds_read_b64_tr_b16 a[232:233], v31 offset:24576
    s_waitcnt vmcnt(9)
    ds_read_b64_tr_b16 a[0:1], v248 offset:0
    v_mfma_f32_16x16x32_bf16 v[92:95], a[196:199], a[160:163], v[92:95]
    ds_read_b64_tr_b16 a[234:235], v31 offset:28672
    ds_read_b64_tr_b16 a[2:3], v248 offset:2048
    v_mfma_f32_16x16x32_bf16 v[140:143], a[160:163], a[200:203], v[140:143]
    buffer_load_dwordx4 v253, s[24:27], s59 offen offset:1024 lds
    v_mfma_f32_16x16x32_bf16 v[168:171], a[160:163], a[204:207], v[168:171]
    ds_read_b64_tr_b16 a[236:237], v33 offset:24576
    ds_read_b64_tr_b16 a[4:5], v249 offset:0
    v_mfma_f32_16x16x32_bf16 v[48:51], a[184:187], a[164:167], v[48:51]
    ds_read_b64_tr_b16 a[238:239], v33 offset:28672
    ds_read_b64_tr_b16 a[6:7], v249 offset:2048
    v_mfma_f32_16x16x32_bf16 v[52:55], a[188:191], a[164:167], v[52:55]
    ds_read_b64_tr_b16 a[240:241], v31 offset:32768
    ds_read_b64_tr_b16 a[8:9], v250 offset:0
    v_mfma_f32_16x16x32_bf16 v[96:99], a[192:195], a[164:167], v[96:99]
    buffer_load_dwordx4 v254, s[24:27], s59 offen offset:2048 lds
    v_mfma_f32_16x16x32_bf16 v[100:103], a[196:199], a[164:167], v[100:103]
    ds_read_b64_tr_b16 a[242:243], v31 offset:36864
    ds_read_b64_tr_b16 a[10:11], v250 offset:2048
    v_mfma_f32_16x16x32_bf16 v[144:147], a[164:167], a[200:203], v[144:147]
    ds_read_b64_tr_b16 a[244:245], v33 offset:32768
    ds_read_b64_tr_b16 a[12:13], v251 offset:0
    v_mfma_f32_16x16x32_bf16 v[172:175], a[164:167], a[204:207], v[172:175]
    ds_read_b64_tr_b16 a[246:247], v33 offset:36864
    ds_read_b64_tr_b16 a[14:15], v251 offset:2048
    v_mfma_f32_16x16x32_bf16 v[56:59], a[184:187], a[168:171], v[56:59]
    buffer_load_dwordx4 v255, s[24:27], s59 offen offset:3072 lds
    v_mfma_f32_16x16x32_bf16 v[60:63], a[188:191], a[168:171], v[60:63]
    ds_read_b64_tr_b16 a[248:249], v31 offset:40960
    v_mfma_f32_16x16x32_bf16 v[104:107], a[192:195], a[168:171], v[104:107]
    ds_read_b64_tr_b16 a[250:251], v31 offset:45056
    v_mfma_f32_16x16x32_bf16 v[108:111], a[196:199], a[168:171], v[108:111]
    ds_read_b64_tr_b16 a[252:253], v33 offset:40960
    v_mfma_f32_16x16x32_bf16 v[148:151], a[168:171], a[200:203], v[148:151]
    s_waitcnt lgkmcnt(3)
    s_add_u32 m0, s52, 0
    s_add_u32 s59, s59, 131072
    buffer_load_dwordx4 v252, s[24:27], s59 offen lds
    v_mfma_f32_16x16x32_bf16 v[176:179], a[168:171], a[204:207], v[176:179]
    ds_read_b64_tr_b16 a[254:255], v33 offset:45056
    s_waitcnt vmcnt(9)
    ds_read_b64_tr_b16 a[16:17], v248 offset:16384
    v_mfma_f32_16x16x32_bf16 v[64:67], a[184:187], a[172:175], v[64:67]
    ds_read_b128 a[212:215], v9 offset:2048
    ds_read_b64_tr_b16 a[18:19], v248 offset:18432
    v_mfma_f32_16x16x32_bf16 v[68:71], a[188:191], a[172:175], v[68:71]
    buffer_load_dwordx4 v253, s[24:27], s59 offen offset:1024 lds
    v_mfma_f32_16x16x32_bf16 v[112:115], a[192:195], a[172:175], v[112:115]
    ds_read_b128 a[216:219], v9 offset:4096
    ds_read_b64_tr_b16 a[20:21], v249 offset:16384
    v_mfma_f32_16x16x32_bf16 v[116:119], a[196:199], a[172:175], v[116:119]
    ds_read_b128 a[220:223], v9 offset:6144
    ds_read_b64_tr_b16 a[22:23], v249 offset:18432
    v_mfma_f32_16x16x32_bf16 v[152:155], a[172:175], a[200:203], v[152:155]
    ds_read_b128 a[224:227], v9 offset:8192
    ds_read_b64_tr_b16 a[24:25], v250 offset:16384
    v_mfma_f32_16x16x32_bf16 v[180:183], a[172:175], a[204:207], v[180:183]
    buffer_load_dwordx4 v254, s[24:27], s59 offen offset:2048 lds
    v_mfma_f32_16x16x32_bf16 v[72:75], a[184:187], a[176:179], v[72:75]
    ds_read_b128 a[228:231], v9 offset:10240
    ds_read_b64_tr_b16 a[26:27], v250 offset:18432
    v_mfma_f32_16x16x32_bf16 v[76:79], a[188:191], a[176:179], v[76:79]
    ds_read_b64_tr_b16 a[28:29], v251 offset:16384
    ds_read_b64_tr_b16 a[30:31], v251 offset:18432
    v_mfma_f32_16x16x32_bf16 v[120:123], a[192:195], a[176:179], v[120:123]
    v_mfma_f32_16x16x32_bf16 v[124:127], a[196:199], a[176:179], v[124:127]
    buffer_load_dwordx4 v255, s[24:27], s59 offen offset:3072 lds
    v_mfma_f32_16x16x32_bf16 v[156:159], a[176:179], a[200:203], v[156:159]
    v_mfma_f32_16x16x32_bf16 v[184:187], a[176:179], a[204:207], v[184:187]
    v_mfma_f32_16x16x32_bf16 v[80:83], a[184:187], a[180:183], v[80:83]
    v_mfma_f32_16x16x32_bf16 v[84:87], a[188:191], a[180:183], v[84:87]
    s_waitcnt lgkmcnt(0)
    s_add_u32 m0, s52, 16384
    s_add_u32 s59, s59, 131072
    buffer_load_dwordx4 v252, s[24:27], s59 offen lds
    v_mfma_f32_16x16x32_bf16 v[128:131], a[192:195], a[180:183], v[128:131]
    s_waitcnt vmcnt(9)
    ds_read_b64_tr_b16 a[32:33], v248 offset:32768
    ds_read_b64_tr_b16 a[34:35], v248 offset:34816
    v_mfma_f32_16x16x32_bf16 v[132:135], a[196:199], a[180:183], v[132:135]
    ds_read_b64_tr_b16 a[36:37], v249 offset:32768
    ds_read_b64_tr_b16 a[38:39], v249 offset:34816
    v_mfma_f32_16x16x32_bf16 v[160:163], a[180:183], a[200:203], v[160:163]
    ds_read_b64_tr_b16 a[40:41], v250 offset:32768
    ds_read_b64_tr_b16 a[42:43], v250 offset:34816
    v_mfma_f32_16x16x32_bf16 v[188:191], a[180:183], a[204:207], v[188:191]
    s_waitcnt lgkmcnt(0)
    s_barrier
    v_mfma_f32_16x16x32_bf16 v[40:43], a[232:235], a[208:211], v[40:43]
    ds_read_b64_tr_b16 a[44:45], v251 offset:32768
    ds_read_b64_tr_b16 a[46:47], v251 offset:34816
    v_mfma_f32_16x16x32_bf16 v[44:47], a[236:239], a[208:211], v[44:47]
    buffer_load_dwordx4 v253, s[24:27], s59 offen offset:1024 lds
    v_mfma_f32_16x16x32_bf16 v[88:91], a[240:243], a[208:211], v[88:91]
    v_mfma_f32_16x16x32_bf16 v[92:95], a[244:247], a[208:211], v[92:95]
    v_mfma_f32_16x16x32_bf16 v[140:143], a[208:211], a[248:251], v[140:143]
    buffer_load_dwordx4 v254, s[24:27], s59 offen offset:2048 lds
    v_mfma_f32_16x16x32_bf16 v[168:171], a[208:211], a[252:255], v[168:171]
    v_mfma_f32_16x16x32_bf16 v[48:51], a[232:235], a[212:215], v[48:51]
    v_mfma_f32_16x16x32_bf16 v[52:55], a[236:239], a[212:215], v[52:55]
    v_mfma_f32_16x16x32_bf16 v[96:99], a[240:243], a[212:215], v[96:99]
    buffer_load_dwordx4 v255, s[24:27], s59 offen offset:3072 lds
    v_mfma_f32_16x16x32_bf16 v[100:103], a[244:247], a[212:215], v[100:103]
    v_mfma_f32_16x16x32_bf16 v[144:147], a[212:215], a[248:251], v[144:147]
    v_mfma_f32_16x16x32_bf16 v[172:175], a[212:215], a[252:255], v[172:175]
    v_mfma_f32_16x16x32_bf16 v[56:59], a[232:235], a[216:219], v[56:59]
    s_waitcnt lgkmcnt(0)
    s_add_u32 m0, s52, 32768
    s_add_u32 s59, s59, 131072
    buffer_load_dwordx4 v252, s[24:27], s59 offen lds
    v_mfma_f32_16x16x32_bf16 v[60:63], a[236:239], a[216:219], v[60:63]
    s_waitcnt vmcnt(9)
    ds_read_b64_tr_b16 a[48:49], v248 offset:49152
    ds_read_b64_tr_b16 a[50:51], v248 offset:51200
    v_mfma_f32_16x16x32_bf16 v[104:107], a[240:243], a[216:219], v[104:107]
    ds_read_b64_tr_b16 a[52:53], v249 offset:49152
    ds_read_b64_tr_b16 a[54:55], v249 offset:51200
    v_mfma_f32_16x16x32_bf16 v[108:111], a[244:247], a[216:219], v[108:111]
    ds_read_b64_tr_b16 a[56:57], v250 offset:49152
    ds_read_b64_tr_b16 a[58:59], v250 offset:51200
    v_mfma_f32_16x16x32_bf16 v[148:151], a[216:219], a[248:251], v[148:151]
    buffer_load_dwordx4 v253, s[24:27], s59 offen offset:1024 lds
    v_mfma_f32_16x16x32_bf16 v[176:179], a[216:219], a[252:255], v[176:179]
    ds_read_b64_tr_b16 a[60:61], v251 offset:49152
    ds_read_b64_tr_b16 a[62:63], v251 offset:51200
    v_mfma_f32_16x16x32_bf16 v[64:67], a[232:235], a[220:223], v[64:67]
    v_mfma_f32_16x16x32_bf16 v[68:71], a[236:239], a[220:223], v[68:71]
    buffer_load_dwordx4 v254, s[24:27], s59 offen offset:2048 lds
    v_mfma_f32_16x16x32_bf16 v[112:115], a[240:243], a[220:223], v[112:115]
    v_mfma_f32_16x16x32_bf16 v[116:119], a[244:247], a[220:223], v[116:119]
    v_mfma_f32_16x16x32_bf16 v[152:155], a[220:223], a[248:251], v[152:155]
    v_mfma_f32_16x16x32_bf16 v[180:183], a[220:223], a[252:255], v[180:183]
    buffer_load_dwordx4 v255, s[24:27], s59 offen offset:3072 lds
    v_mfma_f32_16x16x32_bf16 v[72:75], a[232:235], a[224:227], v[72:75]
    v_mfma_f32_16x16x32_bf16 v[76:79], a[236:239], a[224:227], v[76:79]
    v_mfma_f32_16x16x32_bf16 v[120:123], a[240:243], a[224:227], v[120:123]
    v_mfma_f32_16x16x32_bf16 v[124:127], a[244:247], a[224:227], v[124:127]
    s_waitcnt lgkmcnt(0)
    s_add_u32 m0, s52, 49152
    s_add_u32 s59, s59, 131072
    buffer_load_dwordx4 v252, s[24:27], s59 offen lds
    v_mfma_f32_16x16x32_bf16 v[156:159], a[224:227], a[248:251], v[156:159]
    s_waitcnt vmcnt(9)
    ds_read_b64_tr_b16 a[64:65], v248 offset:0
    ds_read_b64_tr_b16 a[66:67], v248 offset:2048
    v_mfma_f32_16x16x32_bf16 v[184:187], a[224:227], a[252:255], v[184:187]
    ds_read_b64_tr_b16 a[68:69], v249 offset:0
    ds_read_b64_tr_b16 a[70:71], v249 offset:2048
    v_mfma_f32_16x16x32_bf16 v[80:83], a[232:235], a[228:231], v[80:83]
    ds_read_b64_tr_b16 a[72:73], v250 offset:0
    ds_read_b64_tr_b16 a[74:75], v250 offset:2048
    v_mfma_f32_16x16x32_bf16 v[84:87], a[236:239], a[228:231], v[84:87]
    buffer_load_dwordx4 v253, s[24:27], s59 offen offset:1024 lds
    v_mfma_f32_16x16x32_bf16 v[128:131], a[240:243], a[228:231], v[128:131]
    ds_read_b64_tr_b16 a[76:77], v251 offset:0
    ds_read_b64_tr_b16 a[78:79], v251 offset:2048
    v_mfma_f32_16x16x32_bf16 v[132:135], a[244:247], a[228:231], v[132:135]
    v_mfma_f32_16x16x32_bf16 v[160:163], a[228:231], a[248:251], v[160:163]
    v_mfma_f32_16x16x32_bf16 v[188:191], a[228:231], a[252:255], v[188:191]
    ds_read2_b32 v[24:25], v34 offset0:0 offset1:128
    ds_read_b128 v[12:15], v35 offset:0
    ds_read_b128 v[16:19], v35 offset:512
    v_mov_b32_dpp v28, v88 row_newbcast:0 row_mask:0xf bank_mask:0xf
    v_mov_b32_dpp v204, v40 row_newbcast:0 row_mask:0xf bank_mask:0xf
    v_mov_b32_dpp v29, v89 row_newbcast:0 row_mask:0xf bank_mask:0xf
    v_mov_b32_dpp v205, v41 row_newbcast:0 row_mask:0xf bank_mask:0xf
    v_mov_b32_dpp v30, v90 row_newbcast:0 row_mask:0xf bank_mask:0xf
    v_mov_b32_dpp v206, v42 row_newbcast:0 row_mask:0xf bank_mask:0xf
    v_mov_b32_dpp v31, v91 row_newbcast:0 row_mask:0xf bank_mask:0xf
    v_mov_b32_dpp v207, v43 row_newbcast:0 row_mask:0xf bank_mask:0xf
    v_mov_b32_dpp v32, v92 row_newbcast:0 row_mask:0xf bank_mask:0xf
    v_mov_b32_dpp v208, v44 row_newbcast:0 row_mask:0xf bank_mask:0xf
    v_mov_b32_dpp v33, v93 row_newbcast:0 row_mask:0xf bank_mask:0xf
    v_mov_b32_dpp v209, v45 row_newbcast:0 row_mask:0xf bank_mask:0xf
    buffer_load_dwordx4 v254, s[24:27], s59 offen offset:2048 lds
    v_mov_b32_dpp v36, v94 row_newbcast:0 row_mask:0xf bank_mask:0xf
    v_mov_b32_dpp v210, v46 row_newbcast:0 row_mask:0xf bank_mask:0xf
    v_mov_b32_dpp v37, v95 row_newbcast:0 row_mask:0xf bank_mask:0xf
    v_mov_b32_dpp v211, v47 row_newbcast:0 row_mask:0xf bank_mask:0xf
    v_mov_b32 v8, v140
    v_mov_b32 v2, v140
    v_mov_b32 v9, v168
    v_mov_b32 v3, v168
    v_permlane16_swap_b32 v8, v2
    s_nop 0
    v_permlane16_swap_b32 v9, v3
    buffer_load_dwordx4 v255, s[24:27], s59 offen offset:3072 lds
    v_mov_b32 v2, v8
    v_mov_b32 v3, v9
    s_nop 0
    v_permlane32_swap_b32 v8, v2
    v_permlane32_swap_b32 v9, v3
    ds_read2_b32 v[136:137], v34 offset0:16 offset1:144
    ds_read_b128 v[2:5], v35 offset:64
    ds_read_b128 v[220:223], v35 offset:576
    s_waitcnt lgkmcnt(3)
    v_pk_fma_f32 v[88:89], v[28:29], v[24:25], v[88:89] op_sel:[0,1,0] op_sel_hi:[1,1,1]
    v_pk_fma_f32 v[90:91], v[30:31], v[24:25], v[90:91] op_sel:[0,1,0] op_sel_hi:[1,1,1]
    v_pk_fma_f32 v[92:93], v[32:33], v[24:25], v[92:93] op_sel:[0,1,0] op_sel_hi:[1,1,1]
    v_pk_fma_f32 v[94:95], v[36:37], v[24:25], v[94:95] op_sel:[0,1,0] op_sel_hi:[1,1,1]
    v_pk_fma_f32 v[40:41], v[204:205], v[24:25], v[40:41] op_sel:[0,1,0] op_sel_hi:[1,1,1]
    v_pk_fma_f32 v[42:43], v[206:207], v[24:25], v[42:43] op_sel:[0,1,0] op_sel_hi:[1,1,1]
    s_add_u32 m0, s52, 0
    s_add_u32 s59, s59, 131072
    buffer_load_dwordx4 v252, s[24:27], s59 offen lds
    s_waitcnt vmcnt(9)
    ds_read_b64_tr_b16 a[80:81], v248 offset:16384
    ds_read_b64_tr_b16 a[82:83], v248 offset:18432
    v_pk_fma_f32 v[44:45], v[208:209], v[24:25], v[44:45] op_sel:[0,1,0] op_sel_hi:[1,1,1]
    v_pk_fma_f32 v[46:47], v[210:211], v[24:25], v[46:47] op_sel:[0,1,0] op_sel_hi:[1,1,1]
    v_pk_fma_f32 v[140:141], v[16:17], v[8:9], v[140:141] op_sel_hi:[1,0,1]
    v_pk_fma_f32 v[142:143], v[18:19], v[8:9], v[142:143] op_sel_hi:[1,0,1]
    v_pk_fma_f32 v[168:169], v[16:17], v[8:9], v[168:169] op_sel:[0,1,0] op_sel_hi:[1,1,1]
    v_pk_fma_f32 v[170:171], v[18:19], v[8:9], v[170:171] op_sel:[0,1,0] op_sel_hi:[1,1,1]
    v_pk_mul_f32 v[88:89], v[88:89], v[24:25] op_sel_hi:[1,0]
    v_pk_mul_f32 v[90:91], v[90:91], v[24:25] op_sel_hi:[1,0]
    v_pk_mul_f32 v[92:93], v[92:93], v[24:25] op_sel_hi:[1,0]
    v_pk_mul_f32 v[94:95], v[94:95], v[24:25] op_sel_hi:[1,0]
    v_pk_mul_f32 v[140:141], v[140:141], v[12:13]
    v_pk_mul_f32 v[142:143], v[142:143], v[14:15]
    buffer_load_dwordx4 v253, s[24:27], s59 offen offset:1024 lds
    ds_read_b64_tr_b16 a[84:85], v249 offset:16384
    ds_read_b64_tr_b16 a[86:87], v249 offset:18432
    v_pk_mul_f32 v[168:169], v[168:169], v[12:13]
    v_pk_mul_f32 v[170:171], v[170:171], v[14:15]
    v_mul_f32 v192, 0x3e8b97f6, v24
    v_cvt_pk_bf16_f32 v40, v40, v41
    v_cvt_pk_bf16_f32 v41, v42, v43
    v_cvt_pk_bf16_f32 v42, v44, v45
    v_cvt_pk_bf16_f32 v43, v46, v47
    v_cvt_pk_bf16_f32 v88, v88, v89
    v_cvt_pk_bf16_f32 v89, v90, v91
    v_cvt_pk_bf16_f32 v90, v92, v93
    v_cvt_pk_bf16_f32 v91, v94, v95
    buffer_load_dwordx4 v254, s[24:27], s59 offen offset:2048 lds
    ds_read_b64_tr_b16 a[88:89], v250 offset:16384
    ds_read_b64_tr_b16 a[90:91], v250 offset:18432
    v_cvt_pk_bf16_f32 v140, v140, v141
    v_cvt_pk_bf16_f32 v141, v142, v143
    v_cvt_pk_bf16_f32 v168, v168, v169
    v_cvt_pk_bf16_f32 v169, v170, v171
    ds_read2_b32 v[24:25], v34 offset0:32 offset1:160
    ds_read_b128 v[12:15], v35 offset:128
    ds_read_b128 v[16:19], v35 offset:640
    s_waitcnt lgkmcnt(9)
    v_pk_fma_f32 v[96:97], v[28:29], v[136:137], v[96:97] op_sel:[0,1,0] op_sel_hi:[1,1,1]
    v_pk_fma_f32 v[98:99], v[30:31], v[136:137], v[98:99] op_sel:[0,1,0] op_sel_hi:[1,1,1]
    v_pk_fma_f32 v[100:101], v[32:33], v[136:137], v[100:101] op_sel:[0,1,0] op_sel_hi:[1,1,1]
    v_pk_fma_f32 v[102:103], v[36:37], v[136:137], v[102:103] op_sel:[0,1,0] op_sel_hi:[1,1,1]
    v_pk_fma_f32 v[48:49], v[204:205], v[136:137], v[48:49] op_sel:[0,1,0] op_sel_hi:[1,1,1]
    v_pk_fma_f32 v[50:51], v[206:207], v[136:137], v[50:51] op_sel:[0,1,0] op_sel_hi:[1,1,1]
    v_pk_fma_f32 v[52:53], v[208:209], v[136:137], v[52:53] op_sel:[0,1,0] op_sel_hi:[1,1,1]
    v_pk_fma_f32 v[54:55], v[210:211], v[136:137], v[54:55] op_sel:[0,1,0] op_sel_hi:[1,1,1]
    buffer_load_dwordx4 v255, s[24:27], s59 offen offset:3072 lds
    ds_read_b64_tr_b16 a[92:93], v251 offset:16384
    ds_read_b64_tr_b16 a[94:95], v251 offset:18432
    v_pk_fma_f32 v[144:145], v[220:221], v[8:9], v[144:145] op_sel_hi:[1,0,1]
    v_pk_fma_f32 v[146:147], v[222:223], v[8:9], v[146:147] op_sel_hi:[1,0,1]
    v_pk_fma_f32 v[172:173], v[220:221], v[8:9], v[172:173] op_sel:[0,1,0] op_sel_hi:[1,1,1]
    v_pk_fma_f32 v[174:175], v[222:223], v[8:9], v[174:175] op_sel:[0,1,0] op_sel_hi:[1,1,1]
    v_pk_mul_f32 v[96:97], v[96:97], v[136:137] op_sel_hi:[1,0]
    v_pk_mul_f32 v[98:99], v[98:99], v[136:137] op_sel_hi:[1,0]
    v_pk_mul_f32 v[100:101], v[100:101], v[136:137] op_sel_hi:[1,0]
    v_pk_mul_f32 v[102:103], v[102:103], v[136:137] op_sel_hi:[1,0]
    v_pk_mul_f32 v[144:145], v[144:145], v[2:3]
    v_pk_mul_f32 v[146:147], v[146:147], v[4:5]
    v_pk_mul_f32 v[172:173], v[172:173], v[2:3]
    s_waitcnt lgkmcnt(0)
    s_add_u32 m0, s52, 16384
    s_add_u32 s59, s59, 131072
    buffer_load_dwordx4 v252, s[24:27], s59 offen lds
    s_waitcnt vmcnt(9)
    ds_read_b64_tr_b16 a[96:97], v248 offset:32768
    ds_read_b64_tr_b16 a[98:99], v248 offset:34816
    v_pk_mul_f32 v[174:175], v[174:175], v[4:5]
    v_mul_f32 v194, 0x3e8b97f6, v136
    v_mfma_f32_16x16x32_bf16 v[92:95], v[88:91], v[40:43], v[216:219]
    v_cvt_pk_bf16_f32 v48, v48, v49
    v_cvt_pk_bf16_f32 v49, v50, v51
    v_cvt_pk_bf16_f32 v50, v52, v53
    v_cvt_pk_bf16_f32 v51, v54, v55
    v_cvt_pk_bf16_f32 v96, v96, v97
    v_cvt_pk_bf16_f32 v97, v98, v99
    v_cvt_pk_bf16_f32 v98, v100, v101
    buffer_load_dwordx4 v253, s[24:27], s59 offen offset:1024 lds
    ds_read_b64_tr_b16 a[100:101], v249 offset:32768
    ds_read_b64_tr_b16 a[102:103], v249 offset:34816
    v_cvt_pk_bf16_f32 v99, v102, v103
    v_cvt_pk_bf16_f32 v142, v144, v145
    v_cvt_pk_bf16_f32 v143, v146, v147
    v_cvt_pk_bf16_f32 v170, v172, v173
    v_cvt_pk_bf16_f32 v171, v174, v175
    ds_read2_b32 v[136:137], v34 offset0:48 offset1:176
    ds_read_b128 v[2:5], v35 offset:192
    ds_read_b128 v[220:223], v35 offset:704
    v_pk_fma_f32 v[104:105], v[28:29], v[24:25], v[104:105] op_sel:[0,1,0] op_sel_hi:[1,1,1]
    v_pk_fma_f32 v[106:107], v[30:31], v[24:25], v[106:107] op_sel:[0,1,0] op_sel_hi:[1,1,1]
    v_pk_fma_f32 v[108:109], v[32:33], v[24:25], v[108:109] op_sel:[0,1,0] op_sel_hi:[1,1,1]
    v_pk_fma_f32 v[110:111], v[36:37], v[24:25], v[110:111] op_sel:[0,1,0] op_sel_hi:[1,1,1]
    v_pk_fma_f32 v[56:57], v[204:205], v[24:25], v[56:57] op_sel:[0,1,0] op_sel_hi:[1,1,1]
    v_pk_fma_f32 v[58:59], v[206:207], v[24:25], v[58:59] op_sel:[0,1,0] op_sel_hi:[1,1,1]
    buffer_load_dwordx4 v254, s[24:27], s59 offen offset:2048 lds
    ds_read_b64_tr_b16 a[104:105], v250 offset:32768
    ds_read_b64_tr_b16 a[106:107], v250 offset:34816
    v_pk_fma_f32 v[60:61], v[208:209], v[24:25], v[60:61] op_sel:[0,1,0] op_sel_hi:[1,1,1]
    v_pk_fma_f32 v[62:63], v[210:211], v[24:25], v[62:63] op_sel:[0,1,0] op_sel_hi:[1,1,1]
    v_pk_fma_f32 v[148:149], v[16:17], v[8:9], v[148:149] op_sel_hi:[1,0,1]
    v_pk_fma_f32 v[150:151], v[18:19], v[8:9], v[150:151] op_sel_hi:[1,0,1]
    v_pk_fma_f32 v[176:177], v[16:17], v[8:9], v[176:177] op_sel:[0,1,0] op_sel_hi:[1,1,1]
    v_pk_fma_f32 v[178:179], v[18:19], v[8:9], v[178:179] op_sel:[0,1,0] op_sel_hi:[1,1,1]
    v_pk_mul_f32 v[104:105], v[104:105], v[24:25] op_sel_hi:[1,0]
    v_pk_mul_f32 v[106:107], v[106:107], v[24:25] op_sel_hi:[1,0]
    v_pk_mul_f32 v[108:109], v[108:109], v[24:25] op_sel_hi:[1,0]
    v_pk_mul_f32 v[110:111], v[110:111], v[24:25] op_sel_hi:[1,0]
    v_pk_mul_f32 v[148:149], v[148:149], v[12:13]
    v_pk_mul_f32 v[150:151], v[150:151], v[14:15]
    buffer_load_dwordx4 v255, s[24:27], s59 offen offset:3072 lds
    ds_read_b64_tr_b16 a[108:109], v251 offset:32768
    ds_read_b64_tr_b16 a[110:111], v251 offset:34816
    v_pk_mul_f32 v[176:177], v[176:177], v[12:13]
    v_pk_mul_f32 v[178:179], v[178:179], v[14:15]
L_pad_10:
    s_cbranch_execz L_ret
    v_mul_f32 v196, 0x3e8b97f6, v24
    v_mfma_f32_16x16x32_bf16 v[52:55], v[88:91], v[48:51], 0
    v_mfma_f32_16x16x32_bf16 v[100:103], v[96:99], v[48:51], v[212:215]
    v_cvt_pk_bf16_f32 v56, v56, v57
    v_cvt_pk_bf16_f32 v57, v58, v59
    s_waitcnt lgkmcnt(0)
    s_add_u32 m0, s52, 32768
    s_add_u32 s59, s59, 131072
    buffer_load_dwordx4 v252, s[24:27], s59 offen lds
    s_waitcnt vmcnt(9)
    ds_read_b64_tr_b16 a[112:113], v248 offset:49152
    ds_read_b64_tr_b16 a[114:115], v248 offset:51200
    v_cvt_pk_bf16_f32 v58, v60, v61
    v_cvt_pk_bf16_f32 v59, v62, v63
    v_cvt_pk_bf16_f32 v104, v104, v105
    v_cvt_pk_bf16_f32 v105, v106, v107
    v_cvt_pk_bf16_f32 v106, v108, v109
    v_cvt_pk_bf16_f32 v107, v110, v111
    v_cvt_pk_bf16_f32 v144, v148, v149
    v_cvt_pk_bf16_f32 v145, v150, v151
    v_cvt_pk_bf16_f32 v172, v176, v177
    v_cvt_pk_bf16_f32 v173, v178, v179
    ds_read2_b32 v[24:25], v34 offset0:64 offset1:192
    ds_read_b128 v[12:15], v35 offset:256
    ds_read_b128 v[16:19], v35 offset:768
    v_pk_fma_f32 v[112:113], v[28:29], v[136:137], v[112:113] op_sel:[0,1,0] op_sel_hi:[1,1,1]
    v_pk_fma_f32 v[114:115], v[30:31], v[136:137], v[114:115] op_sel:[0,1,0] op_sel_hi:[1,1,1]
    buffer_load_dwordx4 v253, s[24:27], s59 offen offset:1024 lds
    ds_read_b64_tr_b16 a[116:117], v249 offset:49152
    ds_read_b64_tr_b16 a[118:119], v249 offset:51200
    v_pk_fma_f32 v[116:117], v[32:33], v[136:137], v[116:117] op_sel:[0,1,0] op_sel_hi:[1,1,1]
    v_pk_fma_f32 v[118:119], v[36:37], v[136:137], v[118:119] op_sel:[0,1,0] op_sel_hi:[1,1,1]
    v_pk_fma_f32 v[64:65], v[204:205], v[136:137], v[64:65] op_sel:[0,1,0] op_sel_hi:[1,1,1]
    v_pk_fma_f32 v[66:67], v[206:207], v[136:137], v[66:67] op_sel:[0,1,0] op_sel_hi:[1,1,1]
    v_pk_fma_f32 v[68:69], v[208:209], v[136:137], v[68:69] op_sel:[0,1,0] op_sel_hi:[1,1,1]
    v_pk_fma_f32 v[70:71], v[210:211], v[136:137], v[70:71] op_sel:[0,1,0] op_sel_hi:[1,1,1]
    v_pk_fma_f32 v[152:153], v[220:221], v[8:9], v[152:153] op_sel_hi:[1,0,1]
    v_pk_fma_f32 v[154:155], v[222:223], v[8:9], v[154:155] op_sel_hi:[1,0,1]
    v_pk_fma_f32 v[180:181], v[220:221], v[8:9], v[180:181] op_sel:[0,1,0] op_sel_hi:[1,1,1]
    v_pk_fma_f32 v[182:183], v[222:223], v[8:9], v[182:183] op_sel:[0,1,0] op_sel_hi:[1,1,1]
    v_pk_mul_f32 v[112:113], v[112:113], v[136:137] op_sel_hi:[1,0]
    buffer_load_dwordx4 v254, s[24:27], s59 offen offset:2048 lds
    ds_read_b64_tr_b16 a[120:121], v250 offset:49152
    ds_read_b64_tr_b16 a[122:123], v250 offset:51200
    v_pk_mul_f32 v[114:115], v[114:115], v[136:137] op_sel_hi:[1,0]
    v_pk_mul_f32 v[116:117], v[116:117], v[136:137] op_sel_hi:[1,0]
    v_pk_mul_f32 v[118:119], v[118:119], v[136:137] op_sel_hi:[1,0]
    v_pk_mul_f32 v[152:153], v[152:153], v[2:3]
    v_pk_mul_f32 v[154:155], v[154:155], v[4:5]
    v_pk_mul_f32 v[180:181], v[180:181], v[2:3]
    v_pk_mul_f32 v[182:183], v[182:183], v[4:5]
    v_mul_f32 v198, 0x3e8b97f6, v136
    v_mfma_f32_16x16x32_bf16 v[60:63], v[96:99], v[56:59], 0
    v_mfma_f32_16x16x32_bf16 v[108:111], v[104:107], v[56:59], v[212:215]
    buffer_load_dwordx4 v255, s[24:27], s59 offen offset:3072 lds
    ds_read_b64_tr_b16 a[124:125], v251 offset:49152
    ds_read_b64_tr_b16 a[126:127], v251 offset:51200
    v_cvt_pk_bf16_f32 v64, v64, v65
    v_cvt_pk_bf16_f32 v65, v66, v67
    v_cvt_pk_bf16_f32 v66, v68, v69
    v_cvt_pk_bf16_f32 v67, v70, v71
    v_cvt_pk_bf16_f32 v112, v112, v113
    v_cvt_pk_bf16_f32 v113, v114, v115
    v_cvt_pk_bf16_f32 v114, v116, v117
    v_cvt_pk_bf16_f32 v115, v118, v119
    v_cvt_pk_bf16_f32 v146, v152, v153
    s_waitcnt lgkmcnt(0)
    s_add_u32 m0, s52, 49152
    s_add_u32 s59, s59, 131072
    buffer_load_dwordx4 v252, s[24:27], s59 offen lds
    s_waitcnt vmcnt(9)
    ds_read_b64_tr_b16 a[128:129], v248 offset:0
    ds_read_b64_tr_b16 a[130:131], v248 offset:2048
    v_cvt_pk_bf16_f32 v147, v154, v155
    v_cvt_pk_bf16_f32 v174, v180, v181
    v_cvt_pk_bf16_f32 v175, v182, v183
    ds_read2_b32 v[136:137], v34 offset0:80 offset1:208
    ds_read_b128 v[2:5], v35 offset:320
    ds_read_b128 v[220:223], v35 offset:832
    v_pk_fma_f32 v[120:121], v[28:29], v[24:25], v[120:121] op_sel:[0,1,0] op_sel_hi:[1,1,1]
    v_pk_fma_f32 v[122:123], v[30:31], v[24:25], v[122:123] op_sel:[0,1,0] op_sel_hi:[1,1,1]
    v_pk_fma_f32 v[124:125], v[32:33], v[24:25], v[124:125] op_sel:[0,1,0] op_sel_hi:[1,1,1]
    v_pk_fma_f32 v[126:127], v[36:37], v[24:25], v[126:127] op_sel:[0,1,0] op_sel_hi:[1,1,1]
    v_pk_fma_f32 v[72:73], v[204:205], v[24:25], v[72:73] op_sel:[0,1,0] op_sel_hi:[1,1,1]
    v_pk_fma_f32 v[74:75], v[206:207], v[24:25], v[74:75] op_sel:[0,1,0] op_sel_hi:[1,1,1]
    v_pk_fma_f32 v[76:77], v[208:209], v[24:25], v[76:77] op_sel:[0,1,0] op_sel_hi:[1,1,1]
    v_pk_fma_f32 v[78:79], v[210:211], v[24:25], v[78:79] op_sel:[0,1,0] op_sel_hi:[1,1,1]
    v_pk_fma_f32 v[156:157], v[16:17], v[8:9], v[156:157] op_sel_hi:[1,0,1]
    buffer_load_dwordx4 v253, s[24:27], s59 offen offset:1024 lds
    ds_read_b64_tr_b16 a[132:133], v249 offset:0
    ds_read_b64_tr_b16 a[134:135], v249 offset:2048
    v_pk_fma_f32 v[158:159], v[18:19], v[8:9], v[158:159] op_sel_hi:[1,0,1]
    v_pk_fma_f32 v[184:185], v[16:17], v[8:9], v[184:185] op_sel:[0,1,0] op_sel_hi:[1,1,1]
    v_pk_fma_f32 v[186:187], v[18:19], v[8:9], v[186:187] op_sel:[0,1,0] op_sel_hi:[1,1,1]
    v_pk_mul_f32 v[120:121], v[120:121], v[24:25] op_sel_hi:[1,0]
    v_pk_mul_f32 v[122:123], v[122:123], v[24:25] op_sel_hi:[1,0]
    v_pk_mul_f32 v[124:125], v[124:125], v[24:25] op_sel_hi:[1,0]
    v_pk_mul_f32 v[126:127], v[126:127], v[24:25] op_sel_hi:[1,0]
    v_pk_mul_f32 v[156:157], v[156:157], v[12:13]
    v_pk_mul_f32 v[158:159], v[158:159], v[14:15]
    v_pk_mul_f32 v[184:185], v[184:185], v[12:13]
    v_pk_mul_f32 v[186:187], v[186:187], v[14:15]
    buffer_load_dwordx4 v254, s[24:27], s59 offen offset:2048 lds
    ds_read_b64_tr_b16 a[136:137], v250 offset:0
    ds_read_b64_tr_b16 a[138:139], v250 offset:2048
    v_mul_f32 v200, 0x3e8b97f6, v24
    v_mfma_f32_16x16x32_bf16 v[68:71], v[104:107], v[64:67], 0
    v_mfma_f32_16x16x32_bf16 v[116:119], v[112:115], v[64:67], v[212:215]
    v_cvt_pk_bf16_f32 v72, v72, v73
    v_cvt_pk_bf16_f32 v73, v74, v75
    v_cvt_pk_bf16_f32 v74, v76, v77
    v_cvt_pk_bf16_f32 v75, v78, v79
    v_cvt_pk_bf16_f32 v120, v120, v121
    buffer_load_dwordx4 v255, s[24:27], s59 offen offset:3072 lds
    ds_read_b64_tr_b16 a[140:141], v251 offset:0
    ds_read_b64_tr_b16 a[142:143], v251 offset:2048
    v_cvt_pk_bf16_f32 v121, v122, v123
    v_cvt_pk_bf16_f32 v122, v124, v125
    v_cvt_pk_bf16_f32 v123, v126, v127
    v_cvt_pk_bf16_f32 v148, v156, v157
    v_cvt_pk_bf16_f32 v149, v158, v159
    v_cvt_pk_bf16_f32 v176, v184, v185
    v_cvt_pk_bf16_f32 v177, v186, v187
    s_waitcnt lgkmcnt(6)
    v_pk_fma_f32 v[128:129], v[28:29], v[136:137], v[128:129] op_sel:[0,1,0] op_sel_hi:[1,1,1]
    v_pk_fma_f32 v[130:131], v[30:31], v[136:137], v[130:131] op_sel:[0,1,0] op_sel_hi:[1,1,1]
    v_pk_fma_f32 v[132:133], v[32:33], v[136:137], v[132:133] op_sel:[0,1,0] op_sel_hi:[1,1,1]
    v_pk_fma_f32 v[134:135], v[36:37], v[136:137], v[134:135] op_sel:[0,1,0] op_sel_hi:[1,1,1]
    s_waitcnt lgkmcnt(0)
    s_add_u32 m0, s52, 0
    s_add_u32 s59, s59, 131072
    buffer_load_dwordx4 v252, s[24:27], s59 offen lds
    s_waitcnt vmcnt(9)
    ds_read_b64_tr_b16 a[144:145], v248 offset:16384
    ds_read_b64_tr_b16 a[146:147], v248 offset:18432
    v_pk_fma_f32 v[80:81], v[204:205], v[136:137], v[80:81] op_sel:[0,1,0] op_sel_hi:[1,1,1]
    v_pk_fma_f32 v[82:83], v[206:207], v[136:137], v[82:83] op_sel:[0,1,0] op_sel_hi:[1,1,1]
    v_pk_fma_f32 v[84:85], v[208:209], v[136:137], v[84:85] op_sel:[0,1,0] op_sel_hi:[1,1,1]
    v_pk_fma_f32 v[86:87], v[210:211], v[136:137], v[86:87] op_sel:[0,1,0] op_sel_hi:[1,1,1]
    v_pk_fma_f32 v[160:161], v[220:221], v[8:9], v[160:161] op_sel_hi:[1,0,1]
    v_pk_fma_f32 v[162:163], v[222:223], v[8:9], v[162:163] op_sel_hi:[1,0,1]
    v_pk_fma_f32 v[188:189], v[220:221], v[8:9], v[188:189] op_sel:[0,1,0] op_sel_hi:[1,1,1]
    v_pk_fma_f32 v[190:191], v[222:223], v[8:9], v[190:191] op_sel:[0,1,0] op_sel_hi:[1,1,1]
    v_pk_mul_f32 v[128:129], v[128:129], v[136:137] op_sel_hi:[1,0]
    v_pk_mul_f32 v[130:131], v[130:131], v[136:137] op_sel_hi:[1,0]
    v_pk_mul_f32 v[132:133], v[132:133], v[136:137] op_sel_hi:[1,0]
    v_pk_mul_f32 v[134:135], v[134:135], v[136:137] op_sel_hi:[1,0]
    buffer_load_dwordx4 v253, s[24:27], s59 offen offset:1024 lds
    ds_read_b64_tr_b16 a[148:149], v249 offset:16384
    ds_read_b64_tr_b16 a[150:151], v249 offset:18432
    v_pk_mul_f32 v[160:161], v[160:161], v[2:3]
    v_pk_mul_f32 v[162:163], v[162:163], v[4:5]
    v_pk_mul_f32 v[188:189], v[188:189], v[2:3]
    v_pk_mul_f32 v[190:191], v[190:191], v[4:5]
    v_mul_f32 v202, 0x3e8b97f6, v136
    v_mfma_f32_16x16x32_bf16 v[76:79], v[112:115], v[72:75], 0
    v_mfma_f32_16x16x32_bf16 v[124:127], v[120:123], v[72:75], v[212:215]
    buffer_load_dwordx4 v254, s[24:27], s59 offen offset:2048 lds
    ds_read_b64_tr_b16 a[152:153], v250 offset:16384
    ds_read_b64_tr_b16 a[154:155], v250 offset:18432
    v_cvt_pk_bf16_f32 v80, v80, v81
    v_cvt_pk_bf16_f32 v81, v82, v83
    v_cvt_pk_bf16_f32 v82, v84, v85
    v_cvt_pk_bf16_f32 v83, v86, v87
    v_cvt_pk_bf16_f32 v128, v128, v129
    v_cvt_pk_bf16_f32 v129, v130, v131
    v_cvt_pk_bf16_f32 v130, v132, v133
    v_cvt_pk_bf16_f32 v131, v134, v135
    v_cvt_pk_bf16_f32 v150, v160, v161
    v_cvt_pk_bf16_f32 v151, v162, v163
    v_cvt_pk_bf16_f32 v178, v188, v189
    v_cvt_pk_bf16_f32 v179, v190, v191
    buffer_load_dwordx4 v255, s[24:27], s59 offen offset:3072 lds
    ds_read_b64_tr_b16 a[156:157], v251 offset:16384
    ds_read_b64_tr_b16 a[158:159], v251 offset:18432
    v_mfma_f32_16x16x32_bf16 v[84:87], v[120:123], v[80:83], 0
    v_mfma_f32_16x16x32_bf16 v[132:135], v[128:131], v[80:83], v[212:215]
    v_max3_f32 v193, v92, v93, v94
    v_max_f32 v193, v193, v95
    v_cndmask_b32 v100, v100, v52, s[6:7]
    v_cndmask_b32 v101, v101, v53, s[46:47]
    v_cndmask_b32 v102, v102, v54, s[48:49]
    s_waitcnt lgkmcnt(0)
    s_add_u32 m0, s52, 16384
    s_add_u32 s59, s59, 131072
    buffer_load_dwordx4 v252, s[24:27], s59 offen lds
    s_waitcnt vmcnt(9)
    ds_read_b64_tr_b16 a[160:161], v248 offset:32768
    ds_read_b64_tr_b16 a[162:163], v248 offset:34816
    v_cndmask_b32 v103, v103, v55, s[50:51]
    v_max3_f32 v195, v100, v101, v102
    v_max_f32 v195, v195, v103
    v_cndmask_b32 v108, v108, v60, s[6:7]
    v_cndmask_b32 v109, v109, v61, s[46:47]
    v_cndmask_b32 v110, v110, v62, s[48:49]
    v_cndmask_b32 v111, v111, v63, s[50:51]
    v_max3_f32 v197, v108, v109, v110
    v_max_f32 v197, v197, v111
    v_cndmask_b32 v116, v116, v68, s[6:7]
    v_cndmask_b32 v117, v117, v69, s[46:47]
    buffer_load_dwordx4 v253, s[24:27], s59 offen offset:1024 lds
    ds_read_b64_tr_b16 a[164:165], v249 offset:32768
    ds_read_b64_tr_b16 a[166:167], v249 offset:34816
    v_cndmask_b32 v118, v118, v70, s[48:49]
    v_cndmask_b32 v119, v119, v71, s[50:51]
    v_max3_f32 v199, v116, v117, v118
    v_max_f32 v199, v199, v119
    v_cndmask_b32 v124, v124, v76, s[6:7]
    v_cndmask_b32 v125, v125, v77, s[46:47]
    v_cndmask_b32 v126, v126, v78, s[48:49]
    v_cndmask_b32 v127, v127, v79, s[50:51]
    v_max3_f32 v201, v124, v125, v126
    v_max_f32 v201, v201, v127
    v_cndmask_b32 v132, v132, v84, s[6:7]
    v_cndmask_b32 v133, v133, v85, s[46:47]
    buffer_load_dwordx4 v254, s[24:27], s59 offen offset:2048 lds
    ds_read_b64_tr_b16 a[168:169], v250 offset:32768
    ds_read_b64_tr_b16 a[170:171], v250 offset:34816
    v_cndmask_b32 v134, v134, v86, s[48:49]
    v_cndmask_b32 v135, v135, v87, s[50:51]
    v_max3_f32 v203, v132, v133, v134
    v_max_f32 v203, v203, v135
    v_permlane16_swap_b32 v193, v195
    s_nop 0
    v_permlane16_swap_b32 v201, v203
    v_max_f32 v193, v193, v195
    v_max_f32 v201, v201, v203
    v_permlane16_swap_b32 v197, v199
    v_mov_b32 v203, v201
    buffer_load_dwordx4 v255, s[24:27], s59 offen offset:3072 lds
    ds_read_b64_tr_b16 a[172:173], v251 offset:32768
    ds_read_b64_tr_b16 a[174:175], v251 offset:34816
    v_max_f32 v197, v197, v199
    v_permlane32_swap_b32 v201, v203
    s_nop 0
    v_permlane32_swap_b32 v193, v197
    v_max_f32 v201, v201, v203
    v_max_f32 v193, v193, v197
    v_mov_b32 v203, v201
    v_mov_b32 v197, v193
    s_nop 0
    v_permlane16_swap_b32 v201, v203
    v_permlane32_swap_b32 v193, v197
    s_add_u32 m0, s70, 0
    s_nop 0
    buffer_load_dwordx4 v224, s[16:19], s69 offen lds
    s_waitcnt vmcnt(9)
    ds_read_b64_tr_b16 a[176:177], v248 offset:49152
    ds_read_b64_tr_b16 a[178:179], v248 offset:51200
    v_mov_b32 v199, v197
    v_mov_b32 v195, v193
    s_nop 0
    v_permlane16_swap_b32 v197, v199
    v_permlane16_swap_b32 v193, v195
    v_mul_f32 v193, -v193, v192
    v_mul_f32 v195, -v195, v194
    v_mul_f32 v197, -v197, v196
    v_mul_f32 v199, -v199, v198
    v_mul_f32 v201, -v201, v200
    v_mul_f32 v203, -v203, v202
    s_add_u32 m0, s70, 1024
    s_add_u32 s69, s69, 7168
    buffer_load_dwordx4 v224, s[16:19], s69 offen lds
    ds_read_b64_tr_b16 a[180:181], v249 offset:49152
    ds_read_b64_tr_b16 a[182:183], v249 offset:51200
    v_pk_fma_f32 v[92:93], v[92:93], v[192:193], v[192:193] op_sel:[0,0,1] op_sel_hi:[1,0,1]
    v_pk_fma_f32 v[94:95], v[94:95], v[192:193], v[192:193] op_sel:[0,0,1] op_sel_hi:[1,0,1]
    v_pk_fma_f32 v[100:101], v[100:101], v[194:195], v[194:195] op_sel:[0,0,1] op_sel_hi:[1,0,1]
    v_pk_fma_f32 v[102:103], v[102:103], v[194:195], v[194:195] op_sel:[0,0,1] op_sel_hi:[1,0,1]
    v_pk_fma_f32 v[108:109], v[108:109], v[196:197], v[196:197] op_sel:[0,0,1] op_sel_hi:[1,0,1]
    v_pk_fma_f32 v[110:111], v[110:111], v[196:197], v[196:197] op_sel:[0,0,1] op_sel_hi:[1,0,1]
    v_pk_fma_f32 v[116:117], v[116:117], v[198:199], v[198:199] op_sel:[0,0,1] op_sel_hi:[1,0,1]
    v_pk_fma_f32 v[118:119], v[118:119], v[198:199], v[198:199] op_sel:[0,0,1] op_sel_hi:[1,0,1]
    v_pk_fma_f32 v[124:125], v[124:125], v[200:201], v[200:201] op_sel:[0,0,1] op_sel_hi:[1,0,1]
    v_pk_fma_f32 v[126:127], v[126:127], v[200:201], v[200:201] op_sel:[0,0,1] op_sel_hi:[1,0,1]
    v_pk_fma_f32 v[132:133], v[132:133], v[202:203], v[202:203] op_sel:[0,0,1] op_sel_hi:[1,0,1]
    v_pk_fma_f32 v[134:135], v[134:135], v[202:203], v[202:203] op_sel:[0,0,1] op_sel_hi:[1,0,1]
    s_add_u32 m0, s70, 2048
    s_add_u32 s69, s69, 7168
    buffer_load_dwordx4 v224, s[16:19], s69 offen lds
    ds_read_b64_tr_b16 a[184:185], v250 offset:49152
    ds_read_b64_tr_b16 a[186:187], v250 offset:51200
    v_exp_f32 v92, v92
    v_exp_f32 v93, v93
    v_exp_f32 v94, v94
    v_exp_f32 v95, v95
    v_cvt_pk_bf16_f32 v42, v92, v93
    v_cvt_pk_bf16_f32 v43, v94, v95
    v_mov_b32 v40, 0
    v_mov_b32 v41, 0
    v_exp_f32 v100, v100
    s_add_u32 m0, s70, 3072
    s_add_u32 s69, s69, 7168
    buffer_load_dwordx4 v224, s[16:19], s69 offen lds
    ds_read_b64_tr_b16 a[188:189], v251 offset:49152
    ds_read_b64_tr_b16 a[190:191], v251 offset:51200
    v_exp_f32 v101, v101
    v_mfma_f32_16x16x32_bf16 v[88:91], v[20:23], v[40:43], 0
    v_exp_f32 v102, v102
    v_mfma_f32_16x16x32_bf16 v[44:47], v[138:141], v[40:43], 0
    v_exp_f32 v103, v103
    s_add_u32 m0, s70, 4096
    s_add_u32 s69, s69, 7168
    buffer_load_dwordx4 v224, s[16:19], s69 offen lds
    s_waitcnt vmcnt(9)
    ds_read_b64_tr_b16 a[192:193], v248 offset:0
    ds_read_b64_tr_b16 a[194:195], v248 offset:2048
    v_mfma_f32_16x16x32_bf16 v[92:95], v[166:169], v[40:43], 0
    v_cvt_pk_bf16_f32 v50, v100, v101
    v_cvt_pk_bf16_f32 v51, v102, v103
    v_and_b32 v48, v10, v50
    v_and_b32 v49, v11, v51
    v_xor_b32 v50, v48, v50
    v_xor_b32 v51, v49, v51
    v_exp_f32 v108, v108
    v_exp_f32 v109, v109
    s_add_u32 m0, s70, 5120
    s_add_u32 s69, s69, 7168
    buffer_load_dwordx4 v224, s[16:19], s69 offen lds
    ds_read_b64_tr_b16 a[196:197], v249 offset:0
    ds_read_b64_tr_b16 a[198:199], v249 offset:2048
    v_mfma_f32_16x16x32_bf16 v[96:99], v[20:23], v[48:51], 0
    v_exp_f32 v110, v110
    v_mfma_f32_16x16x32_bf16 v[52:55], v[140:143], v[48:51], 0
    v_exp_f32 v111, v111
    v_mfma_f32_16x16x32_bf16 v[100:103], v[168:171], v[48:51], 0
    s_add_u32 m0, s70, 6144
    s_add_u32 s69, s69, 7168
    buffer_load_dwordx4 v224, s[16:19], s69 offen lds
    ds_read_b64_tr_b16 a[200:201], v250 offset:0
    ds_read_b64_tr_b16 a[202:203], v250 offset:2048
    v_cvt_pk_bf16_f32 v58, v108, v109
    v_cvt_pk_bf16_f32 v59, v110, v111
    v_and_b32 v56, v10, v58
    v_and_b32 v57, v11, v59
    v_xor_b32 v58, v56, v58
    v_xor_b32 v59, v57, v59
    v_exp_f32 v116, v116
    v_exp_f32 v117, v117
    s_add_u32 m0, s70, 7168
    s_add_u32 s69, s69, 7168
    buffer_load_dwordx4 v224, s[16:19], s69 offen lds
    ds_read_b64_tr_b16 a[204:205], v251 offset:0
    ds_read_b64_tr_b16 a[206:207], v251 offset:2048
    v_mfma_f32_16x16x32_bf16 v[104:107], v[20:23], v[56:59], 0
    v_exp_f32 v118, v118
    v_mfma_f32_16x16x32_bf16 v[60:63], v[142:145], v[56:59], 0
    v_exp_f32 v119, v119
    v_mfma_f32_16x16x32_bf16 v[108:111], v[170:173], v[56:59], 0
    s_add_u32 m0, s70, 8192
    s_add_u32 s69, s69, 7168
    buffer_load_dwordx4 v224, s[16:19], s69 offen lds
    s_waitcnt vmcnt(9)
    ds_read_b64_tr_b16 a[208:209], v248 offset:16384
    ds_read_b64_tr_b16 a[210:211], v248 offset:18432
    v_cvt_pk_bf16_f32 v66, v116, v117
    v_cvt_pk_bf16_f32 v67, v118, v119
    v_and_b32 v64, v10, v66
    v_and_b32 v65, v11, v67
    v_xor_b32 v66, v64, v66
    v_xor_b32 v67, v65, v67
    v_exp_f32 v124, v124
    v_exp_f32 v125, v125
    v_mfma_f32_16x16x32_bf16 v[112:115], v[20:23], v[64:67], 0
    s_add_u32 m0, s70, 9216
    s_add_u32 s69, s69, 7168
    buffer_load_dwordx4 v224, s[16:19], s69 offen lds
    ds_read_b64_tr_b16 a[212:213], v249 offset:16384
    ds_read_b64_tr_b16 a[214:215], v249 offset:18432
    v_exp_f32 v126, v126
    v_mfma_f32_16x16x32_bf16 v[68:71], v[144:147], v[64:67], 0
    v_exp_f32 v127, v127
    v_mfma_f32_16x16x32_bf16 v[116:119], v[172:175], v[64:67], 0
    s_add_u32 m0, s70, 10240
    s_add_u32 s69, s69, 7168
    buffer_load_dwordx4 v224, s[16:19], s69 offen lds
    ds_read_b64_tr_b16 a[216:217], v250 offset:16384
    ds_read_b64_tr_b16 a[218:219], v250 offset:18432
    v_cvt_pk_bf16_f32 v74, v124, v125
    v_cvt_pk_bf16_f32 v75, v126, v127
    v_and_b32 v72, v10, v74
    v_and_b32 v73, v11, v75
    v_xor_b32 v74, v72, v74
    v_xor_b32 v75, v73, v75
    v_exp_f32 v132, v132
    v_exp_f32 v133, v133
    v_mfma_f32_16x16x32_bf16 v[120:123], v[20:23], v[72:75], 0
    s_add_u32 m0, s70, 11264
    s_add_u32 s69, s69, 7168
    buffer_load_dwordx4 v224, s[16:19], s69 offen lds
    ds_read_b64_tr_b16 a[220:221], v251 offset:16384
    ds_read_b64_tr_b16 a[222:223], v251 offset:18432
    v_exp_f32 v134, v134
    v_mfma_f32_16x16x32_bf16 v[76:79], v[146:149], v[72:75], 0
    v_exp_f32 v135, v135
    v_mfma_f32_16x16x32_bf16 v[124:127], v[174:177], v[72:75], 0
    v_cvt_pk_bf16_f32 v82, v132, v133
    v_cvt_pk_bf16_f32 v83, v134, v135
    s_add_u32 m0, s70, 12288
    s_add_u32 s69, s69, 7168
    buffer_load_dwordx4 v224, s[16:19], s69 offen lds
    v_and_b32 v80, v10, v82
    v_and_b32 v81, v11, v83
    v_xor_b32 v82, v80, v82
    v_xor_b32 v83, v81, v83
    v_rcp_f32 v88, v88
    v_rcp_f32 v96, v96
    v_mfma_f32_16x16x32_bf16 v[128:131], v[20:23], v[80:83], 0
    v_rcp_f32 v104, v104
    s_add_u32 m0, s70, 13312
    s_add_u32 s69, s69, 7168
    buffer_load_dwordx4 v224, s[16:19], s69 offen lds
    v_mfma_f32_16x16x32_bf16 v[84:87], v[148:151], v[80:83], 0
    v_rcp_f32 v112, v112
    v_mfma_f32_16x16x32_bf16 v[132:135], v[176:179], v[80:83], 0
    v_rcp_f32 v120, v120
    v_rcp_f32 v128, v128
    buffer_load_dwordx2 v[232:233], v228, s[40:43], 0 offen sc1
    v_pk_mul_f32 v[44:45], v[44:45], v[88:89] op_sel_hi:[1,0]
    v_pk_mul_f32 v[46:47], v[46:47], v[88:89] op_sel_hi:[1,0]
    v_pk_mul_f32 v[92:93], v[92:93], v[88:89] op_sel_hi:[1,0]
    v_pk_mul_f32 v[94:95], v[94:95], v[88:89] op_sel_hi:[1,0]
    v_cvt_pk_bf16_f32 v40, v44, v45
    v_cvt_pk_bf16_f32 v41, v46, v47
    v_cvt_pk_bf16_f32 v42, v92, v93
    v_cvt_pk_bf16_f32 v43, v94, v95
    buffer_store_dwordx4 v[40:43], v27, s[40:43], s1 offen sc1
    s_add_u32 s1, s1, 32768
    v_pk_mul_f32 v[52:53], v[52:53], v[96:97] op_sel_hi:[1,0]
    v_pk_mul_f32 v[54:55], v[54:55], v[96:97] op_sel_hi:[1,0]
    v_pk_mul_f32 v[100:101], v[100:101], v[96:97] op_sel_hi:[1,0]
    v_pk_mul_f32 v[102:103], v[102:103], v[96:97] op_sel_hi:[1,0]
    v_cvt_pk_bf16_f32 v48, v52, v53
    v_cvt_pk_bf16_f32 v49, v54, v55
    v_cvt_pk_bf16_f32 v50, v100, v101
    v_cvt_pk_bf16_f32 v51, v102, v103
    buffer_store_dwordx4 v[48:51], v7, s[40:43], s1 offen sc1
    s_add_u32 s1, s1, 32768
    v_pk_mul_f32 v[60:61], v[60:61], v[104:105] op_sel_hi:[1,0]
    v_pk_mul_f32 v[62:63], v[62:63], v[104:105] op_sel_hi:[1,0]
    v_pk_mul_f32 v[108:109], v[108:109], v[104:105] op_sel_hi:[1,0]
    v_pk_mul_f32 v[110:111], v[110:111], v[104:105] op_sel_hi:[1,0]
    v_cvt_pk_bf16_f32 v56, v60, v61
    v_cvt_pk_bf16_f32 v57, v62, v63
    v_cvt_pk_bf16_f32 v58, v108, v109
    v_cvt_pk_bf16_f32 v59, v110, v111
    buffer_store_dwordx4 v[56:59], v7, s[40:43], s1 offen sc1
    s_add_u32 s1, s1, 32768
    v_pk_mul_f32 v[68:69], v[68:69], v[112:113] op_sel_hi:[1,0]
    v_pk_mul_f32 v[70:71], v[70:71], v[112:113] op_sel_hi:[1,0]
    v_pk_mul_f32 v[116:117], v[116:117], v[112:113] op_sel_hi:[1,0]
    v_pk_mul_f32 v[118:119], v[118:119], v[112:113] op_sel_hi:[1,0]
    v_cvt_pk_bf16_f32 v64, v68, v69
    v_cvt_pk_bf16_f32 v65, v70, v71
    v_cvt_pk_bf16_f32 v66, v116, v117
    v_cvt_pk_bf16_f32 v67, v118, v119
    buffer_store_dwordx4 v[64:67], v7, s[40:43], s1 offen sc1
    s_add_u32 s1, s1, 32768
    v_pk_mul_f32 v[76:77], v[76:77], v[120:121] op_sel_hi:[1,0]
    v_pk_mul_f32 v[78:79], v[78:79], v[120:121] op_sel_hi:[1,0]
    v_pk_mul_f32 v[124:125], v[124:125], v[120:121] op_sel_hi:[1,0]
    v_pk_mul_f32 v[126:127], v[126:127], v[120:121] op_sel_hi:[1,0]
    v_cvt_pk_bf16_f32 v72, v76, v77
    v_cvt_pk_bf16_f32 v73, v78, v79
    v_cvt_pk_bf16_f32 v74, v124, v125
    v_cvt_pk_bf16_f32 v75, v126, v127
    buffer_store_dwordx4 v[72:75], v7, s[40:43], s1 offen sc1
    s_add_u32 s1, s1, 32768
    v_pk_mul_f32 v[84:85], v[84:85], v[128:129] op_sel_hi:[1,0]
    v_pk_mul_f32 v[86:87], v[86:87], v[128:129] op_sel_hi:[1,0]
    v_pk_mul_f32 v[132:133], v[132:133], v[128:129] op_sel_hi:[1,0]
    v_pk_mul_f32 v[134:135], v[134:135], v[128:129] op_sel_hi:[1,0]
    v_cvt_pk_bf16_f32 v80, v84, v85
    v_cvt_pk_bf16_f32 v81, v86, v87
    v_cvt_pk_bf16_f32 v82, v132, v133
    v_cvt_pk_bf16_f32 v83, v134, v135
    buffer_store_dwordx4 v[80:83], v7, s[40:43], s1 offen sc1
    s_add_u32 s1, s1, 32768
    v_and_b32 v29, 7, v1
    v_bfe_u32 v31, v1, 3, 1
    v_lshl_add_u32 v29, v29, 1, v31
    s_lshr_b32 s74, s52, 1
    s_add_u32 s74, s74, 149504
    v_add_u32 v18, s74, v231
    v_lshl_add_u32 v31, v29, 7, s74
    v_lshrrev_b32 v28, 4, v1
    v_bfe_u32 v16, v29, 1, 2
    v_lshl_add_u32 v16, v16, 2, v28
    v_lshl_add_u32 v16, v16, 3, v31
    v_and_b32 v19, 7, v29
    v_lshrrev_b32 v29, 3, v29
    v_lshl_or_b32 v19, v19, 1, v29
    v_xor_b32 v19, v19, v28
    v_lshl_add_u32 v19, v19, 3, v31
    v_and_b32 v29, 8, v1
    v_lshlrev_b32 v29, 1, v29
    v_xor_b32 v225, v224, v29
    v_add_u32 v24, s52, v231
    v_and_b32 v29, 7, v1
    v_bfe_u32 v28, v1, 3, 1
    v_lshl_add_u32 v29, v29, 1, v28
    v_and_b32 v28, 48, v1
    v_add_lshl_u32 v29, v29, v28, 4
    s_sub_u32 s74, s3, 0
    s_and_b32 s74, s74, 3
    s_lshl_b32 s74, s74, 12
    s_add_u32 s74, s74, 0
    v_add_u32 v25, s74, v29
    s_sub_u32 s74, s3, 1
    s_and_b32 s74, s74, 3
    s_lshl_b32 s74, s74, 12
    s_add_u32 s74, s74, 1024
    v_add_u32 v26, s74, v29
    s_sub_u32 s74, s3, 2
    s_and_b32 s74, s74, 3
    s_lshl_b32 s74, s74, 12
    s_add_u32 s74, s74, 2048
    v_add_u32 v27, s74, v29
    s_sub_u32 s74, s3, 3
    s_and_b32 s74, s74, 3
    s_lshl_b32 s74, s74, 12
    s_add_u32 s74, s74, 3072
    v_add_u32 v28, s74, v29
    v_xor_b32 v13, 32, v16
    v_xor_b32 v14, 64, v16
    v_xor_b32 v15, 0x60, v16
    ds_read_b64 v[236:237], v16
    ds_read_b64 v[238:239], v13
    ds_read_b64 v[240:241], v14
    ds_read_b64 v[242:243], v15
    v_lshlrev_b32 v20, 16, v227
    v_lshlrev_b32 v21, 16, v227
    v_lshlrev_b32 v22, 16, v227
    v_lshlrev_b32 v23, 16, v227
    s_waitcnt vmcnt(6)
    v_cmp_ne_u64 vcc, s[44:45], v[232:233]
    s_mov_b32 s65, 0
    s_cbranch_vccz L_polled_32
L_poll_31:
    buffer_load_dwordx2 v[232:233], v228, s[40:43], 0 offen sc1
    s_waitcnt vmcnt(0)
    v_cmp_ne_u64 vcc, s[44:45], v[232:233]
    s_add_u32 s65, s65, 1
    s_cbranch_vccz L_polled_32
    s_cmp_lt_u32 s65, 200000
    s_cbranch_scc1 L_poll_31
L_polled_32:
    buffer_load_dwordx4 v[112:115], v234, s[40:43], s66 offen sc1
    s_add_u32 s66, s66, 59392
    buffer_load_dwordx4 v[116:119], v234, s[40:43], s66 offen sc1
    s_add_u32 s66, s66, 59392
    buffer_load_dwordx4 v[120:123], v234, s[40:43], s66 offen sc1
    s_add_u32 s66, s66, 59392
    buffer_load_dwordx4 v[124:127], v234, s[40:43], s66 offen sc1
    s_add_u32 s66, s66, 59392
    buffer_load_dwordx4 v[128:131], v234, s[40:43], s66 offen sc1
    s_add_u32 s66, s66, 59392
    buffer_load_dwordx4 v[132:135], v234, s[40:43], s66 offen sc1
    s_add_u32 s66, s66, 59392
    buffer_load_dwordx4 v[136:139], v234, s[40:43], s66 offen sc1
    s_add_u32 s66, s66, 59392
    buffer_load_dwordx4 v[140:143], v234, s[40:43], s66 offen sc1
    s_add_u32 s66, s66, 59392
    buffer_load_dwordx4 v[144:147], v234, s[40:43], s66 offen sc1
    s_add_u32 s66, s66, 59392
    buffer_load_dwordx4 v[148:151], v234, s[40:43], s66 offen sc1
    s_add_u32 s66, s66, 59392
    buffer_load_dwordx4 v[152:155], v234, s[40:43], s66 offen sc1
    s_add_u32 s66, s66, 59392
    buffer_load_dwordx4 v[156:159], v234, s[40:43], s66 offen sc1
    s_branch L_p2
L_pure:
    s_mul_i32 s58, s64, 13
    s_lshl_b32 s74, s58, 3
    s_add_u32 s74, s74, s77
    s_sub_u32 s74, s74, 8
    v_lshrrev_b32 v12, 3, v1
    v_add_u32 v13, s74, v12
    s_lshl_b32 s75, s76, 2
    v_lshrrev_b32 v12, 1, v12
    v_add_u32 v12, s75, v12
    v_and_b32 v14, 7, v1
    v_xor_b32 v12, v12, v14
    v_lshlrev_b32 v12, 4, v12
    s_mul_i32 s75, s63, 896
    v_add_u32 v12, s75, v12
    s_movk_i32 s76, 1023
    s_movk_i32 s77, 1792
    s_cmp_eq_u32 s3, 0
    s_cselect_b32 s4, 0xffffff00, -1
    s_mov_b32 s5, -1
    v_add_u32 v14, 0, v13
    v_med3_i32 v14, v14, 0, s76
    v_mad_u32_u24 v3, v14, s77, v12
L_pad_11:
    s_cbranch_execz L_ret
    v_add_u32 v14, 32, v13
    v_med3_i32 v14, v14, 0, s76
    v_mad_u32_u24 v4, v14, s77, v12
    v_add_u32 v14, 64, v13
    v_med3_i32 v14, v14, 0, s76
    v_mad_u32_u24 v5, v14, s77, v12
    v_add_u32 v14, 96, v13
    v_med3_i32 v14, v14, 0, s76
    v_mad_u32_u24 v6, v14, s77, v12
    s_add_u32 m0, s57, 12288
    s_cmp_ge_u32 s3, 2
    s_cbranch_scc1 L_xs_33
    buffer_load_dwordx4 v6, s[8:11], s55 offen lds
L_xs_33:
    s_add_u32 m0, s57, 8192
    s_nop 0
    buffer_load_dwordx4 v5, s[8:11], s55 offen lds
    s_add_u32 m0, s57, 4096
    s_nop 0
    buffer_load_dwordx4 v4, s[8:11], s55 offen lds
    s_add_u32 m0, s57, 0
    s_mov_b64 exec, s[4:5]
    buffer_load_dwordx4 v3, s[8:11], s55 offen lds
    s_mov_b64 exec, -1
    s_load_dword s44, s[40:41], 0
    s_load_dword s45, s[40:41], 81792
    s_load_dwordx2 s[16:17], s[0:1], 16
    s_load_dwordx2 s[24:25], s[0:1], 48
    s_load_dwordx2 s[32:33], s[0:1], 56
    s_load_dwordx2 s[36:37], s[0:1], 64
    s_mov_b32 s42, 12058624
    s_mov_b32 s43, 0x20000
    s_mov_b32 s18, 401408
    s_mov_b32 s19, 0x20000
    s_mov_b32 s26, 7340032
    s_mov_b32 s27, 0x20000
    s_mov_b32 s34, 4096
    s_mov_b32 s35, 0x20000
    s_mov_b32 s38, 1835008
    s_mov_b32 s39, 0x20000
    v_mov_b32 v20, 0x3f803f80
    v_and_b32 v13, 31, v0
    v_lshlrev_b32 v13, 2, v13
    v_add_u32 v13, 98304, v13
    ds_write_b32 v13, v20 offset:0
    ds_write_b32 v13, v20 offset:14336
    ds_write_b32 v13, v20 offset:28672
    v_and_b32 v12, 15, v1
    v_lshrrev_b32 v13, 4, v1
    v_lshrrev_b32 v14, 1, v12
    v_xor_b32 v14, v14, v13
    v_lshlrev_b32 v14, 4, v14
    v_lshl_add_u32 v14, v12, 7, v14
    v_add_u32 v8, 98304, v14
    v_xor_b32 v9, 64, v8
    s_nop 0
    v_lshrrev_b32 v14, 2, v1
    v_lshlrev_b32 v12, 8, v14
    v_and_b32 v14, 7, v14
    v_lshlrev_b32 v14, 5, v14
    v_and_b32 v15, 3, v1
    s_and_b32 s75, s62, 1
    s_lshl_b32 s74, s75, 5
    s_mul_i32 s76, s3, 56
    s_add_u32 s74, s74, s76
    v_lshl_add_u32 v13, v15, 3, s74
    v_cmp_eq_u32 s[6:7], 3, v15
    s_xor_b32 s75, s75, 1
    s_mul_i32 s75, s75, 224
    v_add_u32 v15, 32, v13
    v_and_b32 v16, 24, v15
    v_add_u32 v16, s75, v16
    v_cndmask_b32 v15, v15, v16, s[6:7]
    v_xor_b32 v13, v13, v14
    v_xor_b32 v15, v15, v14
    v_add_u32 v30, v12, v13
    v_add_u32 v32, v12, v15
    v_add_u32 v31, 49152, v30
    v_add_u32 v33, 49152, v32
    s_waitcnt lgkmcnt(0)
    s_mov_b64 exec, 0
    s_cmp_lg_u32 s3, 0
    s_cbranch_scc1 L_w_34
    s_call_b64 s[70:71], L_pad_12
L_w_34:
    s_cmp_lg_u32 s3, 1
    s_cbranch_scc1 L_w_35
    s_call_b64 s[70:71], L_pad_13
L_w_35:
    s_cmp_lg_u32 s3, 2
    s_cbranch_scc1 L_w_36
    s_call_b64 s[70:71], L_pad_14
L_w_36:
    s_cmp_lg_u32 s3, 3
    s_cbranch_scc1 L_w_37
    s_call_b64 s[70:71], L_ret
L_w_37:
    s_mov_b64 exec, -1
L_site_pure:
    s_lshl_b32 s74, s58, 1
    s_sub_u32 s74, s74, 2
    v_and_b32 v12, 31, v1
    v_min_u32 v12, 27, v12
    v_add_u32 v12, s74, v12
    s_movk_i32 s75, 255
    v_med3_i32 v12, v12, 0, s75
    v_lshrrev_b32 v13, 1, v12
    v_mul_u32_u24 v13, 32, v13
    v_add_u32 v24, 4096, v13
    v_lshrrev_b32 v13, 5, v1
    v_lshlrev_b32 v13, 13, v13
    v_lshl_add_u32 v25, v12, 4, v13
    s_lshl_b32 s0, s63, 12
    s_add_u32 s0, s0, 81920
    s_lshl_b32 s74, s3, 10
    s_add_u32 m0, s56, 73728
    s_add_u32 s53, s53, 86016
    buffer_load_dwordx4 v2, s[12:15], s53 offen lds
    s_add_u32 s74, s74, 157696
    v_lshl_add_u32 v26, v1, 4, s74
    v_and_b32 v12, 15, v1
    v_lshl_add_u32 v34, v12, 2, s74
    v_lshrrev_b32 v13, 4, v1
    v_lshl_add_u32 v35, v13, 4, s74
    v_mov_b32 v21, v20
    v_mov_b32 v22, v20
    v_mov_b32 v23, v20
    v_mov_b32 v154, 0
    v_mov_b32 v155, 0
    v_mov_b32 v186, 0
    v_mov_b32 v187, 0
    s_lshl_b32 s52, s3, 12
    s_and_b32 s74, s46, 1
    s_mul_i32 s75, s74, 6
    s_add_u32 m0, s56, 77824
    s_add_u32 s54, s53, 10752
    buffer_load_dwordx4 v2, s[12:15], s54 offen lds
    s_add_u32 s78, s75, 4
    s_mul_i32 s78, s78, 1
    s_lshr_b32 s78, s78, 1
    s_sub_u32 s75, 4, s74
    s_mul_i32 s75, s75, 0
    s_add_u32 s78, s78, s75
    s_and_b32 s75, s47, 3
    s_add_u32 s78, s78, s75
    s_mov_b32 s79, 4
    s_lshl_b32 s75, s75, 2
    s_add_u32 s75, s75, s3
    s_lshl_b32 s75, s75, 13
    v_lshl_add_u32 v36, v1, 7, s75
    s_and_b32 s75, s47, 3
    s_lshl_b32 s75, s75, 3
    s_add_u32 s75, s75, s46
    s_add_u32 m0, s56, 81024
    s_nop 0
    buffer_load_dwordx4 v2, s[12:15], s53 offen offset:896 lds
    s_lshl_b32 s74, s3, 5
    s_add_u32 s75, s75, s74
    s_lshl_b32 s75, s75, 13
    v_lshl_add_u32 v251, v1, 7, s75
    v_mov_b32 v250, v36
    v_lshrrev_b32 v12, 2, v1
    v_lshlrev_b32 v12, 12, v12
    v_and_b32 v13, 3, v1
    v_lshl_add_u32 v12, v13, 7, v12
    s_xor_b32 s74, s46, 1
    s_lshl_b32 s74, s74, 9
    s_mul_i32 s75, s3, 1835008
    s_add_u32 s74, s74, s75
    v_add_u32 v38, s74, v12
    s_and_b32 s74, s46, 1
    s_xor_b32 s75, s74, 1
    s_add_u32 m0, s56, 85120
    s_nop 0
    buffer_load_dwordx4 v2, s[12:15], s54 offen offset:896 lds
    s_mul_i32 s76, s74, 0
    s_xor_b32 s76, s76, 3
    s_xor_b32 s77, s46, 1
    s_lshl_b32 s77, s77, 2
    s_lshl_b32 s75, s75, 0
    s_add_u32 s76, s76, s77
    s_lshl_b32 s76, s76, 7
    s_mul_i32 s77, s3, 1835008
    s_add_u32 s76, s76, s77
    v_lshl_add_u32 v37, v1, 12, s76
    s_mul_i32 s76, s74, 3
    s_add_u32 s76, s76, 2
    s_and_b32 s78, s47, 3
    s_xor_b32 s78, s78, 2
    s_add_u32 s76, s76, s78
    s_add_u32 s78, s78, 16
    s_add_u32 m0, s56, 88320
    s_nop 0
    buffer_load_dwordx4 v2, s[12:15], s53 offen offset:1792 lds
    s_add_u32 s76, s76, s75
    s_add_u32 s77, s76, 1
    s_lshr_b32 s77, s77, 3
    s_lshl_b32 s77, s77, 29
    s_lshl_b32 s76, s76, 18
    s_add_u32 s76, s76, s77
    v_add_u32 v37, s76, v37
    v_lshrrev_b32 v12, 4, v1
    v_lshlrev_b32 v12, 2, v12
    v_and_b32 v13, 15, v1
    v_sub_u32 v12, v12, v13
    v_mov_b32 v14, 0xff800000
    s_min_u32 s74, s64, 1
    s_sub_u32 s74, s74, 1
    s_mov_b32 s75, 0
    v_add_u32 v13, 7, v12
    s_add_u32 m0, s56, 92416
    s_nop 0
    buffer_load_dwordx4 v2, s[12:15], s54 offen offset:1792 lds
    v_cmp_gt_u32 s[76:77], 8, v13
    v_cmp_lt_i32 s[6:7], 15, v13
    s_nop 0
    v_cndmask_b32 v238, v14, 0, s[76:77]
    v_cndmask_b32 v242, v238, v14, s[74:75]
    v_add_u32 v13, 8, v12
    v_cmp_gt_u32 s[76:77], 8, v13
    v_cmp_lt_i32 s[46:47], 15, v13
    s_nop 0
    v_cndmask_b32 v239, v14, 0, s[76:77]
    v_cndmask_b32 v243, v239, v14, s[74:75]
    v_add_u32 v13, 9, v12
    v_cmp_gt_u32 s[76:77], 8, v13
    v_cmp_lt_i32 s[48:49], 15, v13
    s_nop 0
    v_cndmask_b32 v240, v14, 0, s[76:77]
    v_cndmask_b32 v244, v240, v14, s[74:75]
    v_add_u32 v13, 10, v12
    v_cmp_gt_u32 s[76:77], 8, v13
    s_add_u32 m0, s57, 26624
    s_add_u32 s55, s55, 128
    s_cmp_ge_u32 s55, 896
    s_cselect_b32 s55, 0, s55
    s_cmp_ge_u32 s3, 2
    s_cbranch_scc1 L_xs_38
    buffer_load_dwordx4 v6, s[8:11], s55 offen lds
L_xs_38:
    v_cmp_lt_i32 s[50:51], 15, v13
    v_cndmask_b32 v241, v14, 0, s[76:77]
    v_cndmask_b32 v245, v241, v14, s[74:75]
    v_mov_b32 v14, 0xffff
    v_mov_b32 v15, 0xffff0000
    v_cndmask_b32 v10, 0, v14, s[6:7]
    v_cndmask_b32 v13, 0, v15, s[46:47]
    v_or_b32 v10, v10, v13
    v_cndmask_b32 v11, 0, v14, s[48:49]
    v_cndmask_b32 v13, 0, v15, s[50:51]
    v_or_b32 v11, v11, v13
    v_bfe_u32 v12, v1, 3, 1
    v_lshrrev_b32 v13, 4, v1
    v_add_u32 v14, 1, v13
    v_lshrrev_b32 v14, 2, v14
    v_add_u32 v13, v13, v14
    s_add_u32 m0, s57, 22528
    s_nop 0
    buffer_load_dwordx4 v5, s[8:11], s55 offen lds
    v_lshlrev_b32 v13, 7, v13
    v_and_b32 v14, 7, v1
    v_lshl_add_u32 v13, v14, 4, v13
    v_lshl_add_u32 v7, v12, 14, v13
    v_xor_b32 v12, 1, v12
    v_lshl_or_b32 v27, v12, 31, v7
    s_mul_i32 s1, s63, 2162688
    s_lshl_b32 s74, s58, 14
    s_add_u32 s1, s1, s74
    s_lshl_b32 s74, s62, 2
    s_add_u32 s74, s74, s3
    s_lshl_b32 s74, s74, 10
    s_add_u32 s1, s1, s74
    s_add_u32 s1, s1, 7585792
    s_add_u32 m0, s57, 18432
    s_nop 0
    buffer_load_dwordx4 v4, s[8:11], s55 offen lds
    s_add_u32 m0, s57, 14336
    s_mov_b64 exec, s[4:5]
    buffer_load_dwordx4 v3, s[8:11], s55 offen lds
    s_mov_b64 exec, -1
    s_add_u32 m0, s56, 0
    s_add_u32 s53, s53, 86016
    s_cmp_ge_u32 s53, 1204224
    s_cselect_b32 s53, 0, s53
    buffer_load_dwordx4 v2, s[12:15], s53 offen lds
    s_add_u32 m0, s56, 4096
    s_add_u32 s54, s53, 10752
    buffer_load_dwordx4 v2, s[12:15], s54 offen lds
    s_waitcnt lgkmcnt(0)
    s_mul_i32 s45, s45, 0x2c9277b5
    s_mul_i32 s44, s44, 0x9e3779b1
    s_add_u32 s45, s45, 0x5bd1e995
    s_add_u32 s44, s44, 0x7f4a7c15
    s_waitcnt vmcnt(11)
    s_barrier
    ds_read_b128 a[152:155], v8 offset:0
    ds_read_b64_tr_b16 a[180:181], v31 offset:0
    ds_read_b64_tr_b16 a[182:183], v31 offset:4096
    ds_read_b64_tr_b16 a[184:185], v33 offset:0
    ds_read_b64_tr_b16 a[186:187], v33 offset:4096
    ds_read_b64_tr_b16 a[188:189], v31 offset:8192
    ds_read_b64_tr_b16 a[190:191], v31 offset:12288
    ds_read_b64_tr_b16 a[192:193], v33 offset:8192
    ds_read_b64_tr_b16 a[194:195], v33 offset:12288
    ds_read_b64_tr_b16 a[196:197], v31 offset:16384
    ds_read_b64_tr_b16 a[198:199], v31 offset:20480
    ds_read_b64_tr_b16 a[200:201], v33 offset:16384
    ds_read_b64_tr_b16 a[202:203], v33 offset:20480
    ds_read_b128 a[156:159], v8 offset:2048
    ds_read_b128 a[160:163], v8 offset:4096
    ds_read_b128 a[164:167], v8 offset:6144
    ds_read_b128 a[168:171], v8 offset:8192
    ds_read_b128 a[172:175], v8 offset:10240
    ds_read_b128 a[176:179], v8 offset:12288
    s_cmp_lg_u32 s3, 0
    s_cbranch_scc1 L_flag_39
    v_cmp_eq_u32 vcc, 0, v1
    v_bfrev_b32 v17, 1
    v_mov_b32 v18, s44
    v_mov_b32 v19, s45
    v_cndmask_b32 v17, v17, 0, vcc
    s_mul_i32 s65, s65, 32
    s_add_u32 s65, s65, 4096
    buffer_store_dwordx2 v[18:19], v17, s[40:43], s65 offen sc1
L_flag_39:
    s_add_u32 m0, s56, 7296
    s_nop 0
    buffer_load_dwordx4 v2, s[12:15], s53 offen offset:896 lds
    s_add_u32 m0, s56, 11392
    s_nop 0
    buffer_load_dwordx4 v2, s[12:15], s54 offen offset:896 lds
    s_add_u32 m0, s56, 14592
    s_nop 0
    buffer_load_dwordx4 v2, s[12:15], s53 offen offset:1792 lds
    s_add_u32 m0, s56, 18688
    s_nop 0
    buffer_load_dwordx4 v2, s[12:15], s54 offen offset:1792 lds
    s_waitcnt vmcnt(9)
    s_waitcnt lgkmcnt(0)
    s_barrier
    v_mfma_f32_16x16x32_bf16 v[40:43], a[180:183], a[152:155], 0
    s_add_u32 m0, s56, 24576
    s_add_u32 s53, s53, 86016
    ds_read_b128 a[204:207], v9 offset:0
    v_mfma_f32_16x16x32_bf16 v[44:47], a[184:187], a[152:155], 0
    buffer_load_dwordx4 v2, s[12:15], s53 offen lds
    v_mfma_f32_16x16x32_bf16 v[96:99], a[188:191], a[152:155], 0
    ds_read_b64_tr_b16 a[232:233], v31 offset:24576
    v_mfma_f32_16x16x32_bf16 v[100:103], a[192:195], a[152:155], 0
    ds_read_b64_tr_b16 a[234:235], v31 offset:28672
    v_mfma_f32_16x16x32_bf16 v[156:159], a[152:155], a[196:199], 0
    s_add_u32 m0, s56, 28672
    s_add_u32 s54, s53, 10752
    ds_read_b64_tr_b16 a[236:237], v33 offset:24576
    v_mfma_f32_16x16x32_bf16 v[188:191], a[152:155], a[200:203], 0
    buffer_load_dwordx4 v2, s[12:15], s54 offen lds
    v_mfma_f32_16x16x32_bf16 v[48:51], a[180:183], a[156:159], 0
    ds_read_b64_tr_b16 a[238:239], v33 offset:28672
    v_mfma_f32_16x16x32_bf16 v[52:55], a[184:187], a[156:159], 0
    ds_read_b64_tr_b16 a[240:241], v31 offset:32768
    v_mfma_f32_16x16x32_bf16 v[104:107], a[188:191], a[156:159], 0
    s_add_u32 m0, s56, 31872
    ds_read_b64_tr_b16 a[242:243], v31 offset:36864
    v_mfma_f32_16x16x32_bf16 v[108:111], a[192:195], a[156:159], 0
    buffer_load_dwordx4 v2, s[12:15], s53 offen offset:896 lds
    v_mfma_f32_16x16x32_bf16 v[160:163], a[156:159], a[196:199], 0
    ds_read_b64_tr_b16 a[244:245], v33 offset:32768
    v_mfma_f32_16x16x32_bf16 v[192:195], a[156:159], a[200:203], 0
    ds_read_b64_tr_b16 a[246:247], v33 offset:36864
    v_mfma_f32_16x16x32_bf16 v[56:59], a[180:183], a[160:163], 0
    ds_read_b64_tr_b16 a[248:249], v31 offset:40960
    v_mfma_f32_16x16x32_bf16 v[60:63], a[184:187], a[160:163], 0
    s_add_u32 m0, s56, 35968
    ds_read_b64_tr_b16 a[250:251], v31 offset:45056
    v_mfma_f32_16x16x32_bf16 v[112:115], a[188:191], a[160:163], 0
    buffer_load_dwordx4 v2, s[12:15], s54 offen offset:896 lds
    v_mfma_f32_16x16x32_bf16 v[116:119], a[192:195], a[160:163], 0
    ds_read_b64_tr_b16 a[252:253], v33 offset:40960
    v_mfma_f32_16x16x32_bf16 v[164:167], a[160:163], a[196:199], 0
    ds_read_b64_tr_b16 a[254:255], v33 offset:45056
    v_mfma_f32_16x16x32_bf16 v[196:199], a[160:163], a[200:203], 0
    s_add_u32 m0, s56, 39168
    ds_read_b128 a[208:211], v9 offset:2048
    v_mfma_f32_16x16x32_bf16 v[64:67], a[180:183], a[164:167], 0
    buffer_load_dwordx4 v2, s[12:15], s53 offen offset:1792 lds
    v_mfma_f32_16x16x32_bf16 v[68:71], a[184:187], a[164:167], 0
    ds_read_b128 a[212:215], v9 offset:4096
    v_mfma_f32_16x16x32_bf16 v[120:123], a[188:191], a[164:167], 0
    ds_read_b128 a[216:219], v9 offset:6144
    v_mfma_f32_16x16x32_bf16 v[124:127], a[192:195], a[164:167], 0
    ds_read_b128 a[220:223], v9 offset:8192
    v_mfma_f32_16x16x32_bf16 v[168:171], a[164:167], a[196:199], 0
    s_add_u32 m0, s56, 43264
    ds_read_b128 a[224:227], v9 offset:10240
    v_mfma_f32_16x16x32_bf16 v[200:203], a[164:167], a[200:203], 0
    buffer_load_dwordx4 v2, s[12:15], s54 offen offset:1792 lds
    v_mfma_f32_16x16x32_bf16 v[72:75], a[180:183], a[168:171], 0
    ds_read_b128 a[228:231], v9 offset:12288
    v_mfma_f32_16x16x32_bf16 v[76:79], a[184:187], a[168:171], 0
    v_mfma_f32_16x16x32_bf16 v[128:131], a[188:191], a[168:171], 0
    s_add_u32 m0, s57, 40960
    s_add_u32 s55, s55, 128
    s_cmp_ge_u32 s55, 896
    s_cselect_b32 s55, 0, s55
    v_mfma_f32_16x16x32_bf16 v[132:135], a[192:195], a[168:171], 0
    s_cmp_ge_u32 s3, 2
    s_cbranch_scc1 L_xs_40
    buffer_load_dwordx4 v6, s[8:11], s55 offen lds
L_xs_40:
    v_mfma_f32_16x16x32_bf16 v[172:175], a[168:171], a[196:199], 0
    v_mfma_f32_16x16x32_bf16 v[204:207], a[168:171], a[200:203], 0
    v_mfma_f32_16x16x32_bf16 v[80:83], a[180:183], a[172:175], 0
    v_mfma_f32_16x16x32_bf16 v[84:87], a[184:187], a[172:175], 0
    s_add_u32 m0, s57, 36864
    v_mfma_f32_16x16x32_bf16 v[136:139], a[188:191], a[172:175], 0
    buffer_load_dwordx4 v5, s[8:11], s55 offen lds
    v_mfma_f32_16x16x32_bf16 v[140:143], a[192:195], a[172:175], 0
    v_mfma_f32_16x16x32_bf16 v[176:179], a[172:175], a[196:199], 0
    v_mfma_f32_16x16x32_bf16 v[208:211], a[172:175], a[200:203], 0
    s_add_u32 m0, s57, 32768
    v_mfma_f32_16x16x32_bf16 v[88:91], a[180:183], a[176:179], 0
    buffer_load_dwordx4 v4, s[8:11], s55 offen lds
    v_mfma_f32_16x16x32_bf16 v[92:95], a[184:187], a[176:179], 0
    v_mfma_f32_16x16x32_bf16 v[144:147], a[188:191], a[176:179], 0
    v_mfma_f32_16x16x32_bf16 v[148:151], a[192:195], a[176:179], 0
    v_mfma_f32_16x16x32_bf16 v[180:183], a[176:179], a[196:199], 0
    v_mfma_f32_16x16x32_bf16 v[212:215], a[176:179], a[200:203], 0
    s_waitcnt vmcnt(8)
    s_waitcnt lgkmcnt(0)
    s_barrier
    v_mfma_f32_16x16x32_bf16 v[40:43], a[232:235], a[204:207], v[40:43]
    s_add_u32 m0, s57, 28672
    ds_read_b128 a[152:155], v8 offset:14336
    v_mfma_f32_16x16x32_bf16 v[44:47], a[236:239], a[204:207], v[44:47]
    s_mov_b64 exec, s[4:5]
    buffer_load_dwordx4 v3, s[8:11], s55 offen lds
    s_mov_b64 exec, -1
    v_mfma_f32_16x16x32_bf16 v[96:99], a[240:243], a[204:207], v[96:99]
    ds_read_b64_tr_b16 a[180:181], v30 offset:0
    v_mfma_f32_16x16x32_bf16 v[100:103], a[244:247], a[204:207], v[100:103]
    ds_read_b64_tr_b16 a[182:183], v30 offset:4096
    v_mfma_f32_16x16x32_bf16 v[156:159], a[204:207], a[248:251], v[156:159]
    s_add_u32 m0, s56, 49152
    s_add_u32 s53, s53, 86016
    s_cmp_ge_u32 s53, 1204224
    s_cselect_b32 s53, 0, s53
    v_mfma_f32_16x16x32_bf16 v[188:191], a[204:207], a[252:255], v[188:191]
    buffer_load_dwordx4 v2, s[12:15], s53 offen lds
    v_mfma_f32_16x16x32_bf16 v[48:51], a[232:235], a[208:211], v[48:51]
    ds_read_b64_tr_b16 a[184:185], v32 offset:0
    v_mfma_f32_16x16x32_bf16 v[52:55], a[236:239], a[208:211], v[52:55]
    ds_read_b64_tr_b16 a[186:187], v32 offset:4096
    v_mfma_f32_16x16x32_bf16 v[104:107], a[240:243], a[208:211], v[104:107]
    s_add_u32 m0, s56, 53248
    s_add_u32 s54, s53, 10752
    ds_read_b64_tr_b16 a[188:189], v30 offset:8192
    v_mfma_f32_16x16x32_bf16 v[108:111], a[244:247], a[208:211], v[108:111]
    buffer_load_dwordx4 v2, s[12:15], s54 offen lds
    v_mfma_f32_16x16x32_bf16 v[160:163], a[208:211], a[248:251], v[160:163]
    ds_read_b64_tr_b16 a[190:191], v30 offset:12288
    v_mfma_f32_16x16x32_bf16 v[192:195], a[208:211], a[252:255], v[192:195]
    ds_read_b64_tr_b16 a[192:193], v32 offset:8192
    v_mfma_f32_16x16x32_bf16 v[56:59], a[232:235], a[212:215], v[56:59]
    ds_read_b64_tr_b16 a[194:195], v32 offset:12288
    v_mfma_f32_16x16x32_bf16 v[60:63], a[236:239], a[212:215], v[60:63]
    s_add_u32 m0, s56, 56448
    ds_read_b64_tr_b16 a[196:197], v30 offset:16384
    v_mfma_f32_16x16x32_bf16 v[112:115], a[240:243], a[212:215], v[112:115]
    buffer_load_dwordx4 v2, s[12:15], s53 offen offset:896 lds
    v_mfma_f32_16x16x32_bf16 v[116:119], a[244:247], a[212:215], v[116:119]
    ds_read_b64_tr_b16 a[198:199], v30 offset:20480
    v_mfma_f32_16x16x32_bf16 v[164:167], a[212:215], a[248:251], v[164:167]
    ds_read_b64_tr_b16 a[200:201], v32 offset:16384
    v_mfma_f32_16x16x32_bf16 v[196:199], a[212:215], a[252:255], v[196:199]
    s_add_u32 m0, s56, 60544
    ds_read_b64_tr_b16 a[202:203], v32 offset:20480
    v_mfma_f32_16x16x32_bf16 v[64:67], a[232:235], a[216:219], v[64:67]
    buffer_load_dwordx4 v2, s[12:15], s54 offen offset:896 lds
    v_mfma_f32_16x16x32_bf16 v[68:71], a[236:239], a[216:219], v[68:71]
    ds_read_b128 a[156:159], v8 offset:16384
    v_mfma_f32_16x16x32_bf16 v[120:123], a[240:243], a[216:219], v[120:123]
    ds_read_b128 a[160:163], v8 offset:18432
    v_mfma_f32_16x16x32_bf16 v[124:127], a[244:247], a[216:219], v[124:127]
    ds_read_b128 a[164:167], v8 offset:20480
    v_mfma_f32_16x16x32_bf16 v[168:171], a[216:219], a[248:251], v[168:171]
    s_add_u32 m0, s56, 63744
    ds_read_b128 a[168:171], v8 offset:22528
    v_mfma_f32_16x16x32_bf16 v[200:203], a[216:219], a[252:255], v[200:203]
    buffer_load_dwordx4 v2, s[12:15], s53 offen offset:1792 lds
    v_mfma_f32_16x16x32_bf16 v[72:75], a[232:235], a[220:223], v[72:75]
    ds_read_b128 a[172:175], v8 offset:24576
    v_mfma_f32_16x16x32_bf16 v[76:79], a[236:239], a[220:223], v[76:79]
    ds_read_b128 a[176:179], v8 offset:26624
    v_mfma_f32_16x16x32_bf16 v[128:131], a[240:243], a[220:223], v[128:131]
    s_add_u32 m0, s56, 67840
    v_mfma_f32_16x16x32_bf16 v[132:135], a[244:247], a[220:223], v[132:135]
    buffer_load_dwordx4 v2, s[12:15], s54 offen offset:1792 lds
    v_mfma_f32_16x16x32_bf16 v[172:175], a[220:223], a[248:251], v[172:175]
    v_mfma_f32_16x16x32_bf16 v[204:207], a[220:223], a[252:255], v[204:207]
    v_mfma_f32_16x16x32_bf16 v[80:83], a[232:235], a[224:227], v[80:83]
    v_mfma_f32_16x16x32_bf16 v[84:87], a[236:239], a[224:227], v[84:87]
    s_add_u32 m0, s56, 73728
    s_add_u32 s53, s53, 86016
    v_mfma_f32_16x16x32_bf16 v[136:139], a[240:243], a[224:227], v[136:139]
    buffer_load_dwordx4 v2, s[12:15], s53 offen lds
    v_mfma_f32_16x16x32_bf16 v[140:143], a[244:247], a[224:227], v[140:143]
    v_mfma_f32_16x16x32_bf16 v[176:179], a[224:227], a[248:251], v[176:179]
    v_mfma_f32_16x16x32_bf16 v[208:211], a[224:227], a[252:255], v[208:211]
    s_add_u32 m0, s56, 77824
    s_add_u32 s54, s53, 10752
    v_mfma_f32_16x16x32_bf16 v[88:91], a[232:235], a[228:231], v[88:91]
    buffer_load_dwordx4 v2, s[12:15], s54 offen lds
    v_mfma_f32_16x16x32_bf16 v[92:95], a[236:239], a[228:231], v[92:95]
    v_mfma_f32_16x16x32_bf16 v[144:147], a[240:243], a[228:231], v[144:147]
    v_mfma_f32_16x16x32_bf16 v[148:151], a[244:247], a[228:231], v[148:151]
    v_mfma_f32_16x16x32_bf16 v[180:183], a[228:231], a[248:251], v[180:183]
    v_mfma_f32_16x16x32_bf16 v[212:215], a[228:231], a[252:255], v[212:215]
    s_waitcnt vmcnt(11)
    s_waitcnt lgkmcnt(0)
    s_barrier
    v_mfma_f32_16x16x32_bf16 v[40:43], a[180:183], a[152:155], v[40:43]
    s_add_u32 m0, s56, 81024
    ds_read_b128 a[204:207], v9 offset:14336
    v_mfma_f32_16x16x32_bf16 v[44:47], a[184:187], a[152:155], v[44:47]
    buffer_load_dwordx4 v2, s[12:15], s53 offen offset:896 lds
    v_mfma_f32_16x16x32_bf16 v[96:99], a[188:191], a[152:155], v[96:99]
    ds_read_b64_tr_b16 a[232:233], v30 offset:24576
    v_mfma_f32_16x16x32_bf16 v[100:103], a[192:195], a[152:155], v[100:103]
    ds_read_b64_tr_b16 a[234:235], v30 offset:28672
    v_mfma_f32_16x16x32_bf16 v[156:159], a[152:155], a[196:199], v[156:159]
    s_add_u32 m0, s56, 85120
    ds_read_b64_tr_b16 a[236:237], v32 offset:24576
    v_mfma_f32_16x16x32_bf16 v[188:191], a[152:155], a[200:203], v[188:191]
    buffer_load_dwordx4 v2, s[12:15], s54 offen offset:896 lds
    v_mfma_f32_16x16x32_bf16 v[48:51], a[180:183], a[156:159], v[48:51]
    ds_read_b64_tr_b16 a[238:239], v32 offset:28672
    v_mfma_f32_16x16x32_bf16 v[52:55], a[184:187], a[156:159], v[52:55]
    ds_read_b64_tr_b16 a[240:241], v30 offset:32768
    v_mfma_f32_16x16x32_bf16 v[104:107], a[188:191], a[156:159], v[104:107]
    s_add_u32 m0, s56, 88320
    ds_read_b64_tr_b16 a[242:243], v30 offset:36864
    v_mfma_f32_16x16x32_bf16 v[108:111], a[192:195], a[156:159], v[108:111]
    buffer_load_dwordx4 v2, s[12:15], s53 offen offset:1792 lds
    v_mfma_f32_16x16x32_bf16 v[160:163], a[156:159], a[196:199], v[160:163]
    ds_read_b64_tr_b16 a[244:245], v32 offset:32768
    v_mfma_f32_16x16x32_bf16 v[192:195], a[156:159], a[200:203], v[192:195]
    ds_read_b64_tr_b16 a[246:247], v32 offset:36864
    v_mfma_f32_16x16x32_bf16 v[56:59], a[180:183], a[160:163], v[56:59]
    ds_read_b64_tr_b16 a[248:249], v30 offset:40960
    v_mfma_f32_16x16x32_bf16 v[60:63], a[184:187], a[160:163], v[60:63]
    s_add_u32 m0, s56, 92416
    ds_read_b64_tr_b16 a[250:251], v30 offset:45056
    v_mfma_f32_16x16x32_bf16 v[112:115], a[188:191], a[160:163], v[112:115]
    buffer_load_dwordx4 v2, s[12:15], s54 offen offset:1792 lds
    v_mfma_f32_16x16x32_bf16 v[116:119], a[192:195], a[160:163], v[116:119]
    ds_read_b64_tr_b16 a[252:253], v32 offset:40960
    v_mfma_f32_16x16x32_bf16 v[164:167], a[160:163], a[196:199], v[164:167]
    ds_read_b64_tr_b16 a[254:255], v32 offset:45056
    v_mfma_f32_16x16x32_bf16 v[196:199], a[160:163], a[200:203], v[196:199]
    s_add_u32 m0, s57, 12288
    s_add_u32 s55, s55, 128
    s_cmp_ge_u32 s55, 896
    s_cselect_b32 s55, 0, s55
    v_mfma_f32_16x16x32_bf16 v[64:67], a[180:183], a[164:167], v[64:67]
    s_cmp_ge_u32 s3, 2
    s_cbranch_scc1 L_xs_41
    buffer_load_dwordx4 v6, s[8:11], s55 offen lds
L_xs_41:
    v_mfma_f32_16x16x32_bf16 v[68:71], a[184:187], a[164:167], v[68:71]
    ds_read_b128 a[208:211], v9 offset:16384
    v_mfma_f32_16x16x32_bf16 v[120:123], a[188:191], a[164:167], v[120:123]
    ds_read_b128 a[212:215], v9 offset:18432
    v_mfma_f32_16x16x32_bf16 v[124:127], a[192:195], a[164:167], v[124:127]
    ds_read_b128 a[216:219], v9 offset:20480
    v_mfma_f32_16x16x32_bf16 v[168:171], a[164:167], a[196:199], v[168:171]
    s_add_u32 m0, s57, 8192
    ds_read_b128 a[220:223], v9 offset:22528
    v_mfma_f32_16x16x32_bf16 v[200:203], a[164:167], a[200:203], v[200:203]
    buffer_load_dwordx4 v5, s[8:11], s55 offen lds
    v_mfma_f32_16x16x32_bf16 v[72:75], a[180:183], a[168:171], v[72:75]
    ds_read_b128 a[224:227], v9 offset:24576
    v_mfma_f32_16x16x32_bf16 v[76:79], a[184:187], a[168:171], v[76:79]
    ds_read_b128 a[228:231], v9 offset:26624
    v_mfma_f32_16x16x32_bf16 v[128:131], a[188:191], a[168:171], v[128:131]
    s_add_u32 m0, s57, 4096
    v_mfma_f32_16x16x32_bf16 v[132:135], a[192:195], a[168:171], v[132:135]
    buffer_load_dwordx4 v4, s[8:11], s55 offen lds
    v_mfma_f32_16x16x32_bf16 v[172:175], a[168:171], a[196:199], v[172:175]
    v_mfma_f32_16x16x32_bf16 v[204:207], a[168:171], a[200:203], v[204:207]
    v_mfma_f32_16x16x32_bf16 v[80:83], a[180:183], a[172:175], v[80:83]
    v_mfma_f32_16x16x32_bf16 v[84:87], a[184:187], a[172:175], v[84:87]
    s_add_u32 m0, s57, 0
    v_mfma_f32_16x16x32_bf16 v[136:139], a[188:191], a[172:175], v[136:139]
    s_mov_b64 exec, s[4:5]
    buffer_load_dwordx4 v3, s[8:11], s55 offen lds
    s_mov_b64 exec, -1
    v_mfma_f32_16x16x32_bf16 v[140:143], a[192:195], a[172:175], v[140:143]
    v_mfma_f32_16x16x32_bf16 v[176:179], a[172:175], a[196:199], v[176:179]
    v_mfma_f32_16x16x32_bf16 v[208:211], a[172:175], a[200:203], v[208:211]
    s_add_u32 m0, s56, 0
    s_add_u32 s53, s53, 86016
    s_cmp_ge_u32 s53, 1204224
    s_cselect_b32 s53, 0, s53
    v_mfma_f32_16x16x32_bf16 v[88:91], a[180:183], a[176:179], v[88:91]
    buffer_load_dwordx4 v2, s[12:15], s53 offen lds
    v_mfma_f32_16x16x32_bf16 v[92:95], a[184:187], a[176:179], v[92:95]
    v_mfma_f32_16x16x32_bf16 v[144:147], a[188:191], a[176:179], v[144:147]
    v_mfma_f32_16x16x32_bf16 v[148:151], a[192:195], a[176:179], v[148:151]
    v_mfma_f32_16x16x32_bf16 v[180:183], a[176:179], a[196:199], v[180:183]
    v_mfma_f32_16x16x32_bf16 v[212:215], a[176:179], a[200:203], v[212:215]
    s_waitcnt vmcnt(10)
    s_waitcnt lgkmcnt(0)
    s_barrier
    v_mfma_f32_16x16x32_bf16 v[40:43], a[232:235], a[204:207], v[40:43]
    s_add_u32 m0, s56, 4096
    s_add_u32 s54, s53, 10752
    ds_read_b128 a[152:155], v8 offset:28672
    v_mfma_f32_16x16x32_bf16 v[44:47], a[236:239], a[204:207], v[44:47]
    buffer_load_dwordx4 v2, s[12:15], s54 offen lds
    v_mfma_f32_16x16x32_bf16 v[96:99], a[240:243], a[204:207], v[96:99]
    ds_read_b64_tr_b16 a[180:181], v31 offset:0
    v_mfma_f32_16x16x32_bf16 v[100:103], a[244:247], a[204:207], v[100:103]
    ds_read_b64_tr_b16 a[182:183], v31 offset:4096
    v_mfma_f32_16x16x32_bf16 v[156:159], a[204:207], a[248:251], v[156:159]
L_pad_12:
    s_cbranch_execz L_ret
    s_add_u32 m0, s56, 7296
    ds_read_b64_tr_b16 a[184:185], v33 offset:0
    v_mfma_f32_16x16x32_bf16 v[188:191], a[204:207], a[252:255], v[188:191]
    buffer_load_dwordx4 v2, s[12:15], s53 offen offset:896 lds
    v_mfma_f32_16x16x32_bf16 v[48:51], a[232:235], a[208:211], v[48:51]
    ds_read_b64_tr_b16 a[186:187], v33 offset:4096
    v_mfma_f32_16x16x32_bf16 v[52:55], a[236:239], a[208:211], v[52:55]
    ds_read_b64_tr_b16 a[188:189], v31 offset:8192
    v_mfma_f32_16x16x32_bf16 v[104:107], a[240:243], a[208:211], v[104:107]
    s_add_u32 m0, s56, 11392
    ds_read_b64_tr_b16 a[190:191], v31 offset:12288
    v_mfma_f32_16x16x32_bf16 v[108:111], a[244:247], a[208:211], v[108:111]
    buffer_load_dwordx4 v2, s[12:15], s54 offen offset:896 lds
    v_mfma_f32_16x16x32_bf16 v[160:163], a[208:211], a[248:251], v[160:163]
    ds_read_b64_tr_b16 a[192:193], v33 offset:8192
    v_mfma_f32_16x16x32_bf16 v[192:195], a[208:211], a[252:255], v[192:195]
    ds_read_b64_tr_b16 a[194:195], v33 offset:12288
    v_mfma_f32_16x16x32_bf16 v[56:59], a[232:235], a[212:215], v[56:59]
    ds_read_b64_tr_b16 a[196:197], v31 offset:16384
    v_mfma_f32_16x16x32_bf16 v[60:63], a[236:239], a[212:215], v[60:63]
    s_add_u32 m0, s56, 14592
    ds_read_b64_tr_b16 a[198:199], v31 offset:20480
    v_mfma_f32_16x16x32_bf16 v[112:115], a[240:243], a[212:215], v[112:115]
    buffer_load_dwordx4 v2, s[12:15], s53 offen offset:1792 lds
    v_mfma_f32_16x16x32_bf16 v[116:119], a[244:247], a[212:215], v[116:119]
    ds_read_b64_tr_b16 a[200:201], v33 offset:16384
    v_mfma_f32_16x16x32_bf16 v[164:167], a[212:215], a[248:251], v[164:167]
    ds_read_b64_tr_b16 a[202:203], v33 offset:20480
    v_mfma_f32_16x16x32_bf16 v[196:199], a[212:215], a[252:255], v[196:199]
    s_add_u32 m0, s56, 18688
    ds_read_b128 a[156:159], v8 offset:30720
    v_mfma_f32_16x16x32_bf16 v[64:67], a[232:235], a[216:219], v[64:67]
    buffer_load_dwordx4 v2, s[12:15], s54 offen offset:1792 lds
    v_mfma_f32_16x16x32_bf16 v[68:71], a[236:239], a[216:219], v[68:71]
    ds_read_b128 a[160:163], v8 offset:32768
    v_mfma_f32_16x16x32_bf16 v[120:123], a[240:243], a[216:219], v[120:123]
    ds_read_b128 a[164:167], v8 offset:34816
    v_mfma_f32_16x16x32_bf16 v[124:127], a[244:247], a[216:219], v[124:127]
    ds_read_b128 a[168:171], v8 offset:36864
    v_mfma_f32_16x16x32_bf16 v[168:171], a[216:219], a[248:251], v[168:171]
    s_add_u32 m0, s56, 24576
    s_add_u32 s53, s53, 86016
    ds_read_b128 a[172:175], v8 offset:38912
    v_mfma_f32_16x16x32_bf16 v[200:203], a[216:219], a[252:255], v[200:203]
    buffer_load_dwordx4 v2, s[12:15], s53 offen lds
    v_mfma_f32_16x16x32_bf16 v[72:75], a[232:235], a[220:223], v[72:75]
    ds_read_b128 a[176:179], v8 offset:40960
    v_mfma_f32_16x16x32_bf16 v[76:79], a[236:239], a[220:223], v[76:79]
    v_mfma_f32_16x16x32_bf16 v[128:131], a[240:243], a[220:223], v[128:131]
    s_add_u32 m0, s56, 28672
    s_add_u32 s54, s53, 10752
    v_mfma_f32_16x16x32_bf16 v[132:135], a[244:247], a[220:223], v[132:135]
    buffer_load_dwordx4 v2, s[12:15], s54 offen lds
    v_mfma_f32_16x16x32_bf16 v[172:175], a[220:223], a[248:251], v[172:175]
    v_mfma_f32_16x16x32_bf16 v[204:207], a[220:223], a[252:255], v[204:207]
    v_mfma_f32_16x16x32_bf16 v[80:83], a[232:235], a[224:227], v[80:83]
    v_mfma_f32_16x16x32_bf16 v[84:87], a[236:239], a[224:227], v[84:87]
    s_add_u32 m0, s56, 31872
    v_mfma_f32_16x16x32_bf16 v[136:139], a[240:243], a[224:227], v[136:139]
    buffer_load_dwordx4 v2, s[12:15], s53 offen offset:896 lds
    v_mfma_f32_16x16x32_bf16 v[140:143], a[244:247], a[224:227], v[140:143]
    v_mfma_f32_16x16x32_bf16 v[176:179], a[224:227], a[248:251], v[176:179]
    v_mfma_f32_16x16x32_bf16 v[208:211], a[224:227], a[252:255], v[208:211]
    s_add_u32 m0, s56, 35968
    v_mfma_f32_16x16x32_bf16 v[88:91], a[232:235], a[228:231], v[88:91]
    buffer_load_dwordx4 v2, s[12:15], s54 offen offset:896 lds
    v_mfma_f32_16x16x32_bf16 v[92:95], a[236:239], a[228:231], v[92:95]
    v_mfma_f32_16x16x32_bf16 v[144:147], a[240:243], a[228:231], v[144:147]
    v_mfma_f32_16x16x32_bf16 v[148:151], a[244:247], a[228:231], v[148:151]
    v_mfma_f32_16x16x32_bf16 v[180:183], a[228:231], a[248:251], v[180:183]
    v_mfma_f32_16x16x32_bf16 v[212:215], a[228:231], a[252:255], v[212:215]
    s_waitcnt vmcnt(13)
    s_waitcnt lgkmcnt(0)
    s_barrier
    v_mfma_f32_16x16x32_bf16 v[40:43], a[180:183], a[152:155], v[40:43]
    s_add_u32 m0, s56, 39168
    ds_read_b128 a[204:207], v9 offset:28672
    v_mfma_f32_16x16x32_bf16 v[44:47], a[184:187], a[152:155], v[44:47]
    buffer_load_dwordx4 v2, s[12:15], s53 offen offset:1792 lds
    v_mfma_f32_16x16x32_bf16 v[96:99], a[188:191], a[152:155], v[96:99]
    ds_read_b64_tr_b16 a[232:233], v31 offset:24576
    v_mfma_f32_16x16x32_bf16 v[100:103], a[192:195], a[152:155], v[100:103]
    ds_read_b64_tr_b16 a[234:235], v31 offset:28672
    v_mfma_f32_16x16x32_bf16 v[156:159], a[152:155], a[196:199], v[156:159]
    s_add_u32 m0, s56, 43264
    ds_read_b64_tr_b16 a[236:237], v33 offset:24576
    v_mfma_f32_16x16x32_bf16 v[188:191], a[152:155], a[200:203], v[188:191]
    buffer_load_dwordx4 v2, s[12:15], s54 offen offset:1792 lds
    v_mfma_f32_16x16x32_bf16 v[48:51], a[180:183], a[156:159], v[48:51]
    ds_read_b64_tr_b16 a[238:239], v33 offset:28672
    v_mfma_f32_16x16x32_bf16 v[52:55], a[184:187], a[156:159], v[52:55]
    ds_read_b64_tr_b16 a[240:241], v31 offset:32768
    v_mfma_f32_16x16x32_bf16 v[104:107], a[188:191], a[156:159], v[104:107]
    s_add_u32 m0, s57, 26624
    s_add_u32 s55, s55, 128
    s_cmp_ge_u32 s55, 896
    s_cselect_b32 s55, 0, s55
    v_mfma_f32_16x16x32_bf16 v[108:111], a[192:195], a[156:159], v[108:111]
    s_cmp_ge_u32 s3, 2
    s_cbranch_scc1 L_xs_42
    buffer_load_dwordx4 v6, s[8:11], s55 offen lds
L_xs_42:
    v_mfma_f32_16x16x32_bf16 v[160:163], a[156:159], a[196:199], v[160:163]
    ds_read_b64_tr_b16 a[242:243], v31 offset:36864
    v_mfma_f32_16x16x32_bf16 v[192:195], a[156:159], a[200:203], v[192:195]
    ds_read_b64_tr_b16 a[244:245], v33 offset:32768
    v_mfma_f32_16x16x32_bf16 v[56:59], a[180:183], a[160:163], v[56:59]
    ds_read_b64_tr_b16 a[246:247], v33 offset:36864
    v_mfma_f32_16x16x32_bf16 v[60:63], a[184:187], a[160:163], v[60:63]
    s_add_u32 m0, s57, 22528
    ds_read_b64_tr_b16 a[248:249], v31 offset:40960
    v_mfma_f32_16x16x32_bf16 v[112:115], a[188:191], a[160:163], v[112:115]
    buffer_load_dwordx4 v5, s[8:11], s55 offen lds
    v_mfma_f32_16x16x32_bf16 v[116:119], a[192:195], a[160:163], v[116:119]
    ds_read_b64_tr_b16 a[250:251], v31 offset:45056
    v_mfma_f32_16x16x32_bf16 v[164:167], a[160:163], a[196:199], v[164:167]
    ds_read_b64_tr_b16 a[252:253], v33 offset:40960
    v_mfma_f32_16x16x32_bf16 v[196:199], a[160:163], a[200:203], v[196:199]
    s_add_u32 m0, s57, 18432
    ds_read_b64_tr_b16 a[254:255], v33 offset:45056
    v_mfma_f32_16x16x32_bf16 v[64:67], a[180:183], a[164:167], v[64:67]
    buffer_load_dwordx4 v4, s[8:11], s55 offen lds
    v_mfma_f32_16x16x32_bf16 v[68:71], a[184:187], a[164:167], v[68:71]
    ds_read_b128 a[208:211], v9 offset:30720
    v_mfma_f32_16x16x32_bf16 v[120:123], a[188:191], a[164:167], v[120:123]
    ds_read_b128 a[212:215], v9 offset:32768
    v_mfma_f32_16x16x32_bf16 v[124:127], a[192:195], a[164:167], v[124:127]
    ds_read_b128 a[216:219], v9 offset:34816
    v_mfma_f32_16x16x32_bf16 v[168:171], a[164:167], a[196:199], v[168:171]
    s_add_u32 m0, s57, 14336
    ds_read_b128 a[220:223], v9 offset:36864
    v_mfma_f32_16x16x32_bf16 v[200:203], a[164:167], a[200:203], v[200:203]
    s_mov_b64 exec, s[4:5]
    buffer_load_dwordx4 v3, s[8:11], s55 offen lds
    s_mov_b64 exec, -1
    v_mfma_f32_16x16x32_bf16 v[72:75], a[180:183], a[168:171], v[72:75]
    ds_read_b128 a[224:227], v9 offset:38912
    v_mfma_f32_16x16x32_bf16 v[76:79], a[184:187], a[168:171], v[76:79]
    ds_read_b128 a[228:231], v9 offset:40960
    v_mfma_f32_16x16x32_bf16 v[128:131], a[188:191], a[168:171], v[128:131]
    s_add_u32 m0, s56, 49152
    s_add_u32 s53, s53, 86016
    s_cmp_ge_u32 s53, 1204224
    s_cselect_b32 s53, 0, s53
    v_mfma_f32_16x16x32_bf16 v[132:135], a[192:195], a[168:171], v[132:135]
    buffer_load_dwordx4 v2, s[12:15], s53 offen lds
    v_mfma_f32_16x16x32_bf16 v[172:175], a[168:171], a[196:199], v[172:175]
    v_mfma_f32_16x16x32_bf16 v[204:207], a[168:171], a[200:203], v[204:207]
    v_mfma_f32_16x16x32_bf16 v[80:83], a[180:183], a[172:175], v[80:83]
    v_mfma_f32_16x16x32_bf16 v[84:87], a[184:187], a[172:175], v[84:87]
    s_add_u32 m0, s56, 53248
    s_add_u32 s54, s53, 10752
    v_mfma_f32_16x16x32_bf16 v[136:139], a[188:191], a[172:175], v[136:139]
    buffer_load_dwordx4 v2, s[12:15], s54 offen lds
    v_mfma_f32_16x16x32_bf16 v[140:143], a[192:195], a[172:175], v[140:143]
    v_mfma_f32_16x16x32_bf16 v[176:179], a[172:175], a[196:199], v[176:179]
    v_mfma_f32_16x16x32_bf16 v[208:211], a[172:175], a[200:203], v[208:211]
    s_add_u32 m0, s56, 56448
    v_mfma_f32_16x16x32_bf16 v[88:91], a[180:183], a[176:179], v[88:91]
    buffer_load_dwordx4 v2, s[12:15], s53 offen offset:896 lds
    v_mfma_f32_16x16x32_bf16 v[92:95], a[184:187], a[176:179], v[92:95]
    v_mfma_f32_16x16x32_bf16 v[144:147], a[188:191], a[176:179], v[144:147]
    v_mfma_f32_16x16x32_bf16 v[148:151], a[192:195], a[176:179], v[148:151]
    v_mfma_f32_16x16x32_bf16 v[180:183], a[176:179], a[196:199], v[180:183]
    v_mfma_f32_16x16x32_bf16 v[212:215], a[176:179], a[200:203], v[212:215]
    s_waitcnt vmcnt(12)
    s_waitcnt lgkmcnt(0)
    s_barrier
    v_mfma_f32_16x16x32_bf16 v[40:43], a[232:235], a[204:207], v[40:43]
    s_add_u32 m0, s56, 60544
    ds_read_b128 a[152:155], v8 offset:0
    v_mfma_f32_16x16x32_bf16 v[44:47], a[236:239], a[204:207], v[44:47]
    buffer_load_dwordx4 v2, s[12:15], s54 offen offset:896 lds
    v_mfma_f32_16x16x32_bf16 v[96:99], a[240:243], a[204:207], v[96:99]
    ds_read_b64_tr_b16 a[180:181], v30 offset:0
    v_mfma_f32_16x16x32_bf16 v[100:103], a[244:247], a[204:207], v[100:103]
    ds_read_b64_tr_b16 a[182:183], v30 offset:4096
    v_mfma_f32_16x16x32_bf16 v[156:159], a[204:207], a[248:251], v[156:159]
    s_add_u32 m0, s56, 63744
    ds_read_b64_tr_b16 a[184:185], v32 offset:0
    v_mfma_f32_16x16x32_bf16 v[188:191], a[204:207], a[252:255], v[188:191]
    buffer_load_dwordx4 v2, s[12:15], s53 offen offset:1792 lds
    v_mfma_f32_16x16x32_bf16 v[48:51], a[232:235], a[208:211], v[48:51]
    ds_read_b64_tr_b16 a[186:187], v32 offset:4096
    v_mfma_f32_16x16x32_bf16 v[52:55], a[236:239], a[208:211], v[52:55]
    ds_read_b64_tr_b16 a[188:189], v30 offset:8192
    v_mfma_f32_16x16x32_bf16 v[104:107], a[240:243], a[208:211], v[104:107]
    s_add_u32 m0, s56, 67840
    ds_read_b64_tr_b16 a[190:191], v30 offset:12288
    v_mfma_f32_16x16x32_bf16 v[108:111], a[244:247], a[208:211], v[108:111]
    buffer_load_dwordx4 v2, s[12:15], s54 offen offset:1792 lds
    v_mfma_f32_16x16x32_bf16 v[160:163], a[208:211], a[248:251], v[160:163]
    ds_read_b64_tr_b16 a[192:193], v32 offset:8192
    v_mfma_f32_16x16x32_bf16 v[192:195], a[208:211], a[252:255], v[192:195]
    ds_read_b64_tr_b16 a[194:195], v32 offset:12288
    v_mfma_f32_16x16x32_bf16 v[56:59], a[232:235], a[212:215], v[56:59]
    ds_read_b64_tr_b16 a[196:197], v30 offset:16384
    v_mfma_f32_16x16x32_bf16 v[60:63], a[236:239], a[212:215], v[60:63]
    s_add_u32 m0, s56, 73728
    s_add_u32 s53, s53, 86016
    ds_read_b64_tr_b16 a[198:199], v30 offset:20480
    v_mfma_f32_16x16x32_bf16 v[112:115], a[240:243], a[212:215], v[112:115]
    buffer_load_dwordx4 v2, s[12:15], s53 offen lds
    v_mfma_f32_16x16x32_bf16 v[116:119], a[244:247], a[212:215], v[116:119]
    ds_read_b64_tr_b16 a[200:201], v32 offset:16384
    v_mfma_f32_16x16x32_bf16 v[164:167], a[212:215], a[248:251], v[164:167]
    ds_read_b64_tr_b16 a[202:203], v32 offset:20480
    v_mfma_f32_16x16x32_bf16 v[196:199], a[212:215], a[252:255], v[196:199]
    s_add_u32 m0, s56, 77824
    s_add_u32 s54, s53, 10752
    ds_read_b128 a[156:159], v8 offset:2048
    v_mfma_f32_16x16x32_bf16 v[64:67], a[232:235], a[216:219], v[64:67]
    buffer_load_dwordx4 v2, s[12:15], s54 offen lds
    v_mfma_f32_16x16x32_bf16 v[68:71], a[236:239], a[216:219], v[68:71]
    ds_read_b128 a[160:163], v8 offset:4096
    v_mfma_f32_16x16x32_bf16 v[120:123], a[240:243], a[216:219], v[120:123]
    ds_read_b128 a[164:167], v8 offset:6144
    v_mfma_f32_16x16x32_bf16 v[124:127], a[244:247], a[216:219], v[124:127]
    ds_read_b128 a[168:171], v8 offset:8192
    v_mfma_f32_16x16x32_bf16 v[168:171], a[216:219], a[248:251], v[168:171]
    s_add_u32 m0, s56, 81024
    ds_read_b128 a[172:175], v8 offset:10240
    v_mfma_f32_16x16x32_bf16 v[200:203], a[216:219], a[252:255], v[200:203]
    buffer_load_dwordx4 v2, s[12:15], s53 offen offset:896 lds
    v_mfma_f32_16x16x32_bf16 v[72:75], a[232:235], a[220:223], v[72:75]
    ds_read_b128 a[176:179], v8 offset:12288
    v_mfma_f32_16x16x32_bf16 v[76:79], a[236:239], a[220:223], v[76:79]
    v_mfma_f32_16x16x32_bf16 v[128:131], a[240:243], a[220:223], v[128:131]
    s_add_u32 m0, s56, 85120
    v_mfma_f32_16x16x32_bf16 v[132:135], a[244:247], a[220:223], v[132:135]
    buffer_load_dwordx4 v2, s[12:15], s54 offen offset:896 lds
    v_mfma_f32_16x16x32_bf16 v[172:175], a[220:223], a[248:251], v[172:175]
    v_mfma_f32_16x16x32_bf16 v[204:207], a[220:223], a[252:255], v[204:207]
    v_mfma_f32_16x16x32_bf16 v[80:83], a[232:235], a[224:227], v[80:83]
    v_mfma_f32_16x16x32_bf16 v[84:87], a[236:239], a[224:227], v[84:87]
    s_add_u32 m0, s56, 88320
    v_mfma_f32_16x16x32_bf16 v[136:139], a[240:243], a[224:227], v[136:139]
    buffer_load_dwordx4 v2, s[12:15], s53 offen offset:1792 lds
    v_mfma_f32_16x16x32_bf16 v[140:143], a[244:247], a[224:227], v[140:143]
    v_mfma_f32_16x16x32_bf16 v[176:179], a[224:227], a[248:251], v[176:179]
    v_mfma_f32_16x16x32_bf16 v[208:211], a[224:227], a[252:255], v[208:211]
    s_add_u32 m0, s56, 92416
    v_mfma_f32_16x16x32_bf16 v[88:91], a[232:235], a[228:231], v[88:91]
    buffer_load_dwordx4 v2, s[12:15], s54 offen offset:1792 lds
    v_mfma_f32_16x16x32_bf16 v[92:95], a[236:239], a[228:231], v[92:95]
    v_mfma_f32_16x16x32_bf16 v[144:147], a[240:243], a[228:231], v[144:147]
    v_mfma_f32_16x16x32_bf16 v[148:151], a[244:247], a[228:231], v[148:151]
    v_mfma_f32_16x16x32_bf16 v[180:183], a[228:231], a[248:251], v[180:183]
    v_mfma_f32_16x16x32_bf16 v[212:215], a[228:231], a[252:255], v[212:215]
    buffer_load_dwordx2 v[28:29], v24, s[40:43], 0 offen sc1
    s_waitcnt vmcnt(16)
    s_waitcnt lgkmcnt(0)
    s_barrier
    v_mfma_f32_16x16x32_bf16 v[40:43], a[180:183], a[152:155], v[40:43]
    s_add_u32 m0, s57, 40960
    s_add_u32 s55, s55, 128
    s_cmp_ge_u32 s55, 896
    s_cselect_b32 s55, 0, s55
    v_mfma_f32_16x16x32_bf16 v[44:47], a[184:187], a[152:155], v[44:47]
    s_cmp_ge_u32 s3, 2
    s_cbranch_scc1 L_xs_43
    buffer_load_dwordx4 v6, s[8:11], s55 offen lds
L_xs_43:
    v_mfma_f32_16x16x32_bf16 v[96:99], a[188:191], a[152:155], v[96:99]
    ds_read_b128 a[204:207], v9 offset:0
    v_mfma_f32_16x16x32_bf16 v[100:103], a[192:195], a[152:155], v[100:103]
    ds_read_b64_tr_b16 a[232:233], v30 offset:24576
    v_mfma_f32_16x16x32_bf16 v[156:159], a[152:155], a[196:199], v[156:159]
    s_add_u32 m0, s57, 36864
    ds_read_b64_tr_b16 a[234:235], v30 offset:28672
    v_mfma_f32_16x16x32_bf16 v[188:191], a[152:155], a[200:203], v[188:191]
    buffer_load_dwordx4 v5, s[8:11], s55 offen lds
    v_mfma_f32_16x16x32_bf16 v[48:51], a[180:183], a[156:159], v[48:51]
    ds_read_b64_tr_b16 a[236:237], v32 offset:24576
    v_mfma_f32_16x16x32_bf16 v[52:55], a[184:187], a[156:159], v[52:55]
    ds_read_b64_tr_b16 a[238:239], v32 offset:28672
    v_mfma_f32_16x16x32_bf16 v[104:107], a[188:191], a[156:159], v[104:107]
    s_add_u32 m0, s57, 32768
    ds_read_b64_tr_b16 a[240:241], v30 offset:32768
    v_mfma_f32_16x16x32_bf16 v[108:111], a[192:195], a[156:159], v[108:111]
    buffer_load_dwordx4 v4, s[8:11], s55 offen lds
    v_mfma_f32_16x16x32_bf16 v[160:163], a[156:159], a[196:199], v[160:163]
    ds_read_b64_tr_b16 a[242:243], v30 offset:36864
    v_mfma_f32_16x16x32_bf16 v[192:195], a[156:159], a[200:203], v[192:195]
    ds_read_b64_tr_b16 a[244:245], v32 offset:32768
    v_mfma_f32_16x16x32_bf16 v[56:59], a[180:183], a[160:163], v[56:59]
    ds_read_b64_tr_b16 a[246:247], v32 offset:36864
    v_mfma_f32_16x16x32_bf16 v[60:63], a[184:187], a[160:163], v[60:63]
    s_add_u32 m0, s57, 28672
    ds_read_b64_tr_b16 a[248:249], v30 offset:40960
    v_mfma_f32_16x16x32_bf16 v[112:115], a[188:191], a[160:163], v[112:115]
    s_mov_b64 exec, s[4:5]
    buffer_load_dwordx4 v3, s[8:11], s55 offen lds
    s_mov_b64 exec, -1
    v_mfma_f32_16x16x32_bf16 v[116:119], a[192:195], a[160:163], v[116:119]
    ds_read_b64_tr_b16 a[250:251], v30 offset:45056
    v_mfma_f32_16x16x32_bf16 v[164:167], a[160:163], a[196:199], v[164:167]
    ds_read_b64_tr_b16 a[252:253], v32 offset:40960
    v_mfma_f32_16x16x32_bf16 v[196:199], a[160:163], a[200:203], v[196:199]
    s_add_u32 m0, s56, 0
    s_add_u32 s53, s53, 86016
    s_cmp_ge_u32 s53, 1204224
    s_cselect_b32 s53, 0, s53
    v_mfma_f32_16x16x32_bf16 v[64:67], a[180:183], a[164:167], v[64:67]
    buffer_load_dwordx4 v2, s[12:15], s53 offen lds
    v_mfma_f32_16x16x32_bf16 v[68:71], a[184:187], a[164:167], v[68:71]
    ds_read_b64_tr_b16 a[254:255], v32 offset:45056
    v_mfma_f32_16x16x32_bf16 v[120:123], a[188:191], a[164:167], v[120:123]
    ds_read_b128 a[208:211], v9 offset:2048
    v_mfma_f32_16x16x32_bf16 v[124:127], a[192:195], a[164:167], v[124:127]
    ds_read_b128 a[212:215], v9 offset:4096
    v_mfma_f32_16x16x32_bf16 v[168:171], a[164:167], a[196:199], v[168:171]
    s_add_u32 m0, s56, 4096
    s_add_u32 s54, s53, 10752
    ds_read_b128 a[216:219], v9 offset:6144
    v_mfma_f32_16x16x32_bf16 v[200:203], a[164:167], a[200:203], v[200:203]
    buffer_load_dwordx4 v2, s[12:15], s54 offen lds
    v_mfma_f32_16x16x32_bf16 v[72:75], a[180:183], a[168:171], v[72:75]
    ds_read_b128 a[220:223], v9 offset:8192
    v_mfma_f32_16x16x32_bf16 v[76:79], a[184:187], a[168:171], v[76:79]
    ds_read_b128 a[224:227], v9 offset:10240
    v_mfma_f32_16x16x32_bf16 v[128:131], a[188:191], a[168:171], v[128:131]
    s_add_u32 m0, s56, 7296
    ds_read_b128 a[228:231], v9 offset:12288
    v_mfma_f32_16x16x32_bf16 v[132:135], a[192:195], a[168:171], v[132:135]
    buffer_load_dwordx4 v2, s[12:15], s53 offen offset:896 lds
    v_mfma_f32_16x16x32_bf16 v[172:175], a[168:171], a[196:199], v[172:175]
    v_mfma_f32_16x16x32_bf16 v[204:207], a[168:171], a[200:203], v[204:207]
    v_mfma_f32_16x16x32_bf16 v[80:83], a[180:183], a[172:175], v[80:83]
    v_mfma_f32_16x16x32_bf16 v[84:87], a[184:187], a[172:175], v[84:87]
    s_add_u32 m0, s56, 11392
    v_mfma_f32_16x16x32_bf16 v[136:139], a[188:191], a[172:175], v[136:139]
    buffer_load_dwordx4 v2, s[12:15], s54 offen offset:896 lds
    v_mfma_f32_16x16x32_bf16 v[140:143], a[192:195], a[172:175], v[140:143]
    v_mfma_f32_16x16x32_bf16 v[176:179], a[172:175], a[196:199], v[176:179]
    v_mfma_f32_16x16x32_bf16 v[208:211], a[172:175], a[200:203], v[208:211]
    s_add_u32 m0, s56, 14592
    v_mfma_f32_16x16x32_bf16 v[88:91], a[180:183], a[176:179], v[88:91]
    buffer_load_dwordx4 v2, s[12:15], s53 offen offset:1792 lds
    v_mfma_f32_16x16x32_bf16 v[92:95], a[184:187], a[176:179], v[92:95]
    v_mfma_f32_16x16x32_bf16 v[144:147], a[188:191], a[176:179], v[144:147]
    v_mfma_f32_16x16x32_bf16 v[148:151], a[192:195], a[176:179], v[148:151]
    v_mfma_f32_16x16x32_bf16 v[180:183], a[176:179], a[196:199], v[180:183]
    v_mfma_f32_16x16x32_bf16 v[212:215], a[176:179], a[200:203], v[212:215]
    s_waitcnt vmcnt(15)
    s_waitcnt lgkmcnt(0)
    s_barrier
    v_mfma_f32_16x16x32_bf16 v[40:43], a[232:235], a[204:207], v[40:43]
    s_add_u32 m0, s56, 18688
    ds_read_b128 a[152:155], v8 offset:14336
    v_mfma_f32_16x16x32_bf16 v[44:47], a[236:239], a[204:207], v[44:47]
    buffer_load_dwordx4 v2, s[12:15], s54 offen offset:1792 lds
    v_mfma_f32_16x16x32_bf16 v[96:99], a[240:243], a[204:207], v[96:99]
    ds_read_b64_tr_b16 a[180:181], v31 offset:0
    v_mfma_f32_16x16x32_bf16 v[100:103], a[244:247], a[204:207], v[100:103]
    ds_read_b64_tr_b16 a[182:183], v31 offset:4096
    v_mfma_f32_16x16x32_bf16 v[156:159], a[204:207], a[248:251], v[156:159]
    s_add_u32 m0, s56, 24576
    s_add_u32 s53, s53, 86016
    ds_read_b64_tr_b16 a[184:185], v33 offset:0
    v_mfma_f32_16x16x32_bf16 v[188:191], a[204:207], a[252:255], v[188:191]
    buffer_load_dwordx4 v2, s[12:15], s53 offen lds
    v_mfma_f32_16x16x32_bf16 v[48:51], a[232:235], a[208:211], v[48:51]
    ds_read_b64_tr_b16 a[186:187], v33 offset:4096
    v_mfma_f32_16x16x32_bf16 v[52:55], a[236:239], a[208:211], v[52:55]
    ds_read_b64_tr_b16 a[188:189], v31 offset:8192
    v_mfma_f32_16x16x32_bf16 v[104:107], a[240:243], a[208:211], v[104:107]
    s_add_u32 m0, s56, 28672
    s_add_u32 s54, s53, 10752
    ds_read_b64_tr_b16 a[190:191], v31 offset:12288
    v_mfma_f32_16x16x32_bf16 v[108:111], a[244:247], a[208:211], v[108:111]
    buffer_load_dwordx4 v2, s[12:15], s54 offen lds
    v_mfma_f32_16x16x32_bf16 v[160:163], a[208:211], a[248:251], v[160:163]
    ds_read_b64_tr_b16 a[192:193], v33 offset:8192
    v_mfma_f32_16x16x32_bf16 v[192:195], a[208:211], a[252:255], v[192:195]
    ds_read_b64_tr_b16 a[194:195], v33 offset:12288
    v_mfma_f32_16x16x32_bf16 v[56:59], a[232:235], a[212:215], v[56:59]
    ds_read_b64_tr_b16 a[196:197], v31 offset:16384
    v_mfma_f32_16x16x32_bf16 v[60:63], a[236:239], a[212:215], v[60:63]
    s_add_u32 m0, s56, 31872
    ds_read_b64_tr_b16 a[198:199], v31 offset:20480
    v_mfma_f32_16x16x32_bf16 v[112:115], a[240:243], a[212:215], v[112:115]
    buffer_load_dwordx4 v2, s[12:15], s53 offen offset:896 lds
    v_mfma_f32_16x16x32_bf16 v[116:119], a[244:247], a[212:215], v[116:119]
    ds_read_b64_tr_b16 a[200:201], v33 offset:16384
    v_mfma_f32_16x16x32_bf16 v[164:167], a[212:215], a[248:251], v[164:167]
    ds_read_b64_tr_b16 a[202:203], v33 offset:20480
    v_mfma_f32_16x16x32_bf16 v[196:199], a[212:215], a[252:255], v[196:199]
    s_add_u32 m0, s56, 35968
    ds_read_b128 a[156:159], v8 offset:16384
    v_mfma_f32_16x16x32_bf16 v[64:67], a[232:235], a[216:219], v[64:67]
    buffer_load_dwordx4 v2, s[12:15], s54 offen offset:896 lds
    v_mfma_f32_16x16x32_bf16 v[68:71], a[236:239], a[216:219], v[68:71]
    ds_read_b128 a[160:163], v8 offset:18432
    v_mfma_f32_16x16x32_bf16 v[120:123], a[240:243], a[216:219], v[120:123]
    ds_read_b128 a[164:167], v8 offset:20480
    v_mfma_f32_16x16x32_bf16 v[124:127], a[244:247], a[216:219], v[124:127]
    ds_read_b128 a[168:171], v8 offset:22528
    v_mfma_f32_16x16x32_bf16 v[168:171], a[216:219], a[248:251], v[168:171]
    s_add_u32 m0, s56, 39168
    ds_read_b128 a[172:175], v8 offset:24576
    v_mfma_f32_16x16x32_bf16 v[200:203], a[216:219], a[252:255], v[200:203]
    buffer_load_dwordx4 v2, s[12:15], s53 offen offset:1792 lds
    v_mfma_f32_16x16x32_bf16 v[72:75], a[232:235], a[220:223], v[72:75]
    ds_read_b128 a[176:179], v8 offset:26624
    v_mfma_f32_16x16x32_bf16 v[76:79], a[236:239], a[220:223], v[76:79]
    v_mfma_f32_16x16x32_bf16 v[128:131], a[240:243], a[220:223], v[128:131]
    s_add_u32 m0, s56, 43264
    v_mfma_f32_16x16x32_bf16 v[132:135], a[244:247], a[220:223], v[132:135]
    buffer_load_dwordx4 v2, s[12:15], s54 offen offset:1792 lds
    v_mfma_f32_16x16x32_bf16 v[172:175], a[220:223], a[248:251], v[172:175]
    v_mfma_f32_16x16x32_bf16 v[204:207], a[220:223], a[252:255], v[204:207]
    v_mfma_f32_16x16x32_bf16 v[80:83], a[232:235], a[224:227], v[80:83]
    v_mfma_f32_16x16x32_bf16 v[84:87], a[236:239], a[224:227], v[84:87]
    s_add_u32 m0, s57, 12288
    s_add_u32 s55, s55, 128
    s_cmp_ge_u32 s55, 896
    s_cselect_b32 s55, 0, s55
    v_mfma_f32_16x16x32_bf16 v[136:139], a[240:243], a[224:227], v[136:139]
    s_cmp_ge_u32 s3, 2
    s_cbranch_scc1 L_xs_44
    buffer_load_dwordx4 v6, s[8:11], s55 offen lds
L_xs_44:
    v_mfma_f32_16x16x32_bf16 v[140:143], a[244:247], a[224:227], v[140:143]
    v_mfma_f32_16x16x32_bf16 v[176:179], a[224:227], a[248:251], v[176:179]
    v_mfma_f32_16x16x32_bf16 v[208:211], a[224:227], a[252:255], v[208:211]
    s_add_u32 m0, s57, 8192
    v_mfma_f32_16x16x32_bf16 v[88:91], a[232:235], a[228:231], v[88:91]
    buffer_load_dwordx4 v5, s[8:11], s55 offen lds
    v_mfma_f32_16x16x32_bf16 v[92:95], a[236:239], a[228:231], v[92:95]
    v_mfma_f32_16x16x32_bf16 v[144:147], a[240:243], a[228:231], v[144:147]
    v_mfma_f32_16x16x32_bf16 v[148:151], a[244:247], a[228:231], v[148:151]
    v_mfma_f32_16x16x32_bf16 v[180:183], a[228:231], a[248:251], v[180:183]
    v_mfma_f32_16x16x32_bf16 v[212:215], a[228:231], a[252:255], v[212:215]
    s_waitcnt vmcnt(16)
    v_cmp_ne_u64 vcc, s[44:45], v[28:29]
    s_mov_b32 s65, 0
    s_cbranch_vccz L_polled_46
L_poll_45:
    buffer_load_dwordx2 v[28:29], v24, s[40:43], 0 offen sc1
    s_waitcnt vmcnt(0)
    v_cmp_ne_u64 vcc, s[44:45], v[28:29]
    s_add_u32 s65, s65, 1
    s_cbranch_vccz L_polled_46
    s_cmp_lt_u32 s65, 200000
    s_cbranch_scc1 L_poll_45
L_polled_46:
    buffer_load_dwordx4 v[16:19], v25, s[40:43], s0 offen sc1
    s_waitcnt lgkmcnt(0)
    s_barrier
    v_mfma_f32_16x16x32_bf16 v[40:43], a[180:183], a[152:155], v[40:43]
    s_add_u32 m0, s57, 4096
    ds_read_b128 a[204:207], v9 offset:14336
    v_mfma_f32_16x16x32_bf16 v[44:47], a[184:187], a[152:155], v[44:47]
    buffer_load_dwordx4 v4, s[8:11], s55 offen lds
    v_mfma_f32_16x16x32_bf16 v[96:99], a[188:191], a[152:155], v[96:99]
    ds_read_b64_tr_b16 a[232:233], v31 offset:24576
    v_mfma_f32_16x16x32_bf16 v[100:103], a[192:195], a[152:155], v[100:103]
    ds_read_b64_tr_b16 a[234:235], v31 offset:28672
    v_mfma_f32_16x16x32_bf16 v[156:159], a[152:155], a[196:199], v[156:159]
    ds_read_b64_tr_b16 a[236:237], v33 offset:24576
    v_mfma_f32_16x16x32_bf16 v[188:191], a[152:155], a[200:203], v[188:191]
    s_add_u32 m0, s57, 0
    ds_read_b64_tr_b16 a[238:239], v33 offset:28672
    v_mfma_f32_16x16x32_bf16 v[48:51], a[180:183], a[156:159], v[48:51]
    s_mov_b64 exec, s[4:5]
    buffer_load_dwordx4 v3, s[8:11], s55 offen lds
    s_mov_b64 exec, -1
    v_mfma_f32_16x16x32_bf16 v[52:55], a[184:187], a[156:159], v[52:55]
    ds_read_b64_tr_b16 a[240:241], v31 offset:32768
    v_mfma_f32_16x16x32_bf16 v[104:107], a[188:191], a[156:159], v[104:107]
    ds_read_b64_tr_b16 a[242:243], v31 offset:36864
    v_mfma_f32_16x16x32_bf16 v[108:111], a[192:195], a[156:159], v[108:111]
    ds_read_b64_tr_b16 a[244:245], v33 offset:32768
    v_mfma_f32_16x16x32_bf16 v[160:163], a[156:159], a[196:199], v[160:163]
    s_add_u32 m0, s56, 49152
    s_add_u32 s53, s53, 86016
    s_cmp_ge_u32 s53, 1204224
    s_cselect_b32 s53, 0, s53
    v_mfma_f32_16x16x32_bf16 v[192:195], a[156:159], a[200:203], v[192:195]
    buffer_load_dwordx4 v2, s[12:15], s53 offen lds
    v_mfma_f32_16x16x32_bf16 v[56:59], a[180:183], a[160:163], v[56:59]
    ds_read_b64_tr_b16 a[246:247], v33 offset:36864
    v_mfma_f32_16x16x32_bf16 v[60:63], a[184:187], a[160:163], v[60:63]
    ds_read_b64_tr_b16 a[248:249], v31 offset:40960
    v_mfma_f32_16x16x32_bf16 v[112:115], a[188:191], a[160:163], v[112:115]
    ds_read_b64_tr_b16 a[250:251], v31 offset:45056
    v_mfma_f32_16x16x32_bf16 v[116:119], a[192:195], a[160:163], v[116:119]
    s_add_u32 m0, s56, 53248
    s_add_u32 s54, s53, 10752
    ds_read_b64_tr_b16 a[252:253], v33 offset:40960
    v_mfma_f32_16x16x32_bf16 v[164:167], a[160:163], a[196:199], v[164:167]
    buffer_load_dwordx4 v2, s[12:15], s54 offen lds
    v_mfma_f32_16x16x32_bf16 v[196:199], a[160:163], a[200:203], v[196:199]
    ds_read_b64_tr_b16 a[254:255], v33 offset:45056
    v_mfma_f32_16x16x32_bf16 v[64:67], a[180:183], a[164:167], v[64:67]
    ds_read_b128 a[208:211], v9 offset:16384
    v_mfma_f32_16x16x32_bf16 v[68:71], a[184:187], a[164:167], v[68:71]
    ds_read_b128 a[212:215], v9 offset:18432
    v_mfma_f32_16x16x32_bf16 v[120:123], a[188:191], a[164:167], v[120:123]
    s_add_u32 m0, s56, 56448
    ds_read_b128 a[216:219], v9 offset:20480
    v_mfma_f32_16x16x32_bf16 v[124:127], a[192:195], a[164:167], v[124:127]
    buffer_load_dwordx4 v2, s[12:15], s53 offen offset:896 lds
    v_mfma_f32_16x16x32_bf16 v[168:171], a[164:167], a[196:199], v[168:171]
    ds_read_b128 a[220:223], v9 offset:22528
    v_mfma_f32_16x16x32_bf16 v[200:203], a[164:167], a[200:203], v[200:203]
    ds_read_b128 a[224:227], v9 offset:24576
    v_mfma_f32_16x16x32_bf16 v[72:75], a[180:183], a[168:171], v[72:75]
    ds_read_b128 a[228:231], v9 offset:26624
    v_mfma_f32_16x16x32_bf16 v[76:79], a[184:187], a[168:171], v[76:79]
    s_add_u32 m0, s56, 60544
    v_mfma_f32_16x16x32_bf16 v[128:131], a[188:191], a[168:171], v[128:131]
    buffer_load_dwordx4 v2, s[12:15], s54 offen offset:896 lds
    v_mfma_f32_16x16x32_bf16 v[132:135], a[192:195], a[168:171], v[132:135]
    v_mfma_f32_16x16x32_bf16 v[172:175], a[168:171], a[196:199], v[172:175]
    v_mfma_f32_16x16x32_bf16 v[204:207], a[168:171], a[200:203], v[204:207]
    v_mfma_f32_16x16x32_bf16 v[80:83], a[180:183], a[172:175], v[80:83]
    s_add_u32 m0, s56, 63744
    v_mfma_f32_16x16x32_bf16 v[84:87], a[184:187], a[172:175], v[84:87]
    buffer_load_dwordx4 v2, s[12:15], s53 offen offset:1792 lds
    v_mfma_f32_16x16x32_bf16 v[136:139], a[188:191], a[172:175], v[136:139]
    v_mfma_f32_16x16x32_bf16 v[140:143], a[192:195], a[172:175], v[140:143]
    v_mfma_f32_16x16x32_bf16 v[176:179], a[172:175], a[196:199], v[176:179]
    v_mfma_f32_16x16x32_bf16 v[208:211], a[172:175], a[200:203], v[208:211]
    s_add_u32 m0, s56, 67840
    v_mfma_f32_16x16x32_bf16 v[88:91], a[180:183], a[176:179], v[88:91]
    buffer_load_dwordx4 v2, s[12:15], s54 offen offset:1792 lds
    v_mfma_f32_16x16x32_bf16 v[92:95], a[184:187], a[176:179], v[92:95]
    v_mfma_f32_16x16x32_bf16 v[144:147], a[188:191], a[176:179], v[144:147]
    v_mfma_f32_16x16x32_bf16 v[148:151], a[192:195], a[176:179], v[148:151]
    v_mfma_f32_16x16x32_bf16 v[180:183], a[176:179], a[196:199], v[180:183]
    v_mfma_f32_16x16x32_bf16 v[212:215], a[176:179], a[200:203], v[212:215]
    s_waitcnt vmcnt(16)
    s_waitcnt lgkmcnt(0)
    s_barrier
    v_mfma_f32_16x16x32_bf16 v[40:43], a[232:235], a[204:207], v[40:43]
    s_add_u32 m0, s56, 73728
    s_add_u32 s53, s53, 86016
    ds_read_b128 a[152:155], v8 offset:28672
L_pad_13:
    s_cbranch_execz L_ret
    v_mfma_f32_16x16x32_bf16 v[44:47], a[236:239], a[204:207], v[44:47]
    buffer_load_dwordx4 v2, s[12:15], s53 offen lds
    v_mfma_f32_16x16x32_bf16 v[96:99], a[240:243], a[204:207], v[96:99]
    ds_read_b64_tr_b16 a[180:181], v30 offset:0
    v_mfma_f32_16x16x32_bf16 v[100:103], a[244:247], a[204:207], v[100:103]
    ds_read_b64_tr_b16 a[182:183], v30 offset:4096
    v_mfma_f32_16x16x32_bf16 v[156:159], a[204:207], a[248:251], v[156:159]
    ds_read_b64_tr_b16 a[184:185], v32 offset:0
    v_mfma_f32_16x16x32_bf16 v[188:191], a[204:207], a[252:255], v[188:191]
    ds_read_b64_tr_b16 a[186:187], v32 offset:4096
    v_mfma_f32_16x16x32_bf16 v[48:51], a[232:235], a[208:211], v[48:51]
    s_add_u32 m0, s56, 77824
    s_add_u32 s54, s53, 10752
    ds_read_b64_tr_b16 a[188:189], v30 offset:8192
    v_mfma_f32_16x16x32_bf16 v[52:55], a[236:239], a[208:211], v[52:55]
    buffer_load_dwordx4 v2, s[12:15], s54 offen lds
    v_mfma_f32_16x16x32_bf16 v[104:107], a[240:243], a[208:211], v[104:107]
    ds_read_b64_tr_b16 a[190:191], v30 offset:12288
    v_mfma_f32_16x16x32_bf16 v[108:111], a[244:247], a[208:211], v[108:111]
    ds_read_b64_tr_b16 a[192:193], v32 offset:8192
    v_mfma_f32_16x16x32_bf16 v[160:163], a[208:211], a[248:251], v[160:163]
    ds_read_b64_tr_b16 a[194:195], v32 offset:12288
    v_mfma_f32_16x16x32_bf16 v[192:195], a[208:211], a[252:255], v[192:195]
    ds_read_b64_tr_b16 a[196:197], v30 offset:16384
    v_mfma_f32_16x16x32_bf16 v[56:59], a[232:235], a[212:215], v[56:59]
    ds_read_b64_tr_b16 a[198:199], v30 offset:20480
    v_mfma_f32_16x16x32_bf16 v[60:63], a[236:239], a[212:215], v[60:63]
    s_add_u32 m0, s56, 81024
    ds_read_b64_tr_b16 a[200:201], v32 offset:16384
    v_mfma_f32_16x16x32_bf16 v[112:115], a[240:243], a[212:215], v[112:115]
    buffer_load_dwordx4 v2, s[12:15], s53 offen offset:896 lds
    v_mfma_f32_16x16x32_bf16 v[116:119], a[244:247], a[212:215], v[116:119]
    ds_read_b64_tr_b16 a[202:203], v32 offset:20480
    v_mfma_f32_16x16x32_bf16 v[164:167], a[212:215], a[248:251], v[164:167]
    ds_read_b128 a[156:159], v8 offset:30720
    v_mfma_f32_16x16x32_bf16 v[196:199], a[212:215], a[252:255], v[196:199]
    ds_read_b128 a[160:163], v8 offset:32768
    v_mfma_f32_16x16x32_bf16 v[64:67], a[232:235], a[216:219], v[64:67]
    ds_read_b128 a[164:167], v8 offset:34816
    v_mfma_f32_16x16x32_bf16 v[68:71], a[236:239], a[216:219], v[68:71]
    ds_read_b128 a[168:171], v8 offset:36864
    v_mfma_f32_16x16x32_bf16 v[120:123], a[240:243], a[216:219], v[120:123]
    s_add_u32 m0, s56, 85120
    ds_read_b128 a[172:175], v8 offset:38912
    v_mfma_f32_16x16x32_bf16 v[124:127], a[244:247], a[216:219], v[124:127]
    buffer_load_dwordx4 v2, s[12:15], s54 offen offset:896 lds
    v_mfma_f32_16x16x32_bf16 v[168:171], a[216:219], a[248:251], v[168:171]
    ds_read_b128 a[176:179], v8 offset:40960
    v_mfma_f32_16x16x32_bf16 v[200:203], a[216:219], a[252:255], v[200:203]
    v_mfma_f32_16x16x32_bf16 v[72:75], a[232:235], a[220:223], v[72:75]
    v_mfma_f32_16x16x32_bf16 v[76:79], a[236:239], a[220:223], v[76:79]
    v_mfma_f32_16x16x32_bf16 v[128:131], a[240:243], a[220:223], v[128:131]
    s_add_u32 m0, s56, 88320
    v_mfma_f32_16x16x32_bf16 v[132:135], a[244:247], a[220:223], v[132:135]
    buffer_load_dwordx4 v2, s[12:15], s53 offen offset:1792 lds
    v_mfma_f32_16x16x32_bf16 v[172:175], a[220:223], a[248:251], v[172:175]
    v_mfma_f32_16x16x32_bf16 v[204:207], a[220:223], a[252:255], v[204:207]
    v_mfma_f32_16x16x32_bf16 v[80:83], a[232:235], a[224:227], v[80:83]
    v_mfma_f32_16x16x32_bf16 v[84:87], a[236:239], a[224:227], v[84:87]
    v_mfma_f32_16x16x32_bf16 v[136:139], a[240:243], a[224:227], v[136:139]
    v_mfma_f32_16x16x32_bf16 v[140:143], a[244:247], a[224:227], v[140:143]
    s_add_u32 m0, s56, 92416
    v_mfma_f32_16x16x32_bf16 v[176:179], a[224:227], a[248:251], v[176:179]
    buffer_load_dwordx4 v2, s[12:15], s54 offen offset:1792 lds
    v_mfma_f32_16x16x32_bf16 v[208:211], a[224:227], a[252:255], v[208:211]
    v_mfma_f32_16x16x32_bf16 v[88:91], a[232:235], a[228:231], v[88:91]
    v_mfma_f32_16x16x32_bf16 v[92:95], a[236:239], a[228:231], v[92:95]
    v_mfma_f32_16x16x32_bf16 v[144:147], a[240:243], a[228:231], v[144:147]
    v_mfma_f32_16x16x32_bf16 v[148:151], a[244:247], a[228:231], v[148:151]
    v_mfma_f32_16x16x32_bf16 v[180:183], a[228:231], a[248:251], v[180:183]
    v_mfma_f32_16x16x32_bf16 v[212:215], a[228:231], a[252:255], v[212:215]
    s_waitcnt vmcnt(14)
    ds_write_b128 v26, v[16:19]
    buffer_load_dwordx2 v[184:185], v36, s[32:35], 0 offen offset:60
    buffer_load_dwordx2 v[184:185], v37, s[24:27], 0 offen offset:60
    s_waitcnt lgkmcnt(0)
    s_barrier
    v_mfma_f32_16x16x32_bf16 v[40:43], a[180:183], a[152:155], v[40:43]
    ds_read_b128 a[204:207], v9 offset:28672
    v_mfma_f32_16x16x32_bf16 v[44:47], a[184:187], a[152:155], v[44:47]
    ds_read_b64_tr_b16 a[232:233], v30 offset:24576
    v_mfma_f32_16x16x32_bf16 v[96:99], a[188:191], a[152:155], v[96:99]
    ds_read_b64_tr_b16 a[234:235], v30 offset:28672
    v_mfma_f32_16x16x32_bf16 v[100:103], a[192:195], a[152:155], v[100:103]
    ds_read_b64_tr_b16 a[236:237], v32 offset:24576
    v_mfma_f32_16x16x32_bf16 v[156:159], a[152:155], a[196:199], v[156:159]
    ds_read_b64_tr_b16 a[238:239], v32 offset:28672
    v_mfma_f32_16x16x32_bf16 v[188:191], a[152:155], a[200:203], v[188:191]
    ds_read_b64_tr_b16 a[240:241], v30 offset:32768
    v_mfma_f32_16x16x32_bf16 v[48:51], a[180:183], a[156:159], v[48:51]
    ds_read_b64_tr_b16 a[242:243], v30 offset:36864
    v_mfma_f32_16x16x32_bf16 v[52:55], a[184:187], a[156:159], v[52:55]
    ds_read_b64_tr_b16 a[244:245], v32 offset:32768
    v_mfma_f32_16x16x32_bf16 v[104:107], a[188:191], a[156:159], v[104:107]
    ds_read_b64_tr_b16 a[246:247], v32 offset:36864
    v_mfma_f32_16x16x32_bf16 v[108:111], a[192:195], a[156:159], v[108:111]
    ds_read_b64_tr_b16 a[248:249], v30 offset:40960
    v_mfma_f32_16x16x32_bf16 v[160:163], a[156:159], a[196:199], v[160:163]
    ds_read_b64_tr_b16 a[250:251], v30 offset:45056
    v_mfma_f32_16x16x32_bf16 v[192:195], a[156:159], a[200:203], v[192:195]
    ds_read_b64_tr_b16 a[252:253], v32 offset:40960
    v_mfma_f32_16x16x32_bf16 v[56:59], a[180:183], a[160:163], v[56:59]
    ds_read_b64_tr_b16 a[254:255], v32 offset:45056
    v_mfma_f32_16x16x32_bf16 v[60:63], a[184:187], a[160:163], v[60:63]
    ds_read_b128 a[208:211], v9 offset:30720
    v_mfma_f32_16x16x32_bf16 v[112:115], a[188:191], a[160:163], v[112:115]
    ds_read_b128 a[212:215], v9 offset:32768
    v_mfma_f32_16x16x32_bf16 v[116:119], a[192:195], a[160:163], v[116:119]
    ds_read_b128 a[216:219], v9 offset:34816
    v_mfma_f32_16x16x32_bf16 v[164:167], a[160:163], a[196:199], v[164:167]
    ds_read_b128 a[220:223], v9 offset:36864
    v_mfma_f32_16x16x32_bf16 v[196:199], a[160:163], a[200:203], v[196:199]
    ds_read_b128 a[224:227], v9 offset:38912
    v_mfma_f32_16x16x32_bf16 v[64:67], a[180:183], a[164:167], v[64:67]
    ds_read_b128 a[228:231], v9 offset:40960
    v_mfma_f32_16x16x32_bf16 v[68:71], a[184:187], a[164:167], v[68:71]
    v_mfma_f32_16x16x32_bf16 v[120:123], a[188:191], a[164:167], v[120:123]
    v_mfma_f32_16x16x32_bf16 v[124:127], a[192:195], a[164:167], v[124:127]
    v_mfma_f32_16x16x32_bf16 v[168:171], a[164:167], a[196:199], v[168:171]
    v_mfma_f32_16x16x32_bf16 v[200:203], a[164:167], a[200:203], v[200:203]
    v_mfma_f32_16x16x32_bf16 v[72:75], a[180:183], a[168:171], v[72:75]
    v_mfma_f32_16x16x32_bf16 v[76:79], a[184:187], a[168:171], v[76:79]
    v_mfma_f32_16x16x32_bf16 v[128:131], a[188:191], a[168:171], v[128:131]
    v_mfma_f32_16x16x32_bf16 v[132:135], a[192:195], a[168:171], v[132:135]
    v_mfma_f32_16x16x32_bf16 v[172:175], a[168:171], a[196:199], v[172:175]
    v_mfma_f32_16x16x32_bf16 v[204:207], a[168:171], a[200:203], v[204:207]
    v_mfma_f32_16x16x32_bf16 v[80:83], a[180:183], a[172:175], v[80:83]
    v_mfma_f32_16x16x32_bf16 v[84:87], a[184:187], a[172:175], v[84:87]
    v_mfma_f32_16x16x32_bf16 v[136:139], a[188:191], a[172:175], v[136:139]
    v_mfma_f32_16x16x32_bf16 v[140:143], a[192:195], a[172:175], v[140:143]
    v_mfma_f32_16x16x32_bf16 v[176:179], a[172:175], a[196:199], v[176:179]
    v_mfma_f32_16x16x32_bf16 v[208:211], a[172:175], a[200:203], v[208:211]
    v_mfma_f32_16x16x32_bf16 v[88:91], a[180:183], a[176:179], v[88:91]
    v_mfma_f32_16x16x32_bf16 v[92:95], a[184:187], a[176:179], v[92:95]
    v_mfma_f32_16x16x32_bf16 v[144:147], a[188:191], a[176:179], v[144:147]
    v_mfma_f32_16x16x32_bf16 v[148:151], a[192:195], a[176:179], v[148:151]
    v_mfma_f32_16x16x32_bf16 v[180:183], a[176:179], a[196:199], v[180:183]
    v_mfma_f32_16x16x32_bf16 v[212:215], a[176:179], a[200:203], v[212:215]
    s_lshl_b32 s74, s78, 16
    s_cmp_ge_u32 s78, 28
    s_cselect_b32 s74, 0x40000000, s74
    s_add_u32 s78, s78, s79
    buffer_load_dwordx2 v[184:185], v38, s[24:27], s74 offen offset:60
    s_waitcnt vmcnt(9)
    s_waitcnt lgkmcnt(0)
    s_barrier
    v_mfma_f32_16x16x32_bf16 v[40:43], a[232:235], a[204:207], v[40:43]
    ds_read_b128 a[152:155], v8 offset:0
    v_mfma_f32_16x16x32_bf16 v[44:47], a[236:239], a[204:207], v[44:47]
    ds_read_b64_tr_b16 a[180:181], v31 offset:0
    v_mfma_f32_16x16x32_bf16 v[96:99], a[240:243], a[204:207], v[96:99]
    ds_read_b64_tr_b16 a[182:183], v31 offset:4096
    v_mfma_f32_16x16x32_bf16 v[100:103], a[244:247], a[204:207], v[100:103]
    ds_read_b64_tr_b16 a[184:185], v33 offset:0
    v_mfma_f32_16x16x32_bf16 v[156:159], a[204:207], a[248:251], v[156:159]
    ds_read_b64_tr_b16 a[186:187], v33 offset:4096
    v_mfma_f32_16x16x32_bf16 v[188:191], a[204:207], a[252:255], v[188:191]
    ds_read_b64_tr_b16 a[188:189], v31 offset:8192
    v_mfma_f32_16x16x32_bf16 v[48:51], a[232:235], a[208:211], v[48:51]
    ds_read_b64_tr_b16 a[190:191], v31 offset:12288
    v_mfma_f32_16x16x32_bf16 v[52:55], a[236:239], a[208:211], v[52:55]
    ds_read_b64_tr_b16 a[192:193], v33 offset:8192
    v_mfma_f32_16x16x32_bf16 v[104:107], a[240:243], a[208:211], v[104:107]
    ds_read_b64_tr_b16 a[194:195], v33 offset:12288
    v_mfma_f32_16x16x32_bf16 v[108:111], a[244:247], a[208:211], v[108:111]
    ds_read_b64_tr_b16 a[196:197], v31 offset:16384
    v_mfma_f32_16x16x32_bf16 v[160:163], a[208:211], a[248:251], v[160:163]
    ds_read_b64_tr_b16 a[198:199], v31 offset:20480
    v_mfma_f32_16x16x32_bf16 v[192:195], a[208:211], a[252:255], v[192:195]
    ds_read_b64_tr_b16 a[200:201], v33 offset:16384
    v_mfma_f32_16x16x32_bf16 v[56:59], a[232:235], a[212:215], v[56:59]
    ds_read_b64_tr_b16 a[202:203], v33 offset:20480
    v_mfma_f32_16x16x32_bf16 v[60:63], a[236:239], a[212:215], v[60:63]
    ds_read_b128 a[156:159], v8 offset:2048
    v_mfma_f32_16x16x32_bf16 v[112:115], a[240:243], a[212:215], v[112:115]
    ds_read_b128 a[160:163], v8 offset:4096
    v_mfma_f32_16x16x32_bf16 v[116:119], a[244:247], a[212:215], v[116:119]
    ds_read_b128 a[164:167], v8 offset:6144
    v_mfma_f32_16x16x32_bf16 v[164:167], a[212:215], a[248:251], v[164:167]
    ds_read_b128 a[168:171], v8 offset:8192
    v_mfma_f32_16x16x32_bf16 v[196:199], a[212:215], a[252:255], v[196:199]
    ds_read_b128 a[172:175], v8 offset:10240
    v_mfma_f32_16x16x32_bf16 v[64:67], a[232:235], a[216:219], v[64:67]
    ds_read_b128 a[176:179], v8 offset:12288
    v_mfma_f32_16x16x32_bf16 v[68:71], a[236:239], a[216:219], v[68:71]
    v_mfma_f32_16x16x32_bf16 v[120:123], a[240:243], a[216:219], v[120:123]
    v_mfma_f32_16x16x32_bf16 v[124:127], a[244:247], a[216:219], v[124:127]
    v_mfma_f32_16x16x32_bf16 v[168:171], a[216:219], a[248:251], v[168:171]
    v_mfma_f32_16x16x32_bf16 v[200:203], a[216:219], a[252:255], v[200:203]
    v_mfma_f32_16x16x32_bf16 v[72:75], a[232:235], a[220:223], v[72:75]
    v_mfma_f32_16x16x32_bf16 v[76:79], a[236:239], a[220:223], v[76:79]
    v_mfma_f32_16x16x32_bf16 v[128:131], a[240:243], a[220:223], v[128:131]
    v_mfma_f32_16x16x32_bf16 v[132:135], a[244:247], a[220:223], v[132:135]
    v_mfma_f32_16x16x32_bf16 v[172:175], a[220:223], a[248:251], v[172:175]
    v_mfma_f32_16x16x32_bf16 v[204:207], a[220:223], a[252:255], v[204:207]
    v_mfma_f32_16x16x32_bf16 v[80:83], a[232:235], a[224:227], v[80:83]
    v_mfma_f32_16x16x32_bf16 v[84:87], a[236:239], a[224:227], v[84:87]
    v_mfma_f32_16x16x32_bf16 v[136:139], a[240:243], a[224:227], v[136:139]
    v_mfma_f32_16x16x32_bf16 v[140:143], a[244:247], a[224:227], v[140:143]
    v_mfma_f32_16x16x32_bf16 v[176:179], a[224:227], a[248:251], v[176:179]
    v_mfma_f32_16x16x32_bf16 v[208:211], a[224:227], a[252:255], v[208:211]
    v_mfma_f32_16x16x32_bf16 v[88:91], a[232:235], a[228:231], v[88:91]
    v_mfma_f32_16x16x32_bf16 v[92:95], a[236:239], a[228:231], v[92:95]
    v_mfma_f32_16x16x32_bf16 v[144:147], a[240:243], a[228:231], v[144:147]
    v_mfma_f32_16x16x32_bf16 v[148:151], a[244:247], a[228:231], v[148:151]
    v_mfma_f32_16x16x32_bf16 v[180:183], a[228:231], a[248:251], v[180:183]
    v_mfma_f32_16x16x32_bf16 v[212:215], a[228:231], a[252:255], v[212:215]
    s_lshl_b32 s74, s78, 16
    s_cmp_ge_u32 s78, 28
    s_cselect_b32 s74, 0x40000000, s74
    s_add_u32 s78, s78, s79
    buffer_load_dwordx2 v[184:185], v38, s[24:27], s74 offen offset:60
    s_waitcnt vmcnt(4)
    s_waitcnt lgkmcnt(0)
    s_barrier
    v_mfma_f32_16x16x32_bf16 v[40:43], a[180:183], a[152:155], v[40:43]
    ds_read_b128 a[204:207], v9 offset:0
    v_mfma_f32_16x16x32_bf16 v[44:47], a[184:187], a[152:155], v[44:47]
    ds_read_b64_tr_b16 a[232:233], v31 offset:24576
    v_mfma_f32_16x16x32_bf16 v[96:99], a[188:191], a[152:155], v[96:99]
    ds_read_b64_tr_b16 a[234:235], v31 offset:28672
    v_mfma_f32_16x16x32_bf16 v[100:103], a[192:195], a[152:155], v[100:103]
    ds_read_b64_tr_b16 a[236:237], v33 offset:24576
    v_mfma_f32_16x16x32_bf16 v[156:159], a[152:155], a[196:199], v[156:159]
    ds_read_b64_tr_b16 a[238:239], v33 offset:28672
    v_mfma_f32_16x16x32_bf16 v[188:191], a[152:155], a[200:203], v[188:191]
    ds_read_b64_tr_b16 a[240:241], v31 offset:32768
    v_mfma_f32_16x16x32_bf16 v[48:51], a[180:183], a[156:159], v[48:51]
    ds_read_b64_tr_b16 a[242:243], v31 offset:36864
    v_mfma_f32_16x16x32_bf16 v[52:55], a[184:187], a[156:159], v[52:55]
    ds_read_b64_tr_b16 a[244:245], v33 offset:32768
    v_mfma_f32_16x16x32_bf16 v[104:107], a[188:191], a[156:159], v[104:107]
    ds_read_b64_tr_b16 a[246:247], v33 offset:36864
    v_mfma_f32_16x16x32_bf16 v[108:111], a[192:195], a[156:159], v[108:111]
    ds_read_b64_tr_b16 a[248:249], v31 offset:40960
    v_mfma_f32_16x16x32_bf16 v[160:163], a[156:159], a[196:199], v[160:163]
    ds_read_b64_tr_b16 a[250:251], v31 offset:45056
    v_mfma_f32_16x16x32_bf16 v[192:195], a[156:159], a[200:203], v[192:195]
    ds_read_b64_tr_b16 a[252:253], v33 offset:40960
    v_mfma_f32_16x16x32_bf16 v[56:59], a[180:183], a[160:163], v[56:59]
    ds_read_b64_tr_b16 a[254:255], v33 offset:45056
    v_mfma_f32_16x16x32_bf16 v[60:63], a[184:187], a[160:163], v[60:63]
    ds_read_b128 a[208:211], v9 offset:2048
    v_mfma_f32_16x16x32_bf16 v[112:115], a[188:191], a[160:163], v[112:115]
    ds_read_b128 a[212:215], v9 offset:4096
    v_mfma_f32_16x16x32_bf16 v[116:119], a[192:195], a[160:163], v[116:119]
    ds_read_b128 a[216:219], v9 offset:6144
    v_mfma_f32_16x16x32_bf16 v[164:167], a[160:163], a[196:199], v[164:167]
    ds_read_b128 a[220:223], v9 offset:8192
    v_mfma_f32_16x16x32_bf16 v[196:199], a[160:163], a[200:203], v[196:199]
    ds_read_b128 a[224:227], v9 offset:10240
    v_mfma_f32_16x16x32_bf16 v[64:67], a[180:183], a[164:167], v[64:67]
    ds_read_b128 a[228:231], v9 offset:12288
    v_mfma_f32_16x16x32_bf16 v[68:71], a[184:187], a[164:167], v[68:71]
    v_mfma_f32_16x16x32_bf16 v[120:123], a[188:191], a[164:167], v[120:123]
    v_mfma_f32_16x16x32_bf16 v[124:127], a[192:195], a[164:167], v[124:127]
    v_mfma_f32_16x16x32_bf16 v[168:171], a[164:167], a[196:199], v[168:171]
    v_mfma_f32_16x16x32_bf16 v[200:203], a[164:167], a[200:203], v[200:203]
    v_mfma_f32_16x16x32_bf16 v[72:75], a[180:183], a[168:171], v[72:75]
    v_mfma_f32_16x16x32_bf16 v[76:79], a[184:187], a[168:171], v[76:79]
    v_mfma_f32_16x16x32_bf16 v[128:131], a[188:191], a[168:171], v[128:131]
    v_mfma_f32_16x16x32_bf16 v[132:135], a[192:195], a[168:171], v[132:135]
    v_mfma_f32_16x16x32_bf16 v[172:175], a[168:171], a[196:199], v[172:175]
    v_mfma_f32_16x16x32_bf16 v[204:207], a[168:171], a[200:203], v[204:207]
    v_mfma_f32_16x16x32_bf16 v[80:83], a[180:183], a[172:175], v[80:83]
    v_mfma_f32_16x16x32_bf16 v[84:87], a[184:187], a[172:175], v[84:87]
    v_mfma_f32_16x16x32_bf16 v[136:139], a[188:191], a[172:175], v[136:139]
    v_mfma_f32_16x16x32_bf16 v[140:143], a[192:195], a[172:175], v[140:143]
    v_mfma_f32_16x16x32_bf16 v[176:179], a[172:175], a[196:199], v[176:179]
    v_mfma_f32_16x16x32_bf16 v[208:211], a[172:175], a[200:203], v[208:211]
    v_mfma_f32_16x16x32_bf16 v[88:91], a[180:183], a[176:179], v[88:91]
    v_mfma_f32_16x16x32_bf16 v[92:95], a[184:187], a[176:179], v[92:95]
    v_mfma_f32_16x16x32_bf16 v[144:147], a[188:191], a[176:179], v[144:147]
    v_mfma_f32_16x16x32_bf16 v[148:151], a[192:195], a[176:179], v[148:151]
    v_mfma_f32_16x16x32_bf16 v[180:183], a[176:179], a[196:199], v[180:183]
    v_mfma_f32_16x16x32_bf16 v[212:215], a[176:179], a[200:203], v[212:215]
    s_lshl_b32 s74, s78, 16
    s_cmp_ge_u32 s78, 28
    s_cselect_b32 s74, 0x40000000, s74
    s_add_u32 s78, s78, s79
    buffer_load_dwordx2 v[184:185], v38, s[24:27], s74 offen offset:60
    s_waitcnt lgkmcnt(0)
    s_barrier
    v_mfma_f32_16x16x32_bf16 v[40:43], a[232:235], a[204:207], v[40:43]
    v_mfma_f32_16x16x32_bf16 v[44:47], a[236:239], a[204:207], v[44:47]
    v_mfma_f32_16x16x32_bf16 v[96:99], a[240:243], a[204:207], v[96:99]
    v_mfma_f32_16x16x32_bf16 v[100:103], a[244:247], a[204:207], v[100:103]
    v_mfma_f32_16x16x32_bf16 v[156:159], a[204:207], a[248:251], v[156:159]
    v_mfma_f32_16x16x32_bf16 v[188:191], a[204:207], a[252:255], v[188:191]
    v_mfma_f32_16x16x32_bf16 v[48:51], a[232:235], a[208:211], v[48:51]
    v_mfma_f32_16x16x32_bf16 v[52:55], a[236:239], a[208:211], v[52:55]
    v_mfma_f32_16x16x32_bf16 v[104:107], a[240:243], a[208:211], v[104:107]
    v_mfma_f32_16x16x32_bf16 v[108:111], a[244:247], a[208:211], v[108:111]
    v_mfma_f32_16x16x32_bf16 v[160:163], a[208:211], a[248:251], v[160:163]
    v_mfma_f32_16x16x32_bf16 v[192:195], a[208:211], a[252:255], v[192:195]
    v_mfma_f32_16x16x32_bf16 v[56:59], a[232:235], a[212:215], v[56:59]
    v_mfma_f32_16x16x32_bf16 v[60:63], a[236:239], a[212:215], v[60:63]
    v_mfma_f32_16x16x32_bf16 v[112:115], a[240:243], a[212:215], v[112:115]
    v_mfma_f32_16x16x32_bf16 v[116:119], a[244:247], a[212:215], v[116:119]
    v_mfma_f32_16x16x32_bf16 v[164:167], a[212:215], a[248:251], v[164:167]
    v_mfma_f32_16x16x32_bf16 v[196:199], a[212:215], a[252:255], v[196:199]
    v_mfma_f32_16x16x32_bf16 v[64:67], a[232:235], a[216:219], v[64:67]
    v_mfma_f32_16x16x32_bf16 v[68:71], a[236:239], a[216:219], v[68:71]
    v_mfma_f32_16x16x32_bf16 v[120:123], a[240:243], a[216:219], v[120:123]
    v_mfma_f32_16x16x32_bf16 v[124:127], a[244:247], a[216:219], v[124:127]
    v_mfma_f32_16x16x32_bf16 v[168:171], a[216:219], a[248:251], v[168:171]
    v_mfma_f32_16x16x32_bf16 v[200:203], a[216:219], a[252:255], v[200:203]
    v_mfma_f32_16x16x32_bf16 v[72:75], a[232:235], a[220:223], v[72:75]
    v_mfma_f32_16x16x32_bf16 v[76:79], a[236:239], a[220:223], v[76:79]
    v_mfma_f32_16x16x32_bf16 v[128:131], a[240:243], a[220:223], v[128:131]
    v_mfma_f32_16x16x32_bf16 v[132:135], a[244:247], a[220:223], v[132:135]
    v_mfma_f32_16x16x32_bf16 v[172:175], a[220:223], a[248:251], v[172:175]
    v_mfma_f32_16x16x32_bf16 v[204:207], a[220:223], a[252:255], v[204:207]
    v_mfma_f32_16x16x32_bf16 v[80:83], a[232:235], a[224:227], v[80:83]
    v_mfma_f32_16x16x32_bf16 v[84:87], a[236:239], a[224:227], v[84:87]
    v_mfma_f32_16x16x32_bf16 v[136:139], a[240:243], a[224:227], v[136:139]
    v_mfma_f32_16x16x32_bf16 v[140:143], a[244:247], a[224:227], v[140:143]
    v_mfma_f32_16x16x32_bf16 v[176:179], a[224:227], a[248:251], v[176:179]
    v_mfma_f32_16x16x32_bf16 v[208:211], a[224:227], a[252:255], v[208:211]
    v_mfma_f32_16x16x32_bf16 v[88:91], a[232:235], a[228:231], v[88:91]
    v_mfma_f32_16x16x32_bf16 v[92:95], a[236:239], a[228:231], v[92:95]
    v_mfma_f32_16x16x32_bf16 v[144:147], a[240:243], a[228:231], v[144:147]
    v_mfma_f32_16x16x32_bf16 v[148:151], a[244:247], a[228:231], v[148:151]
    v_mfma_f32_16x16x32_bf16 v[180:183], a[228:231], a[248:251], v[180:183]
    v_mfma_f32_16x16x32_bf16 v[212:215], a[228:231], a[252:255], v[212:215]
    s_mov_b32 s74, 0
    buffer_load_dwordx2 v[184:185], v250, s[16:19], s74 offen offset:60
    s_mov_b32 s74, 393216
    buffer_load_dwordx2 v[184:185], v250, s[16:19], s74 offen offset:60
    ds_read2_b32 v[24:25], v34 offset0:0 offset1:128
    ds_read_b128 v[12:15], v35 offset:0
    ds_read_b128 v[16:19], v35 offset:512
    v_mov_b32_dpp v28, v96 row_newbcast:0 row_mask:0xf bank_mask:0xf
    v_mov_b32_dpp v230, v40 row_newbcast:0 row_mask:0xf bank_mask:0xf
    v_mov_b32_dpp v29, v97 row_newbcast:0 row_mask:0xf bank_mask:0xf
    v_mov_b32_dpp v231, v41 row_newbcast:0 row_mask:0xf bank_mask:0xf
    v_mov_b32_dpp v30, v98 row_newbcast:0 row_mask:0xf bank_mask:0xf
    v_mov_b32_dpp v232, v42 row_newbcast:0 row_mask:0xf bank_mask:0xf
    v_mov_b32_dpp v31, v99 row_newbcast:0 row_mask:0xf bank_mask:0xf
    v_mov_b32_dpp v233, v43 row_newbcast:0 row_mask:0xf bank_mask:0xf
    v_mov_b32_dpp v32, v100 row_newbcast:0 row_mask:0xf bank_mask:0xf
    v_mov_b32_dpp v234, v44 row_newbcast:0 row_mask:0xf bank_mask:0xf
    v_mov_b32_dpp v33, v101 row_newbcast:0 row_mask:0xf bank_mask:0xf
    v_mov_b32_dpp v235, v45 row_newbcast:0 row_mask:0xf bank_mask:0xf
    v_mov_b32_dpp v36, v102 row_newbcast:0 row_mask:0xf bank_mask:0xf
    v_mov_b32_dpp v236, v46 row_newbcast:0 row_mask:0xf bank_mask:0xf
    v_mov_b32_dpp v37, v103 row_newbcast:0 row_mask:0xf bank_mask:0xf
    v_mov_b32_dpp v237, v47 row_newbcast:0 row_mask:0xf bank_mask:0xf
    v_mov_b32 v8, v156
    v_mov_b32 v2, v156
    v_mov_b32 v9, v188
    v_mov_b32 v3, v188
    v_permlane16_swap_b32 v8, v2
    s_nop 0
    v_permlane16_swap_b32 v9, v3
    v_mov_b32 v2, v8
    v_mov_b32 v3, v9
    s_nop 0
    v_permlane32_swap_b32 v8, v2
    v_permlane32_swap_b32 v9, v3
    ds_read2_b32 v[152:153], v34 offset0:16 offset1:144
    ds_read_b128 v[2:5], v35 offset:64
    ds_read_b128 v[246:249], v35 offset:576
    s_waitcnt lgkmcnt(3)
    v_pk_fma_f32 v[96:97], v[28:29], v[24:25], v[96:97] op_sel:[0,1,0] op_sel_hi:[1,1,1]
    v_pk_fma_f32 v[98:99], v[30:31], v[24:25], v[98:99] op_sel:[0,1,0] op_sel_hi:[1,1,1]
    v_pk_fma_f32 v[100:101], v[32:33], v[24:25], v[100:101] op_sel:[0,1,0] op_sel_hi:[1,1,1]
    v_pk_fma_f32 v[102:103], v[36:37], v[24:25], v[102:103] op_sel:[0,1,0] op_sel_hi:[1,1,1]
    v_pk_fma_f32 v[40:41], v[230:231], v[24:25], v[40:41] op_sel:[0,1,0] op_sel_hi:[1,1,1]
    v_pk_fma_f32 v[42:43], v[232:233], v[24:25], v[42:43] op_sel:[0,1,0] op_sel_hi:[1,1,1]
    v_pk_fma_f32 v[44:45], v[234:235], v[24:25], v[44:45] op_sel:[0,1,0] op_sel_hi:[1,1,1]
    v_pk_fma_f32 v[46:47], v[236:237], v[24:25], v[46:47] op_sel:[0,1,0] op_sel_hi:[1,1,1]
    v_pk_fma_f32 v[156:157], v[16:17], v[8:9], v[156:157] op_sel_hi:[1,0,1]
    v_pk_fma_f32 v[158:159], v[18:19], v[8:9], v[158:159] op_sel_hi:[1,0,1]
    v_pk_fma_f32 v[188:189], v[16:17], v[8:9], v[188:189] op_sel:[0,1,0] op_sel_hi:[1,1,1]
    v_pk_fma_f32 v[190:191], v[18:19], v[8:9], v[190:191] op_sel:[0,1,0] op_sel_hi:[1,1,1]
    v_pk_mul_f32 v[96:97], v[96:97], v[24:25] op_sel_hi:[1,0]
    v_pk_mul_f32 v[98:99], v[98:99], v[24:25] op_sel_hi:[1,0]
    v_pk_mul_f32 v[100:101], v[100:101], v[24:25] op_sel_hi:[1,0]
    v_pk_mul_f32 v[102:103], v[102:103], v[24:25] op_sel_hi:[1,0]
    v_pk_mul_f32 v[156:157], v[156:157], v[12:13]
    v_pk_mul_f32 v[158:159], v[158:159], v[14:15]
    v_pk_mul_f32 v[188:189], v[188:189], v[12:13]
    v_pk_mul_f32 v[190:191], v[190:191], v[14:15]
    v_mul_f32 v216, 0x3e8b97f6, v24
    v_cvt_pk_bf16_f32 v40, v40, v41
    v_cvt_pk_bf16_f32 v41, v42, v43
    v_cvt_pk_bf16_f32 v42, v44, v45
    v_cvt_pk_bf16_f32 v43, v46, v47
    v_cvt_pk_bf16_f32 v96, v96, v97
    v_cvt_pk_bf16_f32 v97, v98, v99
    v_cvt_pk_bf16_f32 v98, v100, v101
    v_cvt_pk_bf16_f32 v99, v102, v103
    v_cvt_pk_bf16_f32 v156, v156, v157
    v_cvt_pk_bf16_f32 v157, v158, v159
    v_cvt_pk_bf16_f32 v188, v188, v189
    v_cvt_pk_bf16_f32 v189, v190, v191
    ds_read2_b32 v[24:25], v34 offset0:32 offset1:160
    ds_read_b128 v[12:15], v35 offset:128
    ds_read_b128 v[16:19], v35 offset:640
    s_waitcnt lgkmcnt(3)
    v_pk_fma_f32 v[104:105], v[28:29], v[152:153], v[104:105] op_sel:[0,1,0] op_sel_hi:[1,1,1]
    v_pk_fma_f32 v[106:107], v[30:31], v[152:153], v[106:107] op_sel:[0,1,0] op_sel_hi:[1,1,1]
    v_pk_fma_f32 v[108:109], v[32:33], v[152:153], v[108:109] op_sel:[0,1,0] op_sel_hi:[1,1,1]
    v_pk_fma_f32 v[110:111], v[36:37], v[152:153], v[110:111] op_sel:[0,1,0] op_sel_hi:[1,1,1]
    v_pk_fma_f32 v[48:49], v[230:231], v[152:153], v[48:49] op_sel:[0,1,0] op_sel_hi:[1,1,1]
    v_pk_fma_f32 v[50:51], v[232:233], v[152:153], v[50:51] op_sel:[0,1,0] op_sel_hi:[1,1,1]
    v_pk_fma_f32 v[52:53], v[234:235], v[152:153], v[52:53] op_sel:[0,1,0] op_sel_hi:[1,1,1]
    v_pk_fma_f32 v[54:55], v[236:237], v[152:153], v[54:55] op_sel:[0,1,0] op_sel_hi:[1,1,1]
    v_pk_fma_f32 v[160:161], v[246:247], v[8:9], v[160:161] op_sel_hi:[1,0,1]
    v_pk_fma_f32 v[162:163], v[248:249], v[8:9], v[162:163] op_sel_hi:[1,0,1]
    v_pk_fma_f32 v[192:193], v[246:247], v[8:9], v[192:193] op_sel:[0,1,0] op_sel_hi:[1,1,1]
    v_pk_fma_f32 v[194:195], v[248:249], v[8:9], v[194:195] op_sel:[0,1,0] op_sel_hi:[1,1,1]
    v_pk_mul_f32 v[104:105], v[104:105], v[152:153] op_sel_hi:[1,0]
    v_pk_mul_f32 v[106:107], v[106:107], v[152:153] op_sel_hi:[1,0]
    v_pk_mul_f32 v[108:109], v[108:109], v[152:153] op_sel_hi:[1,0]
    v_pk_mul_f32 v[110:111], v[110:111], v[152:153] op_sel_hi:[1,0]
    v_pk_mul_f32 v[160:161], v[160:161], v[2:3]
    v_pk_mul_f32 v[162:163], v[162:163], v[4:5]
    v_pk_mul_f32 v[192:193], v[192:193], v[2:3]
    v_pk_mul_f32 v[194:195], v[194:195], v[4:5]
    v_mul_f32 v218, 0x3e8b97f6, v152
    v_mfma_f32_16x16x32_bf16 v[100:103], v[96:99], v[40:43], v[242:245]
    v_cvt_pk_bf16_f32 v48, v48, v49
    v_cvt_pk_bf16_f32 v49, v50, v51
    v_cvt_pk_bf16_f32 v50, v52, v53
    v_cvt_pk_bf16_f32 v51, v54, v55
    v_cvt_pk_bf16_f32 v104, v104, v105
    v_cvt_pk_bf16_f32 v105, v106, v107
    v_cvt_pk_bf16_f32 v106, v108, v109
    v_cvt_pk_bf16_f32 v107, v110, v111
    v_cvt_pk_bf16_f32 v158, v160, v161
    v_cvt_pk_bf16_f32 v159, v162, v163
    v_cvt_pk_bf16_f32 v190, v192, v193
    v_cvt_pk_bf16_f32 v191, v194, v195
    ds_read2_b32 v[152:153], v34 offset0:48 offset1:176
    ds_read_b128 v[2:5], v35 offset:192
    ds_read_b128 v[246:249], v35 offset:704
    s_waitcnt lgkmcnt(3)
    v_pk_fma_f32 v[112:113], v[28:29], v[24:25], v[112:113] op_sel:[0,1,0] op_sel_hi:[1,1,1]
    v_pk_fma_f32 v[114:115], v[30:31], v[24:25], v[114:115] op_sel:[0,1,0] op_sel_hi:[1,1,1]
    v_pk_fma_f32 v[116:117], v[32:33], v[24:25], v[116:117] op_sel:[0,1,0] op_sel_hi:[1,1,1]
    v_pk_fma_f32 v[118:119], v[36:37], v[24:25], v[118:119] op_sel:[0,1,0] op_sel_hi:[1,1,1]
    v_pk_fma_f32 v[56:57], v[230:231], v[24:25], v[56:57] op_sel:[0,1,0] op_sel_hi:[1,1,1]
    v_pk_fma_f32 v[58:59], v[232:233], v[24:25], v[58:59] op_sel:[0,1,0] op_sel_hi:[1,1,1]
    v_pk_fma_f32 v[60:61], v[234:235], v[24:25], v[60:61] op_sel:[0,1,0] op_sel_hi:[1,1,1]
    v_pk_fma_f32 v[62:63], v[236:237], v[24:25], v[62:63] op_sel:[0,1,0] op_sel_hi:[1,1,1]
    v_pk_fma_f32 v[164:165], v[16:17], v[8:9], v[164:165] op_sel_hi:[1,0,1]
    v_pk_fma_f32 v[166:167], v[18:19], v[8:9], v[166:167] op_sel_hi:[1,0,1]
    v_pk_fma_f32 v[196:197], v[16:17], v[8:9], v[196:197] op_sel:[0,1,0] op_sel_hi:[1,1,1]
    v_pk_fma_f32 v[198:199], v[18:19], v[8:9], v[198:199] op_sel:[0,1,0] op_sel_hi:[1,1,1]
    v_pk_mul_f32 v[112:113], v[112:113], v[24:25] op_sel_hi:[1,0]
    v_pk_mul_f32 v[114:115], v[114:115], v[24:25] op_sel_hi:[1,0]
    v_pk_mul_f32 v[116:117], v[116:117], v[24:25] op_sel_hi:[1,0]
    v_pk_mul_f32 v[118:119], v[118:119], v[24:25] op_sel_hi:[1,0]
    v_pk_mul_f32 v[164:165], v[164:165], v[12:13]
    v_pk_mul_f32 v[166:167], v[166:167], v[14:15]
    v_pk_mul_f32 v[196:197], v[196:197], v[12:13]
    v_pk_mul_f32 v[198:199], v[198:199], v[14:15]
    v_mul_f32 v220, 0x3e8b97f6, v24
    v_mfma_f32_16x16x32_bf16 v[52:55], v[96:99], v[48:51], 0
    v_mfma_f32_16x16x32_bf16 v[108:111], v[104:107], v[48:51], v[238:241]
    s_mov_b32 s74, 131072
    buffer_load_dwordx2 v[184:185], v250, s[16:19], s74 offen offset:60
    v_cvt_pk_bf16_f32 v56, v56, v57
    v_cvt_pk_bf16_f32 v57, v58, v59
    v_cvt_pk_bf16_f32 v58, v60, v61
    v_cvt_pk_bf16_f32 v59, v62, v63
    v_cvt_pk_bf16_f32 v112, v112, v113
    v_cvt_pk_bf16_f32 v113, v114, v115
    v_cvt_pk_bf16_f32 v114, v116, v117
    v_cvt_pk_bf16_f32 v115, v118, v119
    v_cvt_pk_bf16_f32 v160, v164, v165
    v_cvt_pk_bf16_f32 v161, v166, v167
    v_cvt_pk_bf16_f32 v192, v196, v197
    v_cvt_pk_bf16_f32 v193, v198, v199
    ds_read2_b32 v[24:25], v34 offset0:64 offset1:192
    ds_read_b128 v[12:15], v35 offset:256
    ds_read_b128 v[16:19], v35 offset:768
    s_waitcnt lgkmcnt(3)
    v_pk_fma_f32 v[120:121], v[28:29], v[152:153], v[120:121] op_sel:[0,1,0] op_sel_hi:[1,1,1]
    v_pk_fma_f32 v[122:123], v[30:31], v[152:153], v[122:123] op_sel:[0,1,0] op_sel_hi:[1,1,1]
    v_pk_fma_f32 v[124:125], v[32:33], v[152:153], v[124:125] op_sel:[0,1,0] op_sel_hi:[1,1,1]
    v_pk_fma_f32 v[126:127], v[36:37], v[152:153], v[126:127] op_sel:[0,1,0] op_sel_hi:[1,1,1]
    v_pk_fma_f32 v[64:65], v[230:231], v[152:153], v[64:65] op_sel:[0,1,0] op_sel_hi:[1,1,1]
    v_pk_fma_f32 v[66:67], v[232:233], v[152:153], v[66:67] op_sel:[0,1,0] op_sel_hi:[1,1,1]
    v_pk_fma_f32 v[68:69], v[234:235], v[152:153], v[68:69] op_sel:[0,1,0] op_sel_hi:[1,1,1]
    v_pk_fma_f32 v[70:71], v[236:237], v[152:153], v[70:71] op_sel:[0,1,0] op_sel_hi:[1,1,1]
    v_pk_fma_f32 v[168:169], v[246:247], v[8:9], v[168:169] op_sel_hi:[1,0,1]
    v_pk_fma_f32 v[170:171], v[248:249], v[8:9], v[170:171] op_sel_hi:[1,0,1]
    v_pk_fma_f32 v[200:201], v[246:247], v[8:9], v[200:201] op_sel:[0,1,0] op_sel_hi:[1,1,1]
    v_pk_fma_f32 v[202:203], v[248:249], v[8:9], v[202:203] op_sel:[0,1,0] op_sel_hi:[1,1,1]
    v_pk_mul_f32 v[120:121], v[120:121], v[152:153] op_sel_hi:[1,0]
    v_pk_mul_f32 v[122:123], v[122:123], v[152:153] op_sel_hi:[1,0]
    v_pk_mul_f32 v[124:125], v[124:125], v[152:153] op_sel_hi:[1,0]
    v_pk_mul_f32 v[126:127], v[126:127], v[152:153] op_sel_hi:[1,0]
    v_pk_mul_f32 v[168:169], v[168:169], v[2:3]
    v_pk_mul_f32 v[170:171], v[170:171], v[4:5]
    v_pk_mul_f32 v[200:201], v[200:201], v[2:3]
    v_pk_mul_f32 v[202:203], v[202:203], v[4:5]
    v_mul_f32 v222, 0x3e8b97f6, v152
    v_mfma_f32_16x16x32_bf16 v[60:63], v[104:107], v[56:59], 0
    v_mfma_f32_16x16x32_bf16 v[116:119], v[112:115], v[56:59], v[238:241]
    v_cvt_pk_bf16_f32 v64, v64, v65
    v_cvt_pk_bf16_f32 v65, v66, v67
    v_cvt_pk_bf16_f32 v66, v68, v69
    v_cvt_pk_bf16_f32 v67, v70, v71
    v_cvt_pk_bf16_f32 v120, v120, v121
    v_cvt_pk_bf16_f32 v121, v122, v123
    v_cvt_pk_bf16_f32 v122, v124, v125
    v_cvt_pk_bf16_f32 v123, v126, v127
    v_cvt_pk_bf16_f32 v162, v168, v169
    v_cvt_pk_bf16_f32 v163, v170, v171
    v_cvt_pk_bf16_f32 v194, v200, v201
    v_cvt_pk_bf16_f32 v195, v202, v203
    ds_read2_b32 v[152:153], v34 offset0:80 offset1:208
    ds_read_b128 v[2:5], v35 offset:320
    ds_read_b128 v[246:249], v35 offset:832
    s_waitcnt lgkmcnt(3)
    v_pk_fma_f32 v[128:129], v[28:29], v[24:25], v[128:129] op_sel:[0,1,0] op_sel_hi:[1,1,1]
    v_pk_fma_f32 v[130:131], v[30:31], v[24:25], v[130:131] op_sel:[0,1,0] op_sel_hi:[1,1,1]
    v_pk_fma_f32 v[132:133], v[32:33], v[24:25], v[132:133] op_sel:[0,1,0] op_sel_hi:[1,1,1]
    v_pk_fma_f32 v[134:135], v[36:37], v[24:25], v[134:135] op_sel:[0,1,0] op_sel_hi:[1,1,1]
    v_pk_fma_f32 v[72:73], v[230:231], v[24:25], v[72:73] op_sel:[0,1,0] op_sel_hi:[1,1,1]
    v_pk_fma_f32 v[74:75], v[232:233], v[24:25], v[74:75] op_sel:[0,1,0] op_sel_hi:[1,1,1]
    v_pk_fma_f32 v[76:77], v[234:235], v[24:25], v[76:77] op_sel:[0,1,0] op_sel_hi:[1,1,1]
    v_pk_fma_f32 v[78:79], v[236:237], v[24:25], v[78:79] op_sel:[0,1,0] op_sel_hi:[1,1,1]
    v_pk_fma_f32 v[172:173], v[16:17], v[8:9], v[172:173] op_sel_hi:[1,0,1]
    v_pk_fma_f32 v[174:175], v[18:19], v[8:9], v[174:175] op_sel_hi:[1,0,1]
    v_pk_fma_f32 v[204:205], v[16:17], v[8:9], v[204:205] op_sel:[0,1,0] op_sel_hi:[1,1,1]
    v_pk_fma_f32 v[206:207], v[18:19], v[8:9], v[206:207] op_sel:[0,1,0] op_sel_hi:[1,1,1]
    v_pk_mul_f32 v[128:129], v[128:129], v[24:25] op_sel_hi:[1,0]
L_pad_14:
    s_cbranch_execz L_ret
    v_pk_mul_f32 v[130:131], v[130:131], v[24:25] op_sel_hi:[1,0]
    v_pk_mul_f32 v[132:133], v[132:133], v[24:25] op_sel_hi:[1,0]
    v_pk_mul_f32 v[134:135], v[134:135], v[24:25] op_sel_hi:[1,0]
    v_pk_mul_f32 v[172:173], v[172:173], v[12:13]
    v_pk_mul_f32 v[174:175], v[174:175], v[14:15]
    v_pk_mul_f32 v[204:205], v[204:205], v[12:13]
    v_pk_mul_f32 v[206:207], v[206:207], v[14:15]
    v_mul_f32 v224, 0x3e8b97f6, v24
    v_mfma_f32_16x16x32_bf16 v[68:71], v[112:115], v[64:67], 0
    v_mfma_f32_16x16x32_bf16 v[124:127], v[120:123], v[64:67], v[238:241]
    v_cvt_pk_bf16_f32 v72, v72, v73
    v_cvt_pk_bf16_f32 v73, v74, v75
    v_cvt_pk_bf16_f32 v74, v76, v77
    v_cvt_pk_bf16_f32 v75, v78, v79
    v_cvt_pk_bf16_f32 v128, v128, v129
    v_cvt_pk_bf16_f32 v129, v130, v131
    v_cvt_pk_bf16_f32 v130, v132, v133
    v_cvt_pk_bf16_f32 v131, v134, v135
    v_cvt_pk_bf16_f32 v164, v172, v173
    v_cvt_pk_bf16_f32 v165, v174, v175
    v_cvt_pk_bf16_f32 v196, v204, v205
    v_cvt_pk_bf16_f32 v197, v206, v207
    ds_read2_b32 v[24:25], v34 offset0:96 offset1:224
    ds_read_b128 v[12:15], v35 offset:384
    ds_read_b128 v[16:19], v35 offset:896
    s_waitcnt lgkmcnt(3)
    v_pk_fma_f32 v[136:137], v[28:29], v[152:153], v[136:137] op_sel:[0,1,0] op_sel_hi:[1,1,1]
    v_pk_fma_f32 v[138:139], v[30:31], v[152:153], v[138:139] op_sel:[0,1,0] op_sel_hi:[1,1,1]
    v_pk_fma_f32 v[140:141], v[32:33], v[152:153], v[140:141] op_sel:[0,1,0] op_sel_hi:[1,1,1]
    v_pk_fma_f32 v[142:143], v[36:37], v[152:153], v[142:143] op_sel:[0,1,0] op_sel_hi:[1,1,1]
    v_pk_fma_f32 v[80:81], v[230:231], v[152:153], v[80:81] op_sel:[0,1,0] op_sel_hi:[1,1,1]
    v_pk_fma_f32 v[82:83], v[232:233], v[152:153], v[82:83] op_sel:[0,1,0] op_sel_hi:[1,1,1]
    v_pk_fma_f32 v[84:85], v[234:235], v[152:153], v[84:85] op_sel:[0,1,0] op_sel_hi:[1,1,1]
    v_pk_fma_f32 v[86:87], v[236:237], v[152:153], v[86:87] op_sel:[0,1,0] op_sel_hi:[1,1,1]
    v_pk_fma_f32 v[176:177], v[246:247], v[8:9], v[176:177] op_sel_hi:[1,0,1]
    v_pk_fma_f32 v[178:179], v[248:249], v[8:9], v[178:179] op_sel_hi:[1,0,1]
    v_pk_fma_f32 v[208:209], v[246:247], v[8:9], v[208:209] op_sel:[0,1,0] op_sel_hi:[1,1,1]
    v_pk_fma_f32 v[210:211], v[248:249], v[8:9], v[210:211] op_sel:[0,1,0] op_sel_hi:[1,1,1]
    v_pk_mul_f32 v[136:137], v[136:137], v[152:153] op_sel_hi:[1,0]
    v_pk_mul_f32 v[138:139], v[138:139], v[152:153] op_sel_hi:[1,0]
    v_pk_mul_f32 v[140:141], v[140:141], v[152:153] op_sel_hi:[1,0]
    v_pk_mul_f32 v[142:143], v[142:143], v[152:153] op_sel_hi:[1,0]
    v_pk_mul_f32 v[176:177], v[176:177], v[2:3]
    v_pk_mul_f32 v[178:179], v[178:179], v[4:5]
    v_pk_mul_f32 v[208:209], v[208:209], v[2:3]
    v_pk_mul_f32 v[210:211], v[210:211], v[4:5]
    v_mul_f32 v226, 0x3e8b97f6, v152
    v_mfma_f32_16x16x32_bf16 v[76:79], v[120:123], v[72:75], 0
    v_mfma_f32_16x16x32_bf16 v[132:135], v[128:131], v[72:75], v[238:241]
    s_mov_b32 s74, 262144
    buffer_load_dwordx2 v[184:185], v250, s[16:19], s74 offen offset:60
    v_cvt_pk_bf16_f32 v80, v80, v81
    v_cvt_pk_bf16_f32 v81, v82, v83
    v_cvt_pk_bf16_f32 v82, v84, v85
    v_cvt_pk_bf16_f32 v83, v86, v87
    v_cvt_pk_bf16_f32 v136, v136, v137
    v_cvt_pk_bf16_f32 v137, v138, v139
    v_cvt_pk_bf16_f32 v138, v140, v141
    v_cvt_pk_bf16_f32 v139, v142, v143
    v_cvt_pk_bf16_f32 v166, v176, v177
    v_cvt_pk_bf16_f32 v167, v178, v179
    v_cvt_pk_bf16_f32 v198, v208, v209
    v_cvt_pk_bf16_f32 v199, v210, v211
    s_waitcnt lgkmcnt(0)
    v_pk_fma_f32 v[144:145], v[28:29], v[24:25], v[144:145] op_sel:[0,1,0] op_sel_hi:[1,1,1]
    v_pk_fma_f32 v[146:147], v[30:31], v[24:25], v[146:147] op_sel:[0,1,0] op_sel_hi:[1,1,1]
    v_pk_fma_f32 v[148:149], v[32:33], v[24:25], v[148:149] op_sel:[0,1,0] op_sel_hi:[1,1,1]
    v_pk_fma_f32 v[150:151], v[36:37], v[24:25], v[150:151] op_sel:[0,1,0] op_sel_hi:[1,1,1]
    v_pk_fma_f32 v[88:89], v[230:231], v[24:25], v[88:89] op_sel:[0,1,0] op_sel_hi:[1,1,1]
    v_pk_fma_f32 v[90:91], v[232:233], v[24:25], v[90:91] op_sel:[0,1,0] op_sel_hi:[1,1,1]
    v_pk_fma_f32 v[92:93], v[234:235], v[24:25], v[92:93] op_sel:[0,1,0] op_sel_hi:[1,1,1]
    v_pk_fma_f32 v[94:95], v[236:237], v[24:25], v[94:95] op_sel:[0,1,0] op_sel_hi:[1,1,1]
    v_pk_fma_f32 v[180:181], v[16:17], v[8:9], v[180:181] op_sel_hi:[1,0,1]
    v_pk_fma_f32 v[182:183], v[18:19], v[8:9], v[182:183] op_sel_hi:[1,0,1]
    v_pk_fma_f32 v[212:213], v[16:17], v[8:9], v[212:213] op_sel:[0,1,0] op_sel_hi:[1,1,1]
    v_pk_fma_f32 v[214:215], v[18:19], v[8:9], v[214:215] op_sel:[0,1,0] op_sel_hi:[1,1,1]
    v_pk_mul_f32 v[144:145], v[144:145], v[24:25] op_sel_hi:[1,0]
    v_pk_mul_f32 v[146:147], v[146:147], v[24:25] op_sel_hi:[1,0]
    v_pk_mul_f32 v[148:149], v[148:149], v[24:25] op_sel_hi:[1,0]
    v_pk_mul_f32 v[150:151], v[150:151], v[24:25] op_sel_hi:[1,0]
    v_pk_mul_f32 v[180:181], v[180:181], v[12:13]
    v_pk_mul_f32 v[182:183], v[182:183], v[14:15]
    v_pk_mul_f32 v[212:213], v[212:213], v[12:13]
    v_pk_mul_f32 v[214:215], v[214:215], v[14:15]
    v_mul_f32 v228, 0x3e8b97f6, v24
    v_mfma_f32_16x16x32_bf16 v[84:87], v[128:131], v[80:83], 0
    v_mfma_f32_16x16x32_bf16 v[140:143], v[136:139], v[80:83], v[238:241]
    v_cvt_pk_bf16_f32 v88, v88, v89
    v_cvt_pk_bf16_f32 v89, v90, v91
    v_cvt_pk_bf16_f32 v90, v92, v93
    v_cvt_pk_bf16_f32 v91, v94, v95
    v_cvt_pk_bf16_f32 v144, v144, v145
    v_cvt_pk_bf16_f32 v145, v146, v147
    v_cvt_pk_bf16_f32 v146, v148, v149
    v_cvt_pk_bf16_f32 v147, v150, v151
    v_cvt_pk_bf16_f32 v168, v180, v181
    v_cvt_pk_bf16_f32 v169, v182, v183
    v_cvt_pk_bf16_f32 v200, v212, v213
    v_cvt_pk_bf16_f32 v201, v214, v215
    v_mfma_f32_16x16x32_bf16 v[92:95], v[136:139], v[88:91], 0
    v_mfma_f32_16x16x32_bf16 v[148:151], v[144:147], v[88:91], v[238:241]
    v_max3_f32 v217, v100, v101, v102
    v_max_f32 v217, v217, v103
    v_cndmask_b32 v108, v108, v52, s[6:7]
    v_cndmask_b32 v109, v109, v53, s[46:47]
    v_cndmask_b32 v110, v110, v54, s[48:49]
    v_cndmask_b32 v111, v111, v55, s[50:51]
    v_max3_f32 v219, v108, v109, v110
    v_max_f32 v219, v219, v111
    v_cndmask_b32 v116, v116, v60, s[6:7]
    v_cndmask_b32 v117, v117, v61, s[46:47]
    v_cndmask_b32 v118, v118, v62, s[48:49]
    v_cndmask_b32 v119, v119, v63, s[50:51]
    v_max3_f32 v221, v116, v117, v118
    v_max_f32 v221, v221, v119
    v_cndmask_b32 v124, v124, v68, s[6:7]
    v_cndmask_b32 v125, v125, v69, s[46:47]
    v_cndmask_b32 v126, v126, v70, s[48:49]
    v_cndmask_b32 v127, v127, v71, s[50:51]
    v_max3_f32 v223, v124, v125, v126
    v_max_f32 v223, v223, v127
    v_cndmask_b32 v132, v132, v76, s[6:7]
    v_cndmask_b32 v133, v133, v77, s[46:47]
    v_cndmask_b32 v134, v134, v78, s[48:49]
    v_cndmask_b32 v135, v135, v79, s[50:51]
    v_max3_f32 v225, v132, v133, v134
    v_max_f32 v225, v225, v135
    v_cndmask_b32 v140, v140, v84, s[6:7]
    v_cndmask_b32 v141, v141, v85, s[46:47]
    v_cndmask_b32 v142, v142, v86, s[48:49]
    v_cndmask_b32 v143, v143, v87, s[50:51]
    v_max3_f32 v227, v140, v141, v142
    v_max_f32 v227, v227, v143
    v_cndmask_b32 v148, v148, v92, s[6:7]
    v_cndmask_b32 v149, v149, v93, s[46:47]
    v_cndmask_b32 v150, v150, v94, s[48:49]
    v_cndmask_b32 v151, v151, v95, s[50:51]
    v_max3_f32 v229, v148, v149, v150
    v_max_f32 v229, v229, v151
    v_permlane16_swap_b32 v217, v219
    v_mov_b32 v3, v229
    v_max_f32 v217, v217, v219
    v_permlane16_swap_b32 v225, v227
    v_permlane16_swap_b32 v221, v223
    v_max_f32 v225, v225, v227
    v_max_f32 v221, v221, v223
    v_permlane16_swap_b32 v229, v3
    s_nop 0
    v_permlane32_swap_b32 v217, v221
    v_max_f32 v229, v229, v3
    v_max_f32 v217, v217, v221
    s_nop 0
    v_permlane32_swap_b32 v225, v229
    v_mov_b32 v221, v217
    v_max_f32 v225, v225, v229
    s_nop 0
    v_permlane32_swap_b32 v217, v221
    v_mov_b32 v229, v225
    v_mov_b32 v223, v221
    s_nop 0
    v_permlane32_swap_b32 v225, v229
    v_mov_b32 v219, v217
    v_mov_b32 v227, v225
    v_permlane16_swap_b32 v221, v223
    s_nop 0
    v_permlane16_swap_b32 v225, v227
    v_permlane16_swap_b32 v217, v219
    v_mul_f32 v217, -v217, v216
    v_mul_f32 v219, -v219, v218
    v_mul_f32 v221, -v221, v220
    v_mul_f32 v223, -v223, v222
    v_mul_f32 v225, -v225, v224
    v_mul_f32 v227, -v227, v226
    v_mul_f32 v229, -v229, v228
    v_pk_fma_f32 v[100:101], v[100:101], v[216:217], v[216:217] op_sel:[0,0,1] op_sel_hi:[1,0,1]
    v_pk_fma_f32 v[102:103], v[102:103], v[216:217], v[216:217] op_sel:[0,0,1] op_sel_hi:[1,0,1]
    v_pk_fma_f32 v[108:109], v[108:109], v[218:219], v[218:219] op_sel:[0,0,1] op_sel_hi:[1,0,1]
    v_pk_fma_f32 v[110:111], v[110:111], v[218:219], v[218:219] op_sel:[0,0,1] op_sel_hi:[1,0,1]
    v_pk_fma_f32 v[116:117], v[116:117], v[220:221], v[220:221] op_sel:[0,0,1] op_sel_hi:[1,0,1]
    v_pk_fma_f32 v[118:119], v[118:119], v[220:221], v[220:221] op_sel:[0,0,1] op_sel_hi:[1,0,1]
    v_pk_fma_f32 v[124:125], v[124:125], v[222:223], v[222:223] op_sel:[0,0,1] op_sel_hi:[1,0,1]
    v_pk_fma_f32 v[126:127], v[126:127], v[222:223], v[222:223] op_sel:[0,0,1] op_sel_hi:[1,0,1]
    v_pk_fma_f32 v[132:133], v[132:133], v[224:225], v[224:225] op_sel:[0,0,1] op_sel_hi:[1,0,1]
    v_pk_fma_f32 v[134:135], v[134:135], v[224:225], v[224:225] op_sel:[0,0,1] op_sel_hi:[1,0,1]
    v_pk_fma_f32 v[140:141], v[140:141], v[226:227], v[226:227] op_sel:[0,0,1] op_sel_hi:[1,0,1]
    v_pk_fma_f32 v[142:143], v[142:143], v[226:227], v[226:227] op_sel:[0,0,1] op_sel_hi:[1,0,1]
    v_pk_fma_f32 v[148:149], v[148:149], v[228:229], v[228:229] op_sel:[0,0,1] op_sel_hi:[1,0,1]
    v_pk_fma_f32 v[150:151], v[150:151], v[228:229], v[228:229] op_sel:[0,0,1] op_sel_hi:[1,0,1]
    v_exp_f32 v100, v100
    v_exp_f32 v101, v101
    v_exp_f32 v102, v102
    v_exp_f32 v103, v103
    v_cvt_pk_bf16_f32 v42, v100, v101
    v_cvt_pk_bf16_f32 v43, v102, v103
    v_mov_b32 v40, 0
    v_mov_b32 v41, 0
    v_exp_f32 v108, v108
    v_exp_f32 v109, v109
    v_mfma_f32_16x16x32_bf16 v[96:99], v[20:23], v[40:43], 0
    v_exp_f32 v110, v110
    v_mfma_f32_16x16x32_bf16 v[44:47], v[154:157], v[40:43], 0
    v_exp_f32 v111, v111
    v_mfma_f32_16x16x32_bf16 v[100:103], v[186:189], v[40:43], 0
    v_cvt_pk_bf16_f32 v50, v108, v109
    v_cvt_pk_bf16_f32 v51, v110, v111
    v_and_b32 v48, v10, v50
    v_and_b32 v49, v11, v51
    v_xor_b32 v50, v48, v50
    v_xor_b32 v51, v49, v51
    v_exp_f32 v116, v116
    v_exp_f32 v117, v117
    v_mfma_f32_16x16x32_bf16 v[104:107], v[20:23], v[48:51], 0
    v_exp_f32 v118, v118
    v_mfma_f32_16x16x32_bf16 v[52:55], v[156:159], v[48:51], 0
    v_exp_f32 v119, v119
    v_mfma_f32_16x16x32_bf16 v[108:111], v[188:191], v[48:51], 0
    v_cvt_pk_bf16_f32 v58, v116, v117
    v_cvt_pk_bf16_f32 v59, v118, v119
    v_and_b32 v56, v10, v58
    v_and_b32 v57, v11, v59
    v_xor_b32 v58, v56, v58
    v_xor_b32 v59, v57, v59
    v_exp_f32 v124, v124
    v_exp_f32 v125, v125
    v_mfma_f32_16x16x32_bf16 v[112:115], v[20:23], v[56:59], 0
    v_exp_f32 v126, v126
    v_mfma_f32_16x16x32_bf16 v[60:63], v[158:161], v[56:59], 0
    v_exp_f32 v127, v127
    v_mfma_f32_16x16x32_bf16 v[116:119], v[190:193], v[56:59], 0
    v_cvt_pk_bf16_f32 v66, v124, v125
    v_cvt_pk_bf16_f32 v67, v126, v127
    v_and_b32 v64, v10, v66
    v_and_b32 v65, v11, v67
    v_xor_b32 v66, v64, v66
    v_xor_b32 v67, v65, v67
    v_exp_f32 v132, v132
    v_exp_f32 v133, v133
    v_mfma_f32_16x16x32_bf16 v[120:123], v[20:23], v[64:67], 0
    v_exp_f32 v134, v134
    v_mfma_f32_16x16x32_bf16 v[68:71], v[160:163], v[64:67], 0
    v_exp_f32 v135, v135
    v_mfma_f32_16x16x32_bf16 v[124:127], v[192:195], v[64:67], 0
    v_cvt_pk_bf16_f32 v74, v132, v133
    v_cvt_pk_bf16_f32 v75, v134, v135
    v_and_b32 v72, v10, v74
    v_and_b32 v73, v11, v75
    v_xor_b32 v74, v72, v74
    v_xor_b32 v75, v73, v75
    v_exp_f32 v140, v140
    v_exp_f32 v141, v141
    v_mfma_f32_16x16x32_bf16 v[128:131], v[20:23], v[72:75], 0
    v_exp_f32 v142, v142
    v_mfma_f32_16x16x32_bf16 v[76:79], v[162:165], v[72:75], 0
    v_exp_f32 v143, v143
    v_mfma_f32_16x16x32_bf16 v[132:135], v[194:197], v[72:75], 0
    v_cvt_pk_bf16_f32 v82, v140, v141
    v_cvt_pk_bf16_f32 v83, v142, v143
    v_and_b32 v80, v10, v82
    v_and_b32 v81, v11, v83
    v_xor_b32 v82, v80, v82
    v_xor_b32 v83, v81, v83
    v_exp_f32 v148, v148
    v_exp_f32 v149, v149
    v_mfma_f32_16x16x32_bf16 v[136:139], v[20:23], v[80:83], 0
    v_exp_f32 v150, v150
    v_mfma_f32_16x16x32_bf16 v[84:87], v[164:167], v[80:83], 0
    v_exp_f32 v151, v151
    v_mfma_f32_16x16x32_bf16 v[140:143], v[196:199], v[80:83], 0
    v_cvt_pk_bf16_f32 v90, v148, v149
    v_cvt_pk_bf16_f32 v91, v150, v151
    v_and_b32 v88, v10, v90
    v_and_b32 v89, v11, v91
    v_xor_b32 v90, v88, v90
    v_xor_b32 v91, v89, v91
    v_rcp_f32 v96, v96
    v_rcp_f32 v104, v104
    v_mfma_f32_16x16x32_bf16 v[144:147], v[20:23], v[88:91], 0
    v_rcp_f32 v112, v112
    v_mfma_f32_16x16x32_bf16 v[92:95], v[166:169], v[88:91], 0
    v_rcp_f32 v120, v120
    v_mfma_f32_16x16x32_bf16 v[148:151], v[198:201], v[88:91], 0
    v_rcp_f32 v128, v128
    v_rcp_f32 v136, v136
    s_nop 1
    v_rcp_f32 v144, v144
    v_pk_mul_f32 v[44:45], v[44:45], v[96:97] op_sel_hi:[1,0]
    v_pk_mul_f32 v[46:47], v[46:47], v[96:97] op_sel_hi:[1,0]
    v_pk_mul_f32 v[100:101], v[100:101], v[96:97] op_sel_hi:[1,0]
    v_pk_mul_f32 v[102:103], v[102:103], v[96:97] op_sel_hi:[1,0]
    v_cvt_pk_bf16_f32 v40, v44, v45
    v_cvt_pk_bf16_f32 v41, v46, v47
    v_cvt_pk_bf16_f32 v42, v100, v101
    v_cvt_pk_bf16_f32 v43, v102, v103
    buffer_store_dwordx4 v[40:43], v27, s[40:43], s1 offen sc1
    s_add_u32 s1, s1, 32768
    v_pk_mul_f32 v[52:53], v[52:53], v[104:105] op_sel_hi:[1,0]
    v_pk_mul_f32 v[54:55], v[54:55], v[104:105] op_sel_hi:[1,0]
    v_pk_mul_f32 v[108:109], v[108:109], v[104:105] op_sel_hi:[1,0]
    v_pk_mul_f32 v[110:111], v[110:111], v[104:105] op_sel_hi:[1,0]
    v_cvt_pk_bf16_f32 v48, v52, v53
    v_cvt_pk_bf16_f32 v49, v54, v55
    v_cvt_pk_bf16_f32 v50, v108, v109
    v_cvt_pk_bf16_f32 v51, v110, v111
    buffer_store_dwordx4 v[48:51], v7, s[40:43], s1 offen sc1
    s_add_u32 s1, s1, 32768
    v_pk_mul_f32 v[60:61], v[60:61], v[112:113] op_sel_hi:[1,0]
    v_pk_mul_f32 v[62:63], v[62:63], v[112:113] op_sel_hi:[1,0]
    v_pk_mul_f32 v[116:117], v[116:117], v[112:113] op_sel_hi:[1,0]
    v_pk_mul_f32 v[118:119], v[118:119], v[112:113] op_sel_hi:[1,0]
    v_cvt_pk_bf16_f32 v56, v60, v61
    v_cvt_pk_bf16_f32 v57, v62, v63
    v_cvt_pk_bf16_f32 v58, v116, v117
    v_cvt_pk_bf16_f32 v59, v118, v119
    buffer_store_dwordx4 v[56:59], v7, s[40:43], s1 offen sc1
    s_add_u32 s1, s1, 32768
    v_pk_mul_f32 v[68:69], v[68:69], v[120:121] op_sel_hi:[1,0]
    v_pk_mul_f32 v[70:71], v[70:71], v[120:121] op_sel_hi:[1,0]
    v_pk_mul_f32 v[124:125], v[124:125], v[120:121] op_sel_hi:[1,0]
    v_pk_mul_f32 v[126:127], v[126:127], v[120:121] op_sel_hi:[1,0]
    v_cvt_pk_bf16_f32 v64, v68, v69
    v_cvt_pk_bf16_f32 v65, v70, v71
    v_cvt_pk_bf16_f32 v66, v124, v125
    v_cvt_pk_bf16_f32 v67, v126, v127
    buffer_store_dwordx4 v[64:67], v7, s[40:43], s1 offen sc1
    s_add_u32 s1, s1, 32768
    v_pk_mul_f32 v[76:77], v[76:77], v[128:129] op_sel_hi:[1,0]
    v_pk_mul_f32 v[78:79], v[78:79], v[128:129] op_sel_hi:[1,0]
    v_pk_mul_f32 v[132:133], v[132:133], v[128:129] op_sel_hi:[1,0]
    v_pk_mul_f32 v[134:135], v[134:135], v[128:129] op_sel_hi:[1,0]
    v_cvt_pk_bf16_f32 v72, v76, v77
    v_cvt_pk_bf16_f32 v73, v78, v79
    v_cvt_pk_bf16_f32 v74, v132, v133
    v_cvt_pk_bf16_f32 v75, v134, v135
    buffer_store_dwordx4 v[72:75], v7, s[40:43], s1 offen sc1
    s_add_u32 s1, s1, 32768
    v_pk_mul_f32 v[84:85], v[84:85], v[136:137] op_sel_hi:[1,0]
    v_pk_mul_f32 v[86:87], v[86:87], v[136:137] op_sel_hi:[1,0]
    v_pk_mul_f32 v[140:141], v[140:141], v[136:137] op_sel_hi:[1,0]
    v_pk_mul_f32 v[142:143], v[142:143], v[136:137] op_sel_hi:[1,0]
    v_cvt_pk_bf16_f32 v80, v84, v85
    v_cvt_pk_bf16_f32 v81, v86, v87
    v_cvt_pk_bf16_f32 v82, v140, v141
    v_cvt_pk_bf16_f32 v83, v142, v143
    buffer_store_dwordx4 v[80:83], v7, s[40:43], s1 offen sc1
    s_add_u32 s1, s1, 32768
    v_pk_mul_f32 v[92:93], v[92:93], v[144:145] op_sel_hi:[1,0]
    v_pk_mul_f32 v[94:95], v[94:95], v[144:145] op_sel_hi:[1,0]
    v_pk_mul_f32 v[148:149], v[148:149], v[144:145] op_sel_hi:[1,0]
    v_pk_mul_f32 v[150:151], v[150:151], v[144:145] op_sel_hi:[1,0]
    v_cvt_pk_bf16_f32 v88, v92, v93
    v_cvt_pk_bf16_f32 v89, v94, v95
    v_cvt_pk_bf16_f32 v90, v148, v149
    v_cvt_pk_bf16_f32 v91, v150, v151
    buffer_store_dwordx4 v[88:91], v7, s[40:43], s1 offen sc1
    s_add_u32 s1, s1, 32768
    s_waitcnt vmcnt(0)
    s_barrier
    s_cmp_lg_u32 s3, 0
    s_cbranch_scc1 L_flag_47
    v_cmp_eq_u32 vcc, 0, v1
    v_bfrev_b32 v17, 1
    v_mov_b32 v18, s44
    v_mov_b32 v19, s45
    v_cndmask_b32 v17, v17, 0, vcc
    s_lshl_b32 s74, s62, 1
    s_add_u32 s74, s74, s63
    s_lshl_b32 s74, s74, 4
    s_add_u32 s74, s74, s64
    s_mul_i32 s74, s74, 128
    s_add_u32 s74, s74, 61440
    buffer_store_dwordx2 v[18:19], v17, s[40:43], s74 offen sc1
L_flag_47:
    s_lshl_b32 s74, s2, 2
    s_add_u32 s74, s74, s3
    s_cmp_lg_u32 s74, 1020
    s_cbranch_scc1 L_fin
    v_mul_u32_u24 v2, 32, v1
    v_add_u32 v2, 4096, v2
    buffer_load_dwordx2 v[4:5], v2, s[40:43], 0 offen sc1
    s_waitcnt vmcnt(0)
    v_cmp_ne_u64 vcc, s[44:45], v[4:5]
    s_mov_b32 s65, 0
    s_cbranch_vccz L_polled_49
L_poll_48:
    buffer_load_dwordx2 v[4:5], v2, s[40:43], 0 offen sc1
    s_waitcnt vmcnt(0)
    v_cmp_ne_u64 vcc, s[44:45], v[4:5]
    s_add_u32 s65, s65, 1
    s_cbranch_vccz L_polled_49
    s_cmp_lt_u32 s65, 200000
    s_cbranch_scc1 L_poll_48
L_polled_49:
    v_add_u32 v2, 2048, v2
    buffer_load_dwordx2 v[4:5], v2, s[40:43], 0 offen sc1
    s_waitcnt vmcnt(0)
    v_cmp_ne_u64 vcc, s[44:45], v[4:5]
    s_mov_b32 s65, 0
    s_cbranch_vccz L_polled_51
L_poll_50:
    buffer_load_dwordx2 v[4:5], v2, s[40:43], 0 offen sc1
    s_waitcnt vmcnt(0)
    v_cmp_ne_u64 vcc, s[44:45], v[4:5]
    s_add_u32 s65, s65, 1
    s_cbranch_vccz L_polled_51
    s_cmp_lt_u32 s65, 200000
    s_cbranch_scc1 L_poll_50
L_polled_51:
    v_add_u32 v2, 2048, v2
    buffer_load_dwordx2 v[4:5], v2, s[40:43], 0 offen sc1
    s_waitcnt vmcnt(0)
    v_cmp_ne_u64 vcc, s[44:45], v[4:5]
    s_mov_b32 s65, 0
    s_cbranch_vccz L_polled_53
L_poll_52:
    buffer_load_dwordx2 v[4:5], v2, s[40:43], 0 offen sc1
    s_waitcnt vmcnt(0)
    v_cmp_ne_u64 vcc, s[44:45], v[4:5]
    s_add_u32 s65, s65, 1
    s_cbranch_vccz L_polled_53
    s_cmp_lt_u32 s65, 200000
    s_cbranch_scc1 L_poll_52
L_polled_53:
    v_add_u32 v2, 2048, v2
    buffer_load_dwordx2 v[4:5], v2, s[40:43], 0 offen sc1
    s_waitcnt vmcnt(0)
    v_cmp_ne_u64 vcc, s[44:45], v[4:5]
    s_mov_b32 s65, 0
    s_cbranch_vccz L_polled_55
L_poll_54:
    buffer_load_dwordx2 v[4:5], v2, s[40:43], 0 offen sc1
    s_waitcnt vmcnt(0)
    v_cmp_ne_u64 vcc, s[44:45], v[4:5]
    s_add_u32 s65, s65, 1
    s_cbranch_vccz L_polled_55
    s_cmp_lt_u32 s65, 200000
    s_cbranch_scc1 L_poll_54
L_polled_55:
    s_mov_b32 s74, 81792
    buffer_store_dword v18, v17, s[40:43], 0 offen sc1
    buffer_store_dword v19, v17, s[40:43], s74 offen sc1
    s_branch L_fin
L_last:
    s_endpgm
.section .rodata,"a"
.p2align 6
.amdhsa_kernel recurrent_scan__sliding_local_dilated__mixer_token_mlp__prompt_kernel
  .amdhsa_next_free_vgpr 512
  .amdhsa_next_free_sgpr 102
  .amdhsa_accum_offset 256
  .amdhsa_group_segment_fixed_size 0
  .amdhsa_kernarg_size 88
  .amdhsa_user_sgpr_count 2
  .amdhsa_user_sgpr_kernarg_segment_ptr 1
  .amdhsa_system_sgpr_workgroup_id_x 1
.end_amdhsa_kernel
```
